```python
import torch

def _softmax(x, axis=-1):
    return torch.softmax(x, dim=axis)
def _gelu(x):
    return torch.nn.functional.gelu(x, approximate="tanh")
def _silu(x):
    return torch.nn.functional.silu(x)
def _sigmoid(x):
    return torch.sigmoid(x)
def _layernorm(x, axis=-1, eps=1e-5):
    m = x.mean(dim=axis, keepdim=True)
    v = x.var(dim=axis, keepdim=True, unbiased=False)
    return (x - m) / torch.sqrt(v + eps)
def _scatter_add(tgt, idx, src, axis=0):
    return tgt.clone().index_add_(axis, idx, src)
def _segment_sum(src, seg, n):
    out = torch.zeros((n,) + src.shape[1:], dtype=src.dtype)
    return out.index_add_(0, seg, src)
def _pad(x, pw):
    flat = tuple(v for pair in reversed(pw) for v in pair)
    return torch.nn.functional.pad(x, flat)

kernel_name = 'concat_heads__mha_block_cached__gqa_block_cached__near_ridge'

def setup_inputs():

    _w = (lambda a: (lambda t: t.to(torch.bfloat16) if t.is_floating_point() else t)(torch.as_tensor(a)))
    def _A_setup():
        B, Sq, D = 8, 144, 512
        H, Sk, Dh = 32, 512, 128
        return {
            "x": _w((lambda *s: torch.randn(*s, dtype=torch.bfloat16) * 0.8)(B, Sq, D)),
            "k_cache": _w((lambda *s: torch.randn(*s, dtype=torch.bfloat16) * 0.8)(B, H, Sk, Dh)),
            "v_cache": _w((lambda *s: torch.randn(*s, dtype=torch.bfloat16) * 0.05)(B, H, Sk, Dh)),
            "wq": _w((lambda *s: torch.randn(*s, dtype=torch.bfloat16) * 0.8)(D, H * Dh) * (D ** -0.5)),
            "wo": _w((lambda *s: torch.randn(*s, dtype=torch.bfloat16) * 0.05)(H * Dh, D) * ((H * Dh) ** -0.5)),
        }
    _A_in = _A_setup()

    def _B_setup():
        B, Sq, D = 8, 144, 512
        Hq, Hkv, Sk, Dh = 32, 32, 512, 128
        assert Hq % Hkv == 0, (Hq, Hkv)
        return {
            "x": _w((lambda *s: torch.randn(*s, dtype=torch.bfloat16) * 0.8)(B, Sq, D)),
            "k_cache": _w((lambda *s: torch.randn(*s, dtype=torch.bfloat16) * 0.8)(B, Hkv, Sk, Dh)),
            "v_cache": _w((lambda *s: torch.randn(*s, dtype=torch.bfloat16) * 0.05)(B, Hkv, Sk, Dh)),
            "wq": _w((lambda *s: torch.randn(*s, dtype=torch.bfloat16) * 0.8)(D, Hq * Dh) * (D ** -0.5)),
            "wo": _w((lambda *s: torch.randn(*s, dtype=torch.bfloat16) * 0.05)(Hq * Dh, D) * ((Hq * Dh) ** -0.5)),
        }
    _B_in = _B_setup()

    return {
        "A_x": _A_in["x"],
        "A_k_cache": _A_in["k_cache"],
        "A_v_cache": _A_in["v_cache"],
        "A_wq": _A_in["wq"],
        "A_wo": _A_in["wo"],
        "B_x": _B_in["x"],
        "B_k_cache": _B_in["k_cache"],
        "B_v_cache": _B_in["v_cache"],
        "B_wq": _B_in["wq"],
        "B_wo": _B_in["wo"],
    }

def reference(A_x, A_k_cache, A_v_cache, A_wq, A_wo, B_x, B_k_cache, B_v_cache, B_wq, B_wo):
    def _A_ref(x, k_cache, v_cache, wq, wo):
        B, Sq, D = x.shape
        H, Dh = 32, 128
        q = (lambda x, *d: x.permute(*d))((x @ wq).reshape(B, Sq, H, Dh), 0, 2, 1, 3)
        scores = torch.einsum("bhqd,bhkd->bhqk", q, k_cache) * (Dh ** -0.5)
        p = _softmax(scores, axis=-1)
        o = torch.einsum("bhqk,bhkd->bhqd", p, v_cache)
        return (lambda x, *d: x.permute(*d))(o, 0, 2, 1, 3).reshape(B, Sq, H * Dh) @ wo

    def _B_ref(x, k_cache, v_cache, wq, wo):
        B, Sq, D = x.shape
        Hq, Dh = 32, 128
        Hkv = k_cache.shape[1]
        rep = Hq // Hkv
        q = (lambda x, *d: x.permute(*d))((x @ wq).reshape(B, Sq, Hq, Dh), 0, 2, 1, 3)
        k = (lambda x, n, axis: torch.repeat_interleave(x, n, dim=axis))(k_cache, rep, axis=1)
        v = (lambda x, n, axis: torch.repeat_interleave(x, n, dim=axis))(v_cache, rep, axis=1)
        scores = torch.einsum("bhqd,bhkd->bhqk", q, k) * (Dh ** -0.5)
        p = _softmax(scores, axis=-1)
        o = torch.einsum("bhqk,bhkd->bhqd", p, v)
        return (lambda x, *d: x.permute(*d))(o, 0, 2, 1, 3).reshape(B, Sq, Hq * Dh) @ wo

    a = _A_ref(A_x, A_k_cache, A_v_cache, A_wq, A_wo)
    b = _B_ref(B_x, B_k_cache, B_v_cache, B_wq, B_wo)
    return torch.concatenate([a, b], axis=-1)
```

```asm
; @launch kernel=concat_heads__mha_block_cached__gqa_block_cached__near_ridge_kernel grid=(256,1,1) block=(512,1,1) lds=161792
; @launch kernel=reduce_kernel grid=(256,1,1) block=(576,1,1) lds=0
.amdgcn_target "amdgcn-amd-amdhsa--gfx950"
.text
.globl concat_heads__mha_block_cached__gqa_block_cached__near_ridge_kernel
.p2align 8
.type concat_heads__mha_block_cached__gqa_block_cached__near_ridge_kernel,@function
concat_heads__mha_block_cached__gqa_block_cached__near_ridge_kernel:
    s_cmp_ge_u32 s2, 256
    s_cbranch_scc1 L_k1_end
    s_mov_b32 s100, s2
    s_load_dwordx16 s[4:19], s[0:1], 0
    s_load_dwordx8 s[20:27], s[0:1], 64
    s_load_dwordx2 s[28:29], s[0:1], 96
    v_lshrrev_b32 v69, 6, v0
    v_and_b32 v64, 63, v0
    v_readfirstlane_b32 s52, v69
    v_lshlrev_b32 v255, 4, v64
    s_nop 1
    s_mov_b32 s30, s52
    s_lshr_b32 s77, s52, 2
    s_and_b32 s52, s52, 3
    s_lshl_b32 s31, s77, 1
    s_xor_b32 s31, s31, s52
    s_and_b32 s62, s100, 7
    s_lshr_b32 s63, s100, 3
    s_lshr_b32 s70, s62, 2
    s_and_b32 s71, s62, 3
    s_lshl_b32 s71, s71, 2
    s_and_b32 s64, s63, 3
    s_add_u32 s71, s71, s64
    s_lshl_b32 s96, s71, 1
    s_add_u32 s71, s96, s77
    s_lshr_b32 s72, s63, 2
    s_lshl_b32 s62, s62, 3
    s_add_u32 s98, s62, s72
    v_lshrrev_b32 v65, 4, v64
    v_and_b32 v66, 15, v64
    v_lshrrev_b32 v67, 2, v66
    v_and_b32 v68, 3, v64
    v_lshrrev_b32 v69, 2, v64
    v_lshlrev_b32 v133, 10, v69
    v_and_b32 v69, 1, v65
    v_lshlrev_b32 v69, 1, v69
    v_xor_b32 v69, v69, v68
    v_lshl_add_u32 v133, v69, 4, v133
    v_lshlrev_b32 v69, 2, v65
    v_xor_b32 v69, v69, v66
    v_lshlrev_b32 v69, 4, v69
    v_lshl_add_u32 v248, v65, 8, v69
    v_lshl_add_u32 v132, v65, 13, v69
    v_lshl_add_u32 v252, v65, 10, v69
    s_mul_i32 s53, s52, 2112
    s_mul_i32 s62, s77, 16896
    s_add_u32 s53, s53, s62
    s_mul_i32 s54, s52, 2080
    s_mul_i32 s62, s77, 8448
    s_add_u32 s54, s54, s62
    s_lshl_b32 s62, s30, 3
    s_mov_b64 s[2:3], 0xff
    s_lshl_b64 s[2:3], s[2:3], s62
    s_lshl_b32 s65, s52, 11
    s_lshl_b32 s62, s52, 4
    s_mov_b64 s[78:79], 0xffff
    s_lshl_b64 s[78:79], s[78:79], s62
    s_lshl_b32 s57, s52, 16
    s_lshl_b32 s59, s30, 14
    s_lshl_b32 s60, s30, 10
    s_mov_b32 s69, 0x3e0293ee
    s_waitcnt lgkmcnt(0)
    s_cmp_eq_u32 s70, 0
    s_cselect_b32 s4, s4, s14
    s_cselect_b32 s5, s5, s15
    s_cselect_b32 s6, s6, s16
    s_cselect_b32 s7, s7, s17
    s_cselect_b32 s8, s8, s18
    s_cselect_b32 s9, s9, s19
    s_cselect_b32 s10, s10, s20
    s_cselect_b32 s11, s11, s21
    s_lshr_b32 s64, s100, 3
    s_lshl_b32 s64, s64, 3
    s_add_u32 s64, s64, s30
    s_and_b32 s62, s71, 0x18
    s_lshl_b32 s62, s62, 8
    s_sub_u32 s63, 0x400000, s62
    s_add_u32 s84, s10, s62
    s_addc_u32 s85, s11, 0
    s_and_b32 s85, s85, 0xffff
    s_mov_b32 s86, s63
    s_mov_b32 s87, 0x20000
    s_mov_b32 s62, 0
    s_add_u32 s80, s4, s62
    s_addc_u32 s81, s5, 0
    s_and_b32 s81, s81, 0xffff
    s_mov_b32 s82, 0x120000
    s_mov_b32 s83, 0x20000
    s_lshr_b32 s62, s64, 1
    s_lshl_b32 s62, s62, 13
    s_and_b32 s63, s64, 1
    s_lshl_b32 s63, s63, 10
    s_add_u32 s62, s62, s63
    v_lshlrev_b32 v70, 10, v65
    v_lshl_add_u32 v70, v66, 4, v70
    s_lshl_b32 s63, s64, 12
    s_lshr_b32 s73, s64, 3
    s_add_u32 s73, s73, 256
    s_lshl_b32 s73, s73, 12
    buffer_load_dwordx4 v[172:175], v255, s[84:87], s62 offen
    buffer_load_dwordx4 v[176:179], v70, s[80:83], s63 offen offset:0
    s_mov_b64 exec, s[2:3]
    buffer_load_dwordx4 v[180:183], v70, s[80:83], s73 offen offset:0
    s_mov_b64 exec, -1
    s_add_u32 s62, s62, 0x100000
    buffer_load_dwordx4 v[184:187], v255, s[84:87], s62 offen
    buffer_load_dwordx4 v[188:191], v70, s[80:83], s63 offen offset:256
    s_mov_b64 exec, s[2:3]
    buffer_load_dwordx4 v[192:195], v70, s[80:83], s73 offen offset:256
    s_mov_b64 exec, -1
    s_add_u32 s62, s62, 0x100000
    buffer_load_dwordx4 v[196:199], v255, s[84:87], s62 offen
    buffer_load_dwordx4 v[200:203], v70, s[80:83], s63 offen offset:512
    s_mov_b64 exec, s[2:3]
    buffer_load_dwordx4 v[204:207], v70, s[80:83], s73 offen offset:512
    s_mov_b64 exec, -1
    s_add_u32 s62, s62, 0x100000
    buffer_load_dwordx4 v[208:211], v255, s[84:87], s62 offen
    buffer_load_dwordx4 v[212:215], v70, s[80:83], s63 offen offset:768
    s_mov_b64 exec, s[2:3]
    buffer_load_dwordx4 v[216:219], v70, s[80:83], s73 offen offset:768
    s_mov_b64 exec, -1
    s_lshl_b32 s62, s71, 8
    s_sub_u32 s63, 0x400000, s62
    s_add_u32 s36, s10, s62
    s_addc_u32 s37, s11, 0
    s_and_b32 s37, s37, 0xffff
    s_mov_b32 s38, s63
    s_mov_b32 s39, 0x20000
    s_mul_i32 s62, s72, 147456
    s_add_u32 s32, s4, s62
    s_addc_u32 s33, s5, 0
    s_and_b32 s33, s33, 0xffff
    s_mov_b32 s34, 0x24000
    s_mov_b32 s35, 0x20000
    s_lshl_b32 s62, s72, 5
    s_add_u32 s63, s62, s71
    s_lshl_b32 s63, s63, 17
    s_add_u32 s40, s6, s63
    s_addc_u32 s41, s7, 0
    s_and_b32 s41, s41, 0xffff
    s_mov_b32 s42, 0x20000
    s_mov_b32 s43, 0x20000
    s_add_u32 s44, s8, s63
    s_addc_u32 s45, s9, 0
    s_and_b32 s45, s45, 0xffff
    s_mov_b32 s46, 0x20000
    s_mov_b32 s47, 0x20000
    v_and_b32 v69, 1, v67
    v_lshlrev_b32 v69, 1, v69
    v_xor_b32 v69, v69, v65
    v_lshl_add_u32 v69, v66, 2, v69
    v_lshlrev_b32 v69, 4, v69
    v_add_u32 v135, 93184, v69
    v_add_u32 v134, 84992, v69
    v_add_u32 v134, s65, v134
    v_lshlrev_b32 v69, 8, v67
    v_lshl_add_u32 v69, v68, 3, v69
    s_movk_i32 s62, 2080
    s_movk_i32 s63, 1056
    s_mov_b32 s16, 0
    s_mul_i32 s64, s77, 16896
    s_add_u32 s64, s64, 512
    s_mul_i32 s73, s77, 8448
    s_add_u32 s73, s73, 68096
    v_mad_u32_u24 v70, v65, s62, v69
    v_add_u32 v70, s73, v70
    v_mad_u32_u24 v69, v65, s63, v69
    v_add_u32 v69, 8448, v69
    v_add_u32 v69, s64, v69
    v_xor_b32 v71, s52, v67
    v_xor_b32 v72, 0, v71
    v_lshl_add_u32 v128, v72, 6, v70
    v_xor_b32 v72, 0, v67
    v_lshl_add_u32 v244, v72, 6, v69
    v_xor_b32 v72, 1, v71
    v_lshl_add_u32 v129, v72, 6, v70
    v_xor_b32 v72, 1, v67
    v_lshl_add_u32 v245, v72, 6, v69
    v_xor_b32 v72, 2, v71
    v_lshl_add_u32 v130, v72, 6, v70
    v_xor_b32 v72, 2, v67
    v_lshl_add_u32 v246, v72, 6, v69
    v_xor_b32 v72, 3, v71
    v_lshl_add_u32 v131, v72, 6, v70
    v_xor_b32 v72, 3, v67
    v_lshl_add_u32 v247, v72, 6, v69
    v_lshlrev_b32 v69, 8, v68
    v_lshl_add_u32 v69, v65, 4, v69
    v_mad_u32_u24 v69, v67, s63, v69
    v_add_u32 v69, s64, v69
    v_xor_b32 v71, s52, v68
    v_xor_b32 v72, 0, v71
    v_lshl_add_u32 v240, v72, 6, v69
    v_xor_b32 v72, 1, v71
    v_lshl_add_u32 v241, v72, 6, v69
    v_xor_b32 v72, 2, v71
    v_lshl_add_u32 v242, v72, 6, v69
    v_xor_b32 v72, 3, v71
    v_lshl_add_u32 v243, v72, 6, v69
    v_mov_b32 v64, 0
    v_mov_b32 v65, 0
    v_mov_b32 v66, 0
    v_mov_b32 v67, 0
    v_mov_b32 v68, 0
    v_mov_b32 v69, 0
    v_mov_b32 v70, 0
    v_mov_b32 v71, 0
    v_mov_b32 v72, 0
    v_mov_b32 v73, 0
    v_mov_b32 v74, 0
    v_mov_b32 v75, 0
    v_mov_b32 v76, 0
    v_mov_b32 v77, 0
    v_mov_b32 v78, 0
    v_mov_b32 v79, 0
    v_mov_b32 v80, 0
    v_mov_b32 v81, 0
    v_mov_b32 v82, 0
    v_mov_b32 v83, 0
    v_mov_b32 v84, 0
    v_mov_b32 v85, 0
    v_mov_b32 v86, 0
    v_mov_b32 v87, 0
    v_mov_b32 v88, 0
    v_mov_b32 v89, 0
    v_mov_b32 v90, 0
    v_mov_b32 v91, 0
    v_mov_b32 v92, 0
    v_mov_b32 v93, 0
    v_mov_b32 v94, 0
    v_mov_b32 v95, 0
    s_lshl_b32 s55, s52, 11
    s_mov_b32 s56, s55
    s_add_u32 s14, s53, 512
    s_mov_b32 s17, 33792
    s_mov_b32 s19, 0
    s_mov_b32 s18, 0xfffe7400
    s_waitcnt vmcnt(0)
    s_add_u32 m0, s54, 68096
    s_add_u32 s62, s57, 0
    buffer_load_dwordx4 v132, s[36:39], s62 offen lds
    s_add_u32 m0, s54, 69120
    s_add_u32 s62, s57, 32768
    buffer_load_dwordx4 v132, s[36:39], s62 offen lds
    s_add_u32 m0, s60, 84992
    s_add_u32 s62, s59, 0
    buffer_load_dwordx4 v133, s[32:35], s62 offen lds
    s_mov_b32 m0, 93184
    s_mov_b32 s62, 131072
    s_mov_b64 exec, s[2:3]
    buffer_load_dwordx4 v133, s[32:35], s62 offen lds
    s_mov_b64 exec, -1
    s_add_u32 m0, s54, 94208
    s_add_u32 s62, s57, 262144
    buffer_load_dwordx4 v132, s[36:39], s62 offen lds
    s_add_u32 m0, s54, 95232
    s_add_u32 s62, s57, 294912
    buffer_load_dwordx4 v132, s[36:39], s62 offen lds
    s_add_u32 m0, s60, 111104
    s_add_u32 s62, s59, 64
    buffer_load_dwordx4 v133, s[32:35], s62 offen lds
    s_mov_b32 m0, 119296
    s_mov_b32 s62, 131136
    s_mov_b64 exec, s[2:3]
    buffer_load_dwordx4 v133, s[32:35], s62 offen lds
    s_mov_b64 exec, -1
    s_add_u32 m0, s54, 120320
    s_add_u32 s62, s57, 524288
    buffer_load_dwordx4 v132, s[36:39], s62 offen lds
    s_add_u32 m0, s54, 121344
    s_add_u32 s62, s57, 557056
    buffer_load_dwordx4 v132, s[36:39], s62 offen lds
    s_add_u32 m0, s60, 137216
    s_add_u32 s62, s59, 128
    buffer_load_dwordx4 v133, s[32:35], s62 offen lds
    s_mov_b32 m0, 145408
    s_mov_b32 s62, 131200
    s_mov_b64 exec, s[2:3]
    buffer_load_dwordx4 v133, s[32:35], s62 offen lds
    s_mov_b64 exec, -1
    s_waitcnt vmcnt(8)
    s_barrier
    ds_read_b128 v[96:99], v134 offset:0
    ds_read_b128 v[100:103], v134 offset:1024
    ds_read_b128 v[104:107], v135 offset:0
    ds_read_b64_tr_b16 v[172:173], v128 offset:0
    ds_read_b64_tr_b16 v[174:175], v128 offset:1024
    ds_read_b64_tr_b16 v[176:177], v128 offset:32
    ds_read_b64_tr_b16 v[178:179], v128 offset:1056
    ds_read_b64_tr_b16 v[180:181], v129 offset:0
    ds_read_b64_tr_b16 v[182:183], v129 offset:1024
    ds_read_b64_tr_b16 v[184:185], v129 offset:32
    ds_read_b64_tr_b16 v[186:187], v129 offset:1056
    ds_read_b64_tr_b16 v[188:189], v130 offset:0
    ds_read_b64_tr_b16 v[190:191], v130 offset:1024
    ds_read_b64_tr_b16 v[192:193], v130 offset:32
    ds_read_b64_tr_b16 v[194:195], v130 offset:1056
    s_waitcnt lgkmcnt(8)
    v_mfma_f32_16x16x32_bf16 v[0:3], v[172:175], v[96:99], 0
    ds_read_b64_tr_b16 v[196:197], v131 offset:0
    ds_read_b64_tr_b16 v[198:199], v131 offset:1024
    v_mfma_f32_16x16x32_bf16 v[32:35], v[172:175], v[100:103], 0
    ds_read_b64_tr_b16 v[200:201], v131 offset:32
    ds_read_b64_tr_b16 v[202:203], v131 offset:1056
    v_mfma_f32_16x16x32_bf16 v[120:123], v[172:175], v[104:107], 0
    v_mfma_f32_16x16x32_bf16 v[4:7], v[176:179], v[96:99], 0
    v_mfma_f32_16x16x32_bf16 v[36:39], v[176:179], v[100:103], 0
    v_mfma_f32_16x16x32_bf16 v[124:127], v[176:179], v[104:107], 0
    s_waitcnt lgkmcnt(8)
    v_mfma_f32_16x16x32_bf16 v[8:11], v[180:183], v[96:99], 0
    v_mfma_f32_16x16x32_bf16 v[40:43], v[180:183], v[100:103], 0
    v_mfma_f32_16x16x32_bf16 v[12:15], v[184:187], v[96:99], 0
    v_mfma_f32_16x16x32_bf16 v[44:47], v[184:187], v[100:103], 0
    s_waitcnt lgkmcnt(0)
    s_waitcnt vmcnt(4)
    s_barrier
    v_mfma_f32_16x16x32_bf16 v[16:19], v[188:191], v[96:99], 0
    ds_read_b128 v[108:111], v134 offset:26112
    ds_read_b128 v[112:115], v134 offset:27136
    v_mfma_f32_16x16x32_bf16 v[48:51], v[188:191], v[100:103], 0
    ds_read_b128 v[116:119], v135 offset:26112
    ds_read_b64_tr_b16 v[204:205], v128 offset:26112
    v_mfma_f32_16x16x32_bf16 v[20:23], v[192:195], v[96:99], 0
    ds_read_b64_tr_b16 v[206:207], v128 offset:27136
    ds_read_b64_tr_b16 v[208:209], v128 offset:26144
    v_mfma_f32_16x16x32_bf16 v[52:55], v[192:195], v[100:103], 0
    ds_read_b64_tr_b16 v[210:211], v128 offset:27168
    ds_read_b64_tr_b16 v[172:173], v129 offset:26112
    v_mfma_f32_16x16x32_bf16 v[24:27], v[196:199], v[96:99], 0
    ds_read_b64_tr_b16 v[174:175], v129 offset:27136
    ds_read_b64_tr_b16 v[176:177], v129 offset:26144
    v_mfma_f32_16x16x32_bf16 v[56:59], v[196:199], v[100:103], 0
    ds_read_b64_tr_b16 v[178:179], v129 offset:27168
    ds_read_b64_tr_b16 v[180:181], v130 offset:26112
    v_mfma_f32_16x16x32_bf16 v[28:31], v[200:203], v[96:99], 0
    ds_read_b64_tr_b16 v[182:183], v130 offset:27136
    ds_read_b64_tr_b16 v[184:185], v130 offset:26144
    v_mfma_f32_16x16x32_bf16 v[60:63], v[200:203], v[100:103], 0
    ds_read_b64_tr_b16 v[186:187], v130 offset:27168
    s_waitcnt lgkmcnt(8)
    v_mfma_f32_16x16x32_bf16 v[0:3], v[204:207], v[108:111], v[0:3]
    s_add_u32 m0, s54, 68096
    s_add_u32 s62, s57, 786432
    buffer_load_dwordx4 v132, s[36:39], s62 offen lds
    v_mfma_f32_16x16x32_bf16 v[32:35], v[204:207], v[112:115], v[32:35]
    ds_read_b64_tr_b16 v[188:189], v131 offset:26112
    ds_read_b64_tr_b16 v[190:191], v131 offset:27136
    v_mfma_f32_16x16x32_bf16 v[120:123], v[204:207], v[116:119], v[120:123]
    s_add_u32 m0, s54, 69120
    s_add_u32 s62, s57, 819200
    buffer_load_dwordx4 v132, s[36:39], s62 offen lds
    v_mfma_f32_16x16x32_bf16 v[4:7], v[208:211], v[108:111], v[4:7]
    ds_read_b64_tr_b16 v[192:193], v131 offset:26144
    ds_read_b64_tr_b16 v[194:195], v131 offset:27168
    v_mfma_f32_16x16x32_bf16 v[36:39], v[208:211], v[112:115], v[36:39]
    s_add_u32 m0, s60, 84992
    s_add_u32 s62, s59, 192
    buffer_load_dwordx4 v133, s[32:35], s62 offen lds
    v_mfma_f32_16x16x32_bf16 v[124:127], v[208:211], v[116:119], v[124:127]
    s_waitcnt lgkmcnt(8)
    v_mfma_f32_16x16x32_bf16 v[8:11], v[172:175], v[108:111], v[8:11]
    s_mov_b32 m0, 93184
    s_mov_b32 s62, 131264
    s_mov_b64 exec, s[2:3]
    buffer_load_dwordx4 v133, s[32:35], s62 offen lds
    s_mov_b64 exec, -1
    v_mfma_f32_16x16x32_bf16 v[40:43], v[172:175], v[112:115], v[40:43]
    v_mfma_f32_16x16x32_bf16 v[12:15], v[176:179], v[108:111], v[12:15]
    v_mfma_f32_16x16x32_bf16 v[44:47], v[176:179], v[112:115], v[44:47]
    s_waitcnt lgkmcnt(0)
    s_waitcnt vmcnt(4)
    s_barrier
    v_mfma_f32_16x16x32_bf16 v[16:19], v[180:183], v[108:111], v[16:19]
    ds_read_b128 v[96:99], v134 offset:52224
    ds_read_b128 v[100:103], v134 offset:53248
    v_mfma_f32_16x16x32_bf16 v[48:51], v[180:183], v[112:115], v[48:51]
    ds_read_b128 v[104:107], v135 offset:52224
    ds_read_b64_tr_b16 v[196:197], v128 offset:52224
    v_mfma_f32_16x16x32_bf16 v[20:23], v[184:187], v[108:111], v[20:23]
    ds_read_b64_tr_b16 v[198:199], v128 offset:53248
    ds_read_b64_tr_b16 v[200:201], v128 offset:52256
    v_mfma_f32_16x16x32_bf16 v[52:55], v[184:187], v[112:115], v[52:55]
    ds_read_b64_tr_b16 v[202:203], v128 offset:53280
    ds_read_b64_tr_b16 v[204:205], v129 offset:52224
    v_mfma_f32_16x16x32_bf16 v[24:27], v[188:191], v[108:111], v[24:27]
    ds_read_b64_tr_b16 v[206:207], v129 offset:53248
    ds_read_b64_tr_b16 v[208:209], v129 offset:52256
    v_mfma_f32_16x16x32_bf16 v[56:59], v[188:191], v[112:115], v[56:59]
    ds_read_b64_tr_b16 v[210:211], v129 offset:53280
    ds_read_b64_tr_b16 v[172:173], v130 offset:52224
    v_mfma_f32_16x16x32_bf16 v[28:31], v[192:195], v[108:111], v[28:31]
    ds_read_b64_tr_b16 v[174:175], v130 offset:53248
    ds_read_b64_tr_b16 v[176:177], v130 offset:52256
    v_mfma_f32_16x16x32_bf16 v[60:63], v[192:195], v[112:115], v[60:63]
    ds_read_b64_tr_b16 v[178:179], v130 offset:53280
    s_waitcnt lgkmcnt(8)
    v_mfma_f32_16x16x32_bf16 v[0:3], v[196:199], v[96:99], v[0:3]
    s_add_u32 m0, s54, 94208
    s_add_u32 s62, s57, 1048576
    buffer_load_dwordx4 v132, s[36:39], s62 offen lds
    v_mfma_f32_16x16x32_bf16 v[32:35], v[196:199], v[100:103], v[32:35]
    ds_read_b64_tr_b16 v[180:181], v131 offset:52224
    ds_read_b64_tr_b16 v[182:183], v131 offset:53248
    v_mfma_f32_16x16x32_bf16 v[120:123], v[196:199], v[104:107], v[120:123]
    s_add_u32 m0, s54, 95232
    s_add_u32 s62, s57, 1081344
    buffer_load_dwordx4 v132, s[36:39], s62 offen lds
    v_mfma_f32_16x16x32_bf16 v[4:7], v[200:203], v[96:99], v[4:7]
    ds_read_b64_tr_b16 v[184:185], v131 offset:52256
    ds_read_b64_tr_b16 v[186:187], v131 offset:53280
    v_mfma_f32_16x16x32_bf16 v[36:39], v[200:203], v[100:103], v[36:39]
    s_add_u32 m0, s60, 111104
    s_add_u32 s62, s59, 256
    buffer_load_dwordx4 v133, s[32:35], s62 offen lds
    v_mfma_f32_16x16x32_bf16 v[124:127], v[200:203], v[104:107], v[124:127]
    s_waitcnt lgkmcnt(8)
    v_mfma_f32_16x16x32_bf16 v[8:11], v[204:207], v[96:99], v[8:11]
    s_mov_b32 m0, 119296
    s_mov_b32 s62, 131328
    s_mov_b64 exec, s[2:3]
    buffer_load_dwordx4 v133, s[32:35], s62 offen lds
    s_mov_b64 exec, -1
    v_mfma_f32_16x16x32_bf16 v[40:43], v[204:207], v[100:103], v[40:43]
    v_mfma_f32_16x16x32_bf16 v[12:15], v[208:211], v[96:99], v[12:15]
    v_mfma_f32_16x16x32_bf16 v[44:47], v[208:211], v[100:103], v[44:47]
    s_waitcnt lgkmcnt(0)
    s_waitcnt vmcnt(4)
    s_barrier
    v_mfma_f32_16x16x32_bf16 v[16:19], v[172:175], v[96:99], v[16:19]
    ds_read_b128 v[108:111], v134 offset:0
    ds_read_b128 v[112:115], v134 offset:1024
    v_mfma_f32_16x16x32_bf16 v[48:51], v[172:175], v[100:103], v[48:51]
    ds_read_b128 v[116:119], v135 offset:0
    ds_read_b64_tr_b16 v[188:189], v128 offset:0
    v_mfma_f32_16x16x32_bf16 v[20:23], v[176:179], v[96:99], v[20:23]
    ds_read_b64_tr_b16 v[190:191], v128 offset:1024
    ds_read_b64_tr_b16 v[192:193], v128 offset:32
    v_mfma_f32_16x16x32_bf16 v[52:55], v[176:179], v[100:103], v[52:55]
    ds_read_b64_tr_b16 v[194:195], v128 offset:1056
    ds_read_b64_tr_b16 v[196:197], v129 offset:0
    v_mfma_f32_16x16x32_bf16 v[24:27], v[180:183], v[96:99], v[24:27]
    ds_read_b64_tr_b16 v[198:199], v129 offset:1024
    ds_read_b64_tr_b16 v[200:201], v129 offset:32
    v_mfma_f32_16x16x32_bf16 v[56:59], v[180:183], v[100:103], v[56:59]
    ds_read_b64_tr_b16 v[202:203], v129 offset:1056
    ds_read_b64_tr_b16 v[204:205], v130 offset:0
    v_mfma_f32_16x16x32_bf16 v[28:31], v[184:187], v[96:99], v[28:31]
    ds_read_b64_tr_b16 v[206:207], v130 offset:1024
    ds_read_b64_tr_b16 v[208:209], v130 offset:32
    v_mfma_f32_16x16x32_bf16 v[60:63], v[184:187], v[100:103], v[60:63]
    ds_read_b64_tr_b16 v[210:211], v130 offset:1056
    s_waitcnt lgkmcnt(8)
    v_mfma_f32_16x16x32_bf16 v[0:3], v[188:191], v[108:111], v[0:3]
    s_add_u32 m0, s54, 120320
    s_add_u32 s62, s57, 1310720
    buffer_load_dwordx4 v132, s[36:39], s62 offen lds
    v_mfma_f32_16x16x32_bf16 v[32:35], v[188:191], v[112:115], v[32:35]
    ds_read_b64_tr_b16 v[172:173], v131 offset:0
    ds_read_b64_tr_b16 v[174:175], v131 offset:1024
    v_mfma_f32_16x16x32_bf16 v[120:123], v[188:191], v[116:119], v[120:123]
    s_add_u32 m0, s54, 121344
    s_add_u32 s62, s57, 1343488
    buffer_load_dwordx4 v132, s[36:39], s62 offen lds
    v_mfma_f32_16x16x32_bf16 v[4:7], v[192:195], v[108:111], v[4:7]
    ds_read_b64_tr_b16 v[176:177], v131 offset:32
    ds_read_b64_tr_b16 v[178:179], v131 offset:1056
    v_mfma_f32_16x16x32_bf16 v[36:39], v[192:195], v[112:115], v[36:39]
    s_add_u32 m0, s60, 137216
    s_add_u32 s62, s59, 320
    buffer_load_dwordx4 v133, s[32:35], s62 offen lds
    v_mfma_f32_16x16x32_bf16 v[124:127], v[192:195], v[116:119], v[124:127]
    s_waitcnt lgkmcnt(8)
    v_mfma_f32_16x16x32_bf16 v[8:11], v[196:199], v[108:111], v[8:11]
    s_mov_b32 m0, 145408
    s_mov_b32 s62, 131392
    s_mov_b64 exec, s[2:3]
    buffer_load_dwordx4 v133, s[32:35], s62 offen lds
    s_mov_b64 exec, -1
    v_mfma_f32_16x16x32_bf16 v[40:43], v[196:199], v[112:115], v[40:43]
    v_mfma_f32_16x16x32_bf16 v[12:15], v[200:203], v[108:111], v[12:15]
    v_mfma_f32_16x16x32_bf16 v[44:47], v[200:203], v[112:115], v[44:47]
    s_waitcnt lgkmcnt(0)
    s_waitcnt vmcnt(4)
    s_barrier
    v_mfma_f32_16x16x32_bf16 v[16:19], v[204:207], v[108:111], v[16:19]
    ds_read_b128 v[96:99], v134 offset:26112
    ds_read_b128 v[100:103], v134 offset:27136
    v_mfma_f32_16x16x32_bf16 v[48:51], v[204:207], v[112:115], v[48:51]
    ds_read_b128 v[104:107], v135 offset:26112
    ds_read_b64_tr_b16 v[180:181], v128 offset:26112
    v_mfma_f32_16x16x32_bf16 v[20:23], v[208:211], v[108:111], v[20:23]
    ds_read_b64_tr_b16 v[182:183], v128 offset:27136
    ds_read_b64_tr_b16 v[184:185], v128 offset:26144
    v_mfma_f32_16x16x32_bf16 v[52:55], v[208:211], v[112:115], v[52:55]
    ds_read_b64_tr_b16 v[186:187], v128 offset:27168
    ds_read_b64_tr_b16 v[188:189], v129 offset:26112
    v_mfma_f32_16x16x32_bf16 v[24:27], v[172:175], v[108:111], v[24:27]
    ds_read_b64_tr_b16 v[190:191], v129 offset:27136
    ds_read_b64_tr_b16 v[192:193], v129 offset:26144
    v_mfma_f32_16x16x32_bf16 v[56:59], v[172:175], v[112:115], v[56:59]
    ds_read_b64_tr_b16 v[194:195], v129 offset:27168
    ds_read_b64_tr_b16 v[196:197], v130 offset:26112
    v_mfma_f32_16x16x32_bf16 v[28:31], v[176:179], v[108:111], v[28:31]
    ds_read_b64_tr_b16 v[198:199], v130 offset:27136
    ds_read_b64_tr_b16 v[200:201], v130 offset:26144
    v_mfma_f32_16x16x32_bf16 v[60:63], v[176:179], v[112:115], v[60:63]
    ds_read_b64_tr_b16 v[202:203], v130 offset:27168
    s_waitcnt lgkmcnt(8)
    v_mfma_f32_16x16x32_bf16 v[0:3], v[180:183], v[96:99], v[0:3]
    s_add_u32 m0, s54, 68096
    s_add_u32 s62, s57, 1572864
    buffer_load_dwordx4 v132, s[36:39], s62 offen lds
    v_mfma_f32_16x16x32_bf16 v[32:35], v[180:183], v[100:103], v[32:35]
    ds_read_b64_tr_b16 v[204:205], v131 offset:26112
    ds_read_b64_tr_b16 v[206:207], v131 offset:27136
    v_mfma_f32_16x16x32_bf16 v[120:123], v[180:183], v[104:107], v[120:123]
    s_add_u32 m0, s54, 69120
    s_add_u32 s62, s57, 1605632
    buffer_load_dwordx4 v132, s[36:39], s62 offen lds
    v_mfma_f32_16x16x32_bf16 v[4:7], v[184:187], v[96:99], v[4:7]
    ds_read_b64_tr_b16 v[208:209], v131 offset:26144
    ds_read_b64_tr_b16 v[210:211], v131 offset:27168
    v_mfma_f32_16x16x32_bf16 v[36:39], v[184:187], v[100:103], v[36:39]
    s_add_u32 m0, s60, 84992
    s_add_u32 s62, s59, 384
    buffer_load_dwordx4 v133, s[32:35], s62 offen lds
    v_mfma_f32_16x16x32_bf16 v[124:127], v[184:187], v[104:107], v[124:127]
    s_waitcnt lgkmcnt(8)
    v_mfma_f32_16x16x32_bf16 v[8:11], v[188:191], v[96:99], v[8:11]
    s_mov_b32 m0, 93184
    s_mov_b32 s62, 131456
    s_mov_b64 exec, s[2:3]
    buffer_load_dwordx4 v133, s[32:35], s62 offen lds
    s_mov_b64 exec, -1
    v_mfma_f32_16x16x32_bf16 v[40:43], v[188:191], v[100:103], v[40:43]
    v_mfma_f32_16x16x32_bf16 v[12:15], v[192:195], v[96:99], v[12:15]
    v_mfma_f32_16x16x32_bf16 v[44:47], v[192:195], v[100:103], v[44:47]
    s_waitcnt lgkmcnt(0)
    s_waitcnt vmcnt(4)
    s_barrier
    v_mfma_f32_16x16x32_bf16 v[16:19], v[196:199], v[96:99], v[16:19]
    ds_read_b128 v[108:111], v134 offset:52224
    ds_read_b128 v[112:115], v134 offset:53248
    v_mfma_f32_16x16x32_bf16 v[48:51], v[196:199], v[100:103], v[48:51]
    ds_read_b128 v[116:119], v135 offset:52224
    ds_read_b64_tr_b16 v[172:173], v128 offset:52224
    v_mfma_f32_16x16x32_bf16 v[20:23], v[200:203], v[96:99], v[20:23]
    ds_read_b64_tr_b16 v[174:175], v128 offset:53248
    ds_read_b64_tr_b16 v[176:177], v128 offset:52256
    v_mfma_f32_16x16x32_bf16 v[52:55], v[200:203], v[100:103], v[52:55]
    ds_read_b64_tr_b16 v[178:179], v128 offset:53280
    ds_read_b64_tr_b16 v[180:181], v129 offset:52224
    v_mfma_f32_16x16x32_bf16 v[24:27], v[204:207], v[96:99], v[24:27]
    ds_read_b64_tr_b16 v[182:183], v129 offset:53248
    ds_read_b64_tr_b16 v[184:185], v129 offset:52256
    v_mfma_f32_16x16x32_bf16 v[56:59], v[204:207], v[100:103], v[56:59]
    ds_read_b64_tr_b16 v[186:187], v129 offset:53280
    ds_read_b64_tr_b16 v[188:189], v130 offset:52224
    v_mfma_f32_16x16x32_bf16 v[28:31], v[208:211], v[96:99], v[28:31]
    ds_read_b64_tr_b16 v[190:191], v130 offset:53248
    ds_read_b64_tr_b16 v[192:193], v130 offset:52256
    v_mfma_f32_16x16x32_bf16 v[60:63], v[208:211], v[100:103], v[60:63]
    ds_read_b64_tr_b16 v[194:195], v130 offset:53280
    s_waitcnt lgkmcnt(8)
    v_mfma_f32_16x16x32_bf16 v[0:3], v[172:175], v[108:111], v[0:3]
    s_add_u32 m0, s54, 94208
    s_add_u32 s62, s57, 1835008
    buffer_load_dwordx4 v132, s[36:39], s62 offen lds
    v_mfma_f32_16x16x32_bf16 v[32:35], v[172:175], v[112:115], v[32:35]
    ds_read_b64_tr_b16 v[196:197], v131 offset:52224
    ds_read_b64_tr_b16 v[198:199], v131 offset:53248
    v_mfma_f32_16x16x32_bf16 v[120:123], v[172:175], v[116:119], v[120:123]
    s_add_u32 m0, s54, 95232
    s_add_u32 s62, s57, 1867776
    buffer_load_dwordx4 v132, s[36:39], s62 offen lds
    v_mfma_f32_16x16x32_bf16 v[4:7], v[176:179], v[108:111], v[4:7]
    ds_read_b64_tr_b16 v[200:201], v131 offset:52256
    ds_read_b64_tr_b16 v[202:203], v131 offset:53280
    v_mfma_f32_16x16x32_bf16 v[36:39], v[176:179], v[112:115], v[36:39]
    s_add_u32 m0, s60, 111104
    s_add_u32 s62, s59, 448
    buffer_load_dwordx4 v133, s[32:35], s62 offen lds
    v_mfma_f32_16x16x32_bf16 v[124:127], v[176:179], v[116:119], v[124:127]
    s_waitcnt lgkmcnt(8)
    v_mfma_f32_16x16x32_bf16 v[8:11], v[180:183], v[108:111], v[8:11]
    s_mov_b32 m0, 119296
    s_mov_b32 s62, 131520
    s_mov_b64 exec, s[2:3]
    buffer_load_dwordx4 v133, s[32:35], s62 offen lds
    s_mov_b64 exec, -1
    v_mfma_f32_16x16x32_bf16 v[40:43], v[180:183], v[112:115], v[40:43]
    v_mfma_f32_16x16x32_bf16 v[12:15], v[184:187], v[108:111], v[12:15]
    v_mfma_f32_16x16x32_bf16 v[44:47], v[184:187], v[112:115], v[44:47]
    s_waitcnt lgkmcnt(0)
    s_waitcnt vmcnt(4)
    s_barrier
    v_mfma_f32_16x16x32_bf16 v[16:19], v[188:191], v[108:111], v[16:19]
    ds_read_b128 v[96:99], v134 offset:0
    ds_read_b128 v[100:103], v134 offset:1024
    v_mfma_f32_16x16x32_bf16 v[48:51], v[188:191], v[112:115], v[48:51]
    ds_read_b128 v[104:107], v135 offset:0
    ds_read_b64_tr_b16 v[204:205], v128 offset:0
    v_mfma_f32_16x16x32_bf16 v[20:23], v[192:195], v[108:111], v[20:23]
    ds_read_b64_tr_b16 v[206:207], v128 offset:1024
    ds_read_b64_tr_b16 v[208:209], v128 offset:32
    v_mfma_f32_16x16x32_bf16 v[52:55], v[192:195], v[112:115], v[52:55]
    ds_read_b64_tr_b16 v[210:211], v128 offset:1056
    ds_read_b64_tr_b16 v[172:173], v129 offset:0
    v_mfma_f32_16x16x32_bf16 v[24:27], v[196:199], v[108:111], v[24:27]
    ds_read_b64_tr_b16 v[174:175], v129 offset:1024
    ds_read_b64_tr_b16 v[176:177], v129 offset:32
    v_mfma_f32_16x16x32_bf16 v[56:59], v[196:199], v[112:115], v[56:59]
    ds_read_b64_tr_b16 v[178:179], v129 offset:1056
    ds_read_b64_tr_b16 v[180:181], v130 offset:0
    v_mfma_f32_16x16x32_bf16 v[28:31], v[200:203], v[108:111], v[28:31]
    ds_read_b64_tr_b16 v[182:183], v130 offset:1024
    ds_read_b64_tr_b16 v[184:185], v130 offset:32
    v_mfma_f32_16x16x32_bf16 v[60:63], v[200:203], v[112:115], v[60:63]
    ds_read_b64_tr_b16 v[186:187], v130 offset:1056
    s_waitcnt lgkmcnt(8)
    v_mfma_f32_16x16x32_bf16 v[0:3], v[204:207], v[96:99], v[0:3]
    s_add_u32 m0, s54, 120320
    s_add_u32 s62, s57, 2097152
    buffer_load_dwordx4 v132, s[36:39], s62 offen lds
    v_mfma_f32_16x16x32_bf16 v[32:35], v[204:207], v[100:103], v[32:35]
    ds_read_b64_tr_b16 v[188:189], v131 offset:0
    ds_read_b64_tr_b16 v[190:191], v131 offset:1024
    v_mfma_f32_16x16x32_bf16 v[120:123], v[204:207], v[104:107], v[120:123]
    s_add_u32 m0, s54, 121344
    s_add_u32 s62, s57, 2129920
    buffer_load_dwordx4 v132, s[36:39], s62 offen lds
    v_mfma_f32_16x16x32_bf16 v[4:7], v[208:211], v[96:99], v[4:7]
    ds_read_b64_tr_b16 v[192:193], v131 offset:32
    ds_read_b64_tr_b16 v[194:195], v131 offset:1056
    v_mfma_f32_16x16x32_bf16 v[36:39], v[208:211], v[100:103], v[36:39]
    s_add_u32 m0, s60, 137216
    s_add_u32 s62, s59, 512
    buffer_load_dwordx4 v133, s[32:35], s62 offen lds
    v_mfma_f32_16x16x32_bf16 v[124:127], v[208:211], v[104:107], v[124:127]
    s_waitcnt lgkmcnt(8)
    v_mfma_f32_16x16x32_bf16 v[8:11], v[172:175], v[96:99], v[8:11]
    s_mov_b32 m0, 145408
    s_mov_b32 s62, 131584
    s_mov_b64 exec, s[2:3]
    buffer_load_dwordx4 v133, s[32:35], s62 offen lds
    s_mov_b64 exec, -1
    v_mfma_f32_16x16x32_bf16 v[40:43], v[172:175], v[100:103], v[40:43]
    v_mfma_f32_16x16x32_bf16 v[12:15], v[176:179], v[96:99], v[12:15]
    v_mfma_f32_16x16x32_bf16 v[44:47], v[176:179], v[100:103], v[44:47]
    s_waitcnt lgkmcnt(0)
    s_waitcnt vmcnt(4)
    s_barrier
    v_mfma_f32_16x16x32_bf16 v[16:19], v[180:183], v[96:99], v[16:19]
    ds_read_b128 v[108:111], v134 offset:26112
    ds_read_b128 v[112:115], v134 offset:27136
    v_mfma_f32_16x16x32_bf16 v[48:51], v[180:183], v[100:103], v[48:51]
    ds_read_b128 v[116:119], v135 offset:26112
    ds_read_b64_tr_b16 v[196:197], v128 offset:26112
    v_mfma_f32_16x16x32_bf16 v[20:23], v[184:187], v[96:99], v[20:23]
    ds_read_b64_tr_b16 v[198:199], v128 offset:27136
    ds_read_b64_tr_b16 v[200:201], v128 offset:26144
    v_mfma_f32_16x16x32_bf16 v[52:55], v[184:187], v[100:103], v[52:55]
    ds_read_b64_tr_b16 v[202:203], v128 offset:27168
    ds_read_b64_tr_b16 v[204:205], v129 offset:26112
    v_mfma_f32_16x16x32_bf16 v[24:27], v[188:191], v[96:99], v[24:27]
    ds_read_b64_tr_b16 v[206:207], v129 offset:27136
    ds_read_b64_tr_b16 v[208:209], v129 offset:26144
    v_mfma_f32_16x16x32_bf16 v[56:59], v[188:191], v[100:103], v[56:59]
    ds_read_b64_tr_b16 v[210:211], v129 offset:27168
    ds_read_b64_tr_b16 v[172:173], v130 offset:26112
    v_mfma_f32_16x16x32_bf16 v[28:31], v[192:195], v[96:99], v[28:31]
    ds_read_b64_tr_b16 v[174:175], v130 offset:27136
    ds_read_b64_tr_b16 v[176:177], v130 offset:26144
    v_mfma_f32_16x16x32_bf16 v[60:63], v[192:195], v[100:103], v[60:63]
    ds_read_b64_tr_b16 v[178:179], v130 offset:27168
    s_waitcnt lgkmcnt(8)
    v_mfma_f32_16x16x32_bf16 v[0:3], v[196:199], v[108:111], v[0:3]
    s_add_u32 m0, s54, 68096
    s_add_u32 s62, s57, 2359296
    buffer_load_dwordx4 v132, s[36:39], s62 offen lds
    v_mfma_f32_16x16x32_bf16 v[32:35], v[196:199], v[112:115], v[32:35]
    ds_read_b64_tr_b16 v[180:181], v131 offset:26112
    ds_read_b64_tr_b16 v[182:183], v131 offset:27136
    v_mfma_f32_16x16x32_bf16 v[120:123], v[196:199], v[116:119], v[120:123]
    s_add_u32 m0, s54, 69120
    s_add_u32 s62, s57, 2392064
    buffer_load_dwordx4 v132, s[36:39], s62 offen lds
    v_mfma_f32_16x16x32_bf16 v[4:7], v[200:203], v[108:111], v[4:7]
    ds_read_b64_tr_b16 v[184:185], v131 offset:26144
    ds_read_b64_tr_b16 v[186:187], v131 offset:27168
    v_mfma_f32_16x16x32_bf16 v[36:39], v[200:203], v[112:115], v[36:39]
    s_add_u32 m0, s60, 84992
    s_add_u32 s62, s59, 576
    buffer_load_dwordx4 v133, s[32:35], s62 offen lds
    v_mfma_f32_16x16x32_bf16 v[124:127], v[200:203], v[116:119], v[124:127]
    s_waitcnt lgkmcnt(8)
    v_mfma_f32_16x16x32_bf16 v[8:11], v[204:207], v[108:111], v[8:11]
    s_mov_b32 m0, 93184
    s_mov_b32 s62, 131648
    s_mov_b64 exec, s[2:3]
    buffer_load_dwordx4 v133, s[32:35], s62 offen lds
    s_mov_b64 exec, -1
    v_mfma_f32_16x16x32_bf16 v[40:43], v[204:207], v[112:115], v[40:43]
    v_mfma_f32_16x16x32_bf16 v[12:15], v[208:211], v[108:111], v[12:15]
    v_mfma_f32_16x16x32_bf16 v[44:47], v[208:211], v[112:115], v[44:47]
    s_waitcnt lgkmcnt(0)
    s_waitcnt vmcnt(4)
    s_barrier
    v_mfma_f32_16x16x32_bf16 v[16:19], v[172:175], v[108:111], v[16:19]
    ds_read_b128 v[96:99], v134 offset:52224
    ds_read_b128 v[100:103], v134 offset:53248
    v_mfma_f32_16x16x32_bf16 v[48:51], v[172:175], v[112:115], v[48:51]
    ds_read_b128 v[104:107], v135 offset:52224
    ds_read_b64_tr_b16 v[188:189], v128 offset:52224
    v_mfma_f32_16x16x32_bf16 v[20:23], v[176:179], v[108:111], v[20:23]
    ds_read_b64_tr_b16 v[190:191], v128 offset:53248
    ds_read_b64_tr_b16 v[192:193], v128 offset:52256
    v_mfma_f32_16x16x32_bf16 v[52:55], v[176:179], v[112:115], v[52:55]
    ds_read_b64_tr_b16 v[194:195], v128 offset:53280
    ds_read_b64_tr_b16 v[196:197], v129 offset:52224
    v_mfma_f32_16x16x32_bf16 v[24:27], v[180:183], v[108:111], v[24:27]
    ds_read_b64_tr_b16 v[198:199], v129 offset:53248
    ds_read_b64_tr_b16 v[200:201], v129 offset:52256
    v_mfma_f32_16x16x32_bf16 v[56:59], v[180:183], v[112:115], v[56:59]
    ds_read_b64_tr_b16 v[202:203], v129 offset:53280
    ds_read_b64_tr_b16 v[204:205], v130 offset:52224
    v_mfma_f32_16x16x32_bf16 v[28:31], v[184:187], v[108:111], v[28:31]
    ds_read_b64_tr_b16 v[206:207], v130 offset:53248
    ds_read_b64_tr_b16 v[208:209], v130 offset:52256
    v_mfma_f32_16x16x32_bf16 v[60:63], v[184:187], v[112:115], v[60:63]
    ds_read_b64_tr_b16 v[210:211], v130 offset:53280
    s_waitcnt lgkmcnt(8)
    v_mfma_f32_16x16x32_bf16 v[0:3], v[188:191], v[96:99], v[0:3]
    s_add_u32 m0, s54, 94208
    s_add_u32 s62, s57, 2621440
    buffer_load_dwordx4 v132, s[36:39], s62 offen lds
    v_mfma_f32_16x16x32_bf16 v[32:35], v[188:191], v[100:103], v[32:35]
    ds_read_b64_tr_b16 v[172:173], v131 offset:52224
    ds_read_b64_tr_b16 v[174:175], v131 offset:53248
    v_mfma_f32_16x16x32_bf16 v[120:123], v[188:191], v[104:107], v[120:123]
    s_add_u32 m0, s54, 95232
    s_add_u32 s62, s57, 2654208
    buffer_load_dwordx4 v132, s[36:39], s62 offen lds
    v_mfma_f32_16x16x32_bf16 v[4:7], v[192:195], v[96:99], v[4:7]
    ds_read_b64_tr_b16 v[176:177], v131 offset:52256
    ds_read_b64_tr_b16 v[178:179], v131 offset:53280
    v_mfma_f32_16x16x32_bf16 v[36:39], v[192:195], v[100:103], v[36:39]
    s_add_u32 m0, s60, 111104
    s_add_u32 s62, s59, 640
    buffer_load_dwordx4 v133, s[32:35], s62 offen lds
    v_mfma_f32_16x16x32_bf16 v[124:127], v[192:195], v[104:107], v[124:127]
    s_waitcnt lgkmcnt(8)
    v_mfma_f32_16x16x32_bf16 v[8:11], v[196:199], v[96:99], v[8:11]
    s_mov_b32 m0, 119296
    s_mov_b32 s62, 131712
    s_mov_b64 exec, s[2:3]
    buffer_load_dwordx4 v133, s[32:35], s62 offen lds
    s_mov_b64 exec, -1
    v_mfma_f32_16x16x32_bf16 v[40:43], v[196:199], v[100:103], v[40:43]
    v_mfma_f32_16x16x32_bf16 v[12:15], v[200:203], v[96:99], v[12:15]
    v_mfma_f32_16x16x32_bf16 v[44:47], v[200:203], v[100:103], v[44:47]
    s_waitcnt lgkmcnt(0)
    s_waitcnt vmcnt(4)
    s_barrier
    v_mfma_f32_16x16x32_bf16 v[16:19], v[204:207], v[96:99], v[16:19]
    ds_read_b128 v[108:111], v134 offset:0
    ds_read_b128 v[112:115], v134 offset:1024
    v_mfma_f32_16x16x32_bf16 v[48:51], v[204:207], v[100:103], v[48:51]
    ds_read_b128 v[116:119], v135 offset:0
    ds_read_b64_tr_b16 v[180:181], v128 offset:0
    v_mfma_f32_16x16x32_bf16 v[20:23], v[208:211], v[96:99], v[20:23]
    ds_read_b64_tr_b16 v[182:183], v128 offset:1024
    ds_read_b64_tr_b16 v[184:185], v128 offset:32
    v_mfma_f32_16x16x32_bf16 v[52:55], v[208:211], v[100:103], v[52:55]
    ds_read_b64_tr_b16 v[186:187], v128 offset:1056
    ds_read_b64_tr_b16 v[188:189], v129 offset:0
    v_mfma_f32_16x16x32_bf16 v[24:27], v[172:175], v[96:99], v[24:27]
    ds_read_b64_tr_b16 v[190:191], v129 offset:1024
    ds_read_b64_tr_b16 v[192:193], v129 offset:32
    v_mfma_f32_16x16x32_bf16 v[56:59], v[172:175], v[100:103], v[56:59]
    ds_read_b64_tr_b16 v[194:195], v129 offset:1056
    ds_read_b64_tr_b16 v[196:197], v130 offset:0
    v_mfma_f32_16x16x32_bf16 v[28:31], v[176:179], v[96:99], v[28:31]
    ds_read_b64_tr_b16 v[198:199], v130 offset:1024
    ds_read_b64_tr_b16 v[200:201], v130 offset:32
    v_mfma_f32_16x16x32_bf16 v[60:63], v[176:179], v[100:103], v[60:63]
    ds_read_b64_tr_b16 v[202:203], v130 offset:1056
    s_waitcnt lgkmcnt(8)
    v_mfma_f32_16x16x32_bf16 v[0:3], v[180:183], v[108:111], v[0:3]
    s_add_u32 m0, s54, 120320
    s_add_u32 s62, s57, 2883584
    buffer_load_dwordx4 v132, s[36:39], s62 offen lds
    v_mfma_f32_16x16x32_bf16 v[32:35], v[180:183], v[112:115], v[32:35]
    ds_read_b64_tr_b16 v[204:205], v131 offset:0
    ds_read_b64_tr_b16 v[206:207], v131 offset:1024
    v_mfma_f32_16x16x32_bf16 v[120:123], v[180:183], v[116:119], v[120:123]
    s_add_u32 m0, s54, 121344
    s_add_u32 s62, s57, 2916352
    buffer_load_dwordx4 v132, s[36:39], s62 offen lds
    v_mfma_f32_16x16x32_bf16 v[4:7], v[184:187], v[108:111], v[4:7]
    ds_read_b64_tr_b16 v[208:209], v131 offset:32
    ds_read_b64_tr_b16 v[210:211], v131 offset:1056
    v_mfma_f32_16x16x32_bf16 v[36:39], v[184:187], v[112:115], v[36:39]
    s_add_u32 m0, s60, 137216
    s_add_u32 s62, s59, 704
    buffer_load_dwordx4 v133, s[32:35], s62 offen lds
    v_mfma_f32_16x16x32_bf16 v[124:127], v[184:187], v[116:119], v[124:127]
    s_waitcnt lgkmcnt(8)
    v_mfma_f32_16x16x32_bf16 v[8:11], v[188:191], v[108:111], v[8:11]
    s_mov_b32 m0, 145408
    s_mov_b32 s62, 131776
    s_mov_b64 exec, s[2:3]
    buffer_load_dwordx4 v133, s[32:35], s62 offen lds
    s_mov_b64 exec, -1
    v_mfma_f32_16x16x32_bf16 v[40:43], v[188:191], v[112:115], v[40:43]
    v_mfma_f32_16x16x32_bf16 v[12:15], v[192:195], v[108:111], v[12:15]
    v_mfma_f32_16x16x32_bf16 v[44:47], v[192:195], v[112:115], v[44:47]
    s_waitcnt lgkmcnt(0)
    s_waitcnt vmcnt(4)
    s_barrier
    v_mfma_f32_16x16x32_bf16 v[16:19], v[196:199], v[108:111], v[16:19]
    ds_read_b128 v[96:99], v134 offset:26112
    ds_read_b128 v[100:103], v134 offset:27136
    v_mfma_f32_16x16x32_bf16 v[48:51], v[196:199], v[112:115], v[48:51]
    ds_read_b128 v[104:107], v135 offset:26112
    ds_read_b64_tr_b16 v[172:173], v128 offset:26112
    v_mfma_f32_16x16x32_bf16 v[20:23], v[200:203], v[108:111], v[20:23]
    ds_read_b64_tr_b16 v[174:175], v128 offset:27136
    ds_read_b64_tr_b16 v[176:177], v128 offset:26144
    v_mfma_f32_16x16x32_bf16 v[52:55], v[200:203], v[112:115], v[52:55]
    ds_read_b64_tr_b16 v[178:179], v128 offset:27168
    ds_read_b64_tr_b16 v[180:181], v129 offset:26112
    v_mfma_f32_16x16x32_bf16 v[24:27], v[204:207], v[108:111], v[24:27]
    ds_read_b64_tr_b16 v[182:183], v129 offset:27136
    ds_read_b64_tr_b16 v[184:185], v129 offset:26144
    v_mfma_f32_16x16x32_bf16 v[56:59], v[204:207], v[112:115], v[56:59]
    ds_read_b64_tr_b16 v[186:187], v129 offset:27168
    ds_read_b64_tr_b16 v[188:189], v130 offset:26112
    v_mfma_f32_16x16x32_bf16 v[28:31], v[208:211], v[108:111], v[28:31]
    ds_read_b64_tr_b16 v[190:191], v130 offset:27136
    ds_read_b64_tr_b16 v[192:193], v130 offset:26144
    v_mfma_f32_16x16x32_bf16 v[60:63], v[208:211], v[112:115], v[60:63]
    ds_read_b64_tr_b16 v[194:195], v130 offset:27168
    s_waitcnt lgkmcnt(8)
    v_mfma_f32_16x16x32_bf16 v[0:3], v[172:175], v[96:99], v[0:3]
    s_add_u32 m0, s54, 68096
    s_add_u32 s62, s57, 3145728
    buffer_load_dwordx4 v132, s[36:39], s62 offen lds
    v_mfma_f32_16x16x32_bf16 v[32:35], v[172:175], v[100:103], v[32:35]
    ds_read_b64_tr_b16 v[196:197], v131 offset:26112
    ds_read_b64_tr_b16 v[198:199], v131 offset:27136
    v_mfma_f32_16x16x32_bf16 v[120:123], v[172:175], v[104:107], v[120:123]
    s_add_u32 m0, s54, 69120
    s_add_u32 s62, s57, 3178496
    buffer_load_dwordx4 v132, s[36:39], s62 offen lds
    v_mfma_f32_16x16x32_bf16 v[4:7], v[176:179], v[96:99], v[4:7]
    ds_read_b64_tr_b16 v[200:201], v131 offset:26144
    ds_read_b64_tr_b16 v[202:203], v131 offset:27168
    v_mfma_f32_16x16x32_bf16 v[36:39], v[176:179], v[100:103], v[36:39]
    s_add_u32 m0, s60, 84992
    s_add_u32 s62, s59, 768
    buffer_load_dwordx4 v133, s[32:35], s62 offen lds
    v_mfma_f32_16x16x32_bf16 v[124:127], v[176:179], v[104:107], v[124:127]
    s_waitcnt lgkmcnt(8)
    v_mfma_f32_16x16x32_bf16 v[8:11], v[180:183], v[96:99], v[8:11]
    s_mov_b32 m0, 93184
    s_mov_b32 s62, 131840
    s_mov_b64 exec, s[2:3]
    buffer_load_dwordx4 v133, s[32:35], s62 offen lds
    s_mov_b64 exec, -1
    v_mfma_f32_16x16x32_bf16 v[40:43], v[180:183], v[100:103], v[40:43]
    v_mfma_f32_16x16x32_bf16 v[12:15], v[184:187], v[96:99], v[12:15]
    v_mfma_f32_16x16x32_bf16 v[44:47], v[184:187], v[100:103], v[44:47]
    s_waitcnt lgkmcnt(0)
    s_waitcnt vmcnt(4)
    s_barrier
    v_mfma_f32_16x16x32_bf16 v[16:19], v[188:191], v[96:99], v[16:19]
    ds_read_b128 v[108:111], v134 offset:52224
    ds_read_b128 v[112:115], v134 offset:53248
    v_mfma_f32_16x16x32_bf16 v[48:51], v[188:191], v[100:103], v[48:51]
    ds_read_b128 v[116:119], v135 offset:52224
    ds_read_b64_tr_b16 v[204:205], v128 offset:52224
    v_mfma_f32_16x16x32_bf16 v[20:23], v[192:195], v[96:99], v[20:23]
    ds_read_b64_tr_b16 v[206:207], v128 offset:53248
    ds_read_b64_tr_b16 v[208:209], v128 offset:52256
    v_mfma_f32_16x16x32_bf16 v[52:55], v[192:195], v[100:103], v[52:55]
    ds_read_b64_tr_b16 v[210:211], v128 offset:53280
    ds_read_b64_tr_b16 v[172:173], v129 offset:52224
    v_mfma_f32_16x16x32_bf16 v[24:27], v[196:199], v[96:99], v[24:27]
    ds_read_b64_tr_b16 v[174:175], v129 offset:53248
    ds_read_b64_tr_b16 v[176:177], v129 offset:52256
    v_mfma_f32_16x16x32_bf16 v[56:59], v[196:199], v[100:103], v[56:59]
    ds_read_b64_tr_b16 v[178:179], v129 offset:53280
    ds_read_b64_tr_b16 v[180:181], v130 offset:52224
    v_mfma_f32_16x16x32_bf16 v[28:31], v[200:203], v[96:99], v[28:31]
    ds_read_b64_tr_b16 v[182:183], v130 offset:53248
    ds_read_b64_tr_b16 v[184:185], v130 offset:52256
    v_mfma_f32_16x16x32_bf16 v[60:63], v[200:203], v[100:103], v[60:63]
    ds_read_b64_tr_b16 v[186:187], v130 offset:53280
    s_waitcnt lgkmcnt(8)
    v_mfma_f32_16x16x32_bf16 v[0:3], v[204:207], v[108:111], v[0:3]
    s_add_u32 m0, s54, 94208
    s_add_u32 s62, s57, 3407872
    buffer_load_dwordx4 v132, s[36:39], s62 offen lds
    v_mfma_f32_16x16x32_bf16 v[32:35], v[204:207], v[112:115], v[32:35]
    ds_read_b64_tr_b16 v[188:189], v131 offset:52224
    ds_read_b64_tr_b16 v[190:191], v131 offset:53248
    v_mfma_f32_16x16x32_bf16 v[120:123], v[204:207], v[116:119], v[120:123]
    s_add_u32 m0, s54, 95232
    s_add_u32 s62, s57, 3440640
    buffer_load_dwordx4 v132, s[36:39], s62 offen lds
    v_mfma_f32_16x16x32_bf16 v[4:7], v[208:211], v[108:111], v[4:7]
    ds_read_b64_tr_b16 v[192:193], v131 offset:52256
    ds_read_b64_tr_b16 v[194:195], v131 offset:53280
    v_mfma_f32_16x16x32_bf16 v[36:39], v[208:211], v[112:115], v[36:39]
    s_add_u32 m0, s60, 111104
    s_add_u32 s62, s59, 832
    buffer_load_dwordx4 v133, s[32:35], s62 offen lds
    v_mfma_f32_16x16x32_bf16 v[124:127], v[208:211], v[116:119], v[124:127]
    s_waitcnt lgkmcnt(8)
    v_mfma_f32_16x16x32_bf16 v[8:11], v[172:175], v[108:111], v[8:11]
    s_mov_b32 m0, 119296
    s_mov_b32 s62, 131904
    s_mov_b64 exec, s[2:3]
    buffer_load_dwordx4 v133, s[32:35], s62 offen lds
    s_mov_b64 exec, -1
    v_mfma_f32_16x16x32_bf16 v[40:43], v[172:175], v[112:115], v[40:43]
    v_mfma_f32_16x16x32_bf16 v[12:15], v[176:179], v[108:111], v[12:15]
    s_add_u32 m0, s14, 0
    s_mov_b32 s73, s55
    buffer_load_dwordx4 v248, s[40:43], s73 offen nt lds
    v_mfma_f32_16x16x32_bf16 v[44:47], v[176:179], v[112:115], v[44:47]
    s_add_u32 m0, s14, 32
    s_add_u32 s55, s55, 8192
    buffer_load_dwordx4 v248, s[40:43], s73 offen offset:1024 nt lds
    s_add_u32 s14, s14, 33792
    s_cmp_ge_u32 s14, 135680
    s_cselect_b32 s73, 135168, 0
    s_sub_u32 s14, s14, s73
    s_waitcnt lgkmcnt(0)
    s_waitcnt vmcnt(6)
    s_barrier
    v_mfma_f32_16x16x32_bf16 v[16:19], v[180:183], v[108:111], v[16:19]
    ds_read_b128 v[96:99], v134 offset:0
    ds_read_b128 v[100:103], v134 offset:1024
    v_mfma_f32_16x16x32_bf16 v[48:51], v[180:183], v[112:115], v[48:51]
    ds_read_b128 v[104:107], v135 offset:0
    ds_read_b64_tr_b16 v[196:197], v128 offset:0
    v_mfma_f32_16x16x32_bf16 v[20:23], v[184:187], v[108:111], v[20:23]
    ds_read_b64_tr_b16 v[198:199], v128 offset:1024
    ds_read_b64_tr_b16 v[200:201], v128 offset:32
    v_mfma_f32_16x16x32_bf16 v[52:55], v[184:187], v[112:115], v[52:55]
    ds_read_b64_tr_b16 v[202:203], v128 offset:1056
    ds_read_b64_tr_b16 v[204:205], v129 offset:0
    v_mfma_f32_16x16x32_bf16 v[24:27], v[188:191], v[108:111], v[24:27]
    ds_read_b64_tr_b16 v[206:207], v129 offset:1024
    ds_read_b64_tr_b16 v[208:209], v129 offset:32
    v_mfma_f32_16x16x32_bf16 v[56:59], v[188:191], v[112:115], v[56:59]
    ds_read_b64_tr_b16 v[210:211], v129 offset:1056
    ds_read_b64_tr_b16 v[172:173], v130 offset:0
    v_mfma_f32_16x16x32_bf16 v[28:31], v[192:195], v[108:111], v[28:31]
    ds_read_b64_tr_b16 v[174:175], v130 offset:1024
    ds_read_b64_tr_b16 v[176:177], v130 offset:32
    v_mfma_f32_16x16x32_bf16 v[60:63], v[192:195], v[112:115], v[60:63]
    ds_read_b64_tr_b16 v[178:179], v130 offset:1056
    s_waitcnt lgkmcnt(8)
    v_mfma_f32_16x16x32_bf16 v[0:3], v[196:199], v[96:99], v[0:3]
    s_add_u32 m0, s54, 120320
    s_add_u32 s62, s57, 3670016
    buffer_load_dwordx4 v132, s[36:39], s62 offen lds
    v_mfma_f32_16x16x32_bf16 v[32:35], v[196:199], v[100:103], v[32:35]
    ds_read_b64_tr_b16 v[180:181], v131 offset:0
    ds_read_b64_tr_b16 v[182:183], v131 offset:1024
    v_mfma_f32_16x16x32_bf16 v[120:123], v[196:199], v[104:107], v[120:123]
    s_add_u32 m0, s54, 121344
    s_add_u32 s62, s57, 3702784
    buffer_load_dwordx4 v132, s[36:39], s62 offen lds
    v_mfma_f32_16x16x32_bf16 v[4:7], v[200:203], v[96:99], v[4:7]
    ds_read_b64_tr_b16 v[184:185], v131 offset:32
    ds_read_b64_tr_b16 v[186:187], v131 offset:1056
    v_mfma_f32_16x16x32_bf16 v[36:39], v[200:203], v[100:103], v[36:39]
    s_add_u32 m0, s60, 137216
    s_add_u32 s62, s59, 896
    buffer_load_dwordx4 v133, s[32:35], s62 offen lds
    v_mfma_f32_16x16x32_bf16 v[124:127], v[200:203], v[104:107], v[124:127]
    s_waitcnt lgkmcnt(8)
    v_mfma_f32_16x16x32_bf16 v[8:11], v[204:207], v[96:99], v[8:11]
    s_mov_b32 m0, 145408
    s_mov_b32 s62, 131968
    s_mov_b64 exec, s[2:3]
    buffer_load_dwordx4 v133, s[32:35], s62 offen lds
    s_mov_b64 exec, -1
    v_mfma_f32_16x16x32_bf16 v[40:43], v[204:207], v[100:103], v[40:43]
    v_mfma_f32_16x16x32_bf16 v[12:15], v[208:211], v[96:99], v[12:15]
    v_mfma_f32_16x16x32_bf16 v[44:47], v[208:211], v[100:103], v[44:47]
    s_waitcnt lgkmcnt(0)
    s_waitcnt vmcnt(6)
    s_barrier
    v_mfma_f32_16x16x32_bf16 v[16:19], v[172:175], v[96:99], v[16:19]
    ds_read_b128 v[108:111], v134 offset:26112
    ds_read_b128 v[112:115], v134 offset:27136
    v_mfma_f32_16x16x32_bf16 v[48:51], v[172:175], v[100:103], v[48:51]
    ds_read_b128 v[116:119], v135 offset:26112
    ds_read_b64_tr_b16 v[188:189], v128 offset:26112
    v_mfma_f32_16x16x32_bf16 v[20:23], v[176:179], v[96:99], v[20:23]
    ds_read_b64_tr_b16 v[190:191], v128 offset:27136
    ds_read_b64_tr_b16 v[192:193], v128 offset:26144
    v_mfma_f32_16x16x32_bf16 v[52:55], v[176:179], v[100:103], v[52:55]
    ds_read_b64_tr_b16 v[194:195], v128 offset:27168
    ds_read_b64_tr_b16 v[196:197], v129 offset:26112
    v_mfma_f32_16x16x32_bf16 v[24:27], v[180:183], v[96:99], v[24:27]
    ds_read_b64_tr_b16 v[198:199], v129 offset:27136
    ds_read_b64_tr_b16 v[200:201], v129 offset:26144
    v_mfma_f32_16x16x32_bf16 v[56:59], v[180:183], v[100:103], v[56:59]
    ds_read_b64_tr_b16 v[202:203], v129 offset:27168
    ds_read_b64_tr_b16 v[204:205], v130 offset:26112
    v_mfma_f32_16x16x32_bf16 v[28:31], v[184:187], v[96:99], v[28:31]
    ds_read_b64_tr_b16 v[206:207], v130 offset:27136
    ds_read_b64_tr_b16 v[208:209], v130 offset:26144
    v_mfma_f32_16x16x32_bf16 v[60:63], v[184:187], v[100:103], v[60:63]
    ds_read_b64_tr_b16 v[210:211], v130 offset:27168
    s_waitcnt lgkmcnt(8)
    v_mfma_f32_16x16x32_bf16 v[0:3], v[188:191], v[108:111], v[0:3]
    s_add_u32 m0, s54, 68096
    s_add_u32 s62, s57, 3932160
    buffer_load_dwordx4 v132, s[36:39], s62 offen lds
    v_mfma_f32_16x16x32_bf16 v[32:35], v[188:191], v[112:115], v[32:35]
    ds_read_b64_tr_b16 v[172:173], v131 offset:26112
    ds_read_b64_tr_b16 v[174:175], v131 offset:27136
    v_mfma_f32_16x16x32_bf16 v[120:123], v[188:191], v[116:119], v[120:123]
    s_add_u32 m0, s54, 69120
    s_add_u32 s62, s57, 3964928
    buffer_load_dwordx4 v132, s[36:39], s62 offen lds
    v_mfma_f32_16x16x32_bf16 v[4:7], v[192:195], v[108:111], v[4:7]
    ds_read_b64_tr_b16 v[176:177], v131 offset:26144
    ds_read_b64_tr_b16 v[178:179], v131 offset:27168
    v_mfma_f32_16x16x32_bf16 v[36:39], v[192:195], v[112:115], v[36:39]
    s_add_u32 m0, s60, 84992
    s_add_u32 s62, s59, 960
    buffer_load_dwordx4 v133, s[32:35], s62 offen lds
    v_mfma_f32_16x16x32_bf16 v[124:127], v[192:195], v[116:119], v[124:127]
    s_waitcnt lgkmcnt(8)
    v_mfma_f32_16x16x32_bf16 v[8:11], v[196:199], v[108:111], v[8:11]
    s_mov_b32 m0, 93184
    s_mov_b32 s62, 132032
    s_mov_b64 exec, s[2:3]
    buffer_load_dwordx4 v133, s[32:35], s62 offen lds
    s_mov_b64 exec, -1
    v_mfma_f32_16x16x32_bf16 v[40:43], v[196:199], v[112:115], v[40:43]
    v_mfma_f32_16x16x32_bf16 v[12:15], v[200:203], v[108:111], v[12:15]
    v_mfma_f32_16x16x32_bf16 v[44:47], v[200:203], v[112:115], v[44:47]
    s_waitcnt lgkmcnt(0)
    s_waitcnt vmcnt(4)
    s_barrier
    v_mfma_f32_16x16x32_bf16 v[16:19], v[204:207], v[108:111], v[16:19]
    ds_read_b128 v[96:99], v134 offset:52224
    ds_read_b128 v[100:103], v134 offset:53248
    v_mfma_f32_16x16x32_bf16 v[48:51], v[204:207], v[112:115], v[48:51]
    ds_read_b128 v[104:107], v135 offset:52224
    ds_read_b64_tr_b16 v[180:181], v128 offset:52224
    v_mfma_f32_16x16x32_bf16 v[20:23], v[208:211], v[108:111], v[20:23]
    ds_read_b64_tr_b16 v[182:183], v128 offset:53248
    ds_read_b64_tr_b16 v[184:185], v128 offset:52256
    v_mfma_f32_16x16x32_bf16 v[52:55], v[208:211], v[112:115], v[52:55]
    ds_read_b64_tr_b16 v[186:187], v128 offset:53280
    ds_read_b64_tr_b16 v[188:189], v129 offset:52224
    v_mfma_f32_16x16x32_bf16 v[24:27], v[172:175], v[108:111], v[24:27]
    ds_read_b64_tr_b16 v[190:191], v129 offset:53248
    ds_read_b64_tr_b16 v[192:193], v129 offset:52256
    v_mfma_f32_16x16x32_bf16 v[56:59], v[172:175], v[112:115], v[56:59]
    ds_read_b64_tr_b16 v[194:195], v129 offset:53280
    ds_read_b64_tr_b16 v[196:197], v130 offset:52224
    v_mfma_f32_16x16x32_bf16 v[28:31], v[176:179], v[108:111], v[28:31]
    ds_read_b64_tr_b16 v[198:199], v130 offset:53248
    ds_read_b64_tr_b16 v[200:201], v130 offset:52256
    v_mfma_f32_16x16x32_bf16 v[60:63], v[176:179], v[112:115], v[60:63]
    ds_read_b64_tr_b16 v[202:203], v130 offset:53280
    s_waitcnt lgkmcnt(8)
    v_mfma_f32_16x16x32_bf16 v[0:3], v[180:183], v[96:99], v[0:3]
    s_add_u32 m0, s14, 0
    s_mov_b32 s73, s55
    buffer_load_dwordx4 v248, s[40:43], s73 offen nt lds
    v_mfma_f32_16x16x32_bf16 v[32:35], v[180:183], v[100:103], v[32:35]
    ds_read_b64_tr_b16 v[204:205], v131 offset:52224
    ds_read_b64_tr_b16 v[206:207], v131 offset:53248
    v_mfma_f32_16x16x32_bf16 v[120:123], v[180:183], v[104:107], v[120:123]
    s_add_u32 m0, s14, 32
    s_add_u32 s55, s55, 8192
    buffer_load_dwordx4 v248, s[40:43], s73 offen offset:1024 nt lds
    v_mfma_f32_16x16x32_bf16 v[4:7], v[184:187], v[96:99], v[4:7]
    ds_read_b64_tr_b16 v[208:209], v131 offset:52256
    ds_read_b64_tr_b16 v[210:211], v131 offset:53280
    v_mfma_f32_16x16x32_bf16 v[36:39], v[184:187], v[100:103], v[36:39]
    s_add_u32 m0, s14, 8448
    s_mov_b32 s73, s56
    buffer_load_dwordx4 v248, s[44:47], s73 offen nt lds
    v_mfma_f32_16x16x32_bf16 v[124:127], v[184:187], v[104:107], v[124:127]
    s_waitcnt lgkmcnt(8)
    v_mfma_f32_16x16x32_bf16 v[8:11], v[188:191], v[96:99], v[8:11]
    s_add_u32 m0, s14, 8480
    s_add_u32 s56, s56, 8192
    buffer_load_dwordx4 v248, s[44:47], s73 offen offset:1024 nt lds
    s_add_u32 s14, s14, 33792
    s_cmp_ge_u32 s14, 135680
    s_cselect_b32 s73, 135168, 0
    s_sub_u32 s14, s14, s73
    v_mfma_f32_16x16x32_bf16 v[40:43], v[188:191], v[100:103], v[40:43]
    v_mfma_f32_16x16x32_bf16 v[12:15], v[192:195], v[96:99], v[12:15]
    v_mfma_f32_16x16x32_bf16 v[44:47], v[192:195], v[100:103], v[44:47]
    s_waitcnt lgkmcnt(0)
    s_waitcnt vmcnt(4)
    s_barrier
    v_mfma_f32_16x16x32_bf16 v[16:19], v[196:199], v[96:99], v[16:19]
    ds_read_b128 v[108:111], v134 offset:0
    ds_read_b128 v[112:115], v134 offset:1024
    v_mfma_f32_16x16x32_bf16 v[48:51], v[196:199], v[100:103], v[48:51]
    ds_read_b128 v[116:119], v135 offset:0
    ds_read_b64_tr_b16 v[172:173], v128 offset:0
    v_mfma_f32_16x16x32_bf16 v[20:23], v[200:203], v[96:99], v[20:23]
    ds_read_b64_tr_b16 v[174:175], v128 offset:1024
    ds_read_b64_tr_b16 v[176:177], v128 offset:32
    v_mfma_f32_16x16x32_bf16 v[52:55], v[200:203], v[100:103], v[52:55]
    ds_read_b64_tr_b16 v[178:179], v128 offset:1056
    ds_read_b64_tr_b16 v[180:181], v129 offset:0
    v_mfma_f32_16x16x32_bf16 v[24:27], v[204:207], v[96:99], v[24:27]
    ds_read_b64_tr_b16 v[182:183], v129 offset:1024
    ds_read_b64_tr_b16 v[184:185], v129 offset:32
    v_mfma_f32_16x16x32_bf16 v[56:59], v[204:207], v[100:103], v[56:59]
    ds_read_b64_tr_b16 v[186:187], v129 offset:1056
    ds_read_b64_tr_b16 v[188:189], v130 offset:0
    v_mfma_f32_16x16x32_bf16 v[28:31], v[208:211], v[96:99], v[28:31]
    ds_read_b64_tr_b16 v[190:191], v130 offset:1024
    ds_read_b64_tr_b16 v[192:193], v130 offset:32
    v_mfma_f32_16x16x32_bf16 v[60:63], v[208:211], v[100:103], v[60:63]
    ds_read_b64_tr_b16 v[194:195], v130 offset:1056
    s_waitcnt lgkmcnt(8)
    v_mfma_f32_16x16x32_bf16 v[0:3], v[172:175], v[108:111], v[0:3]
    ds_read_b64_tr_b16 v[196:197], v131 offset:0
    ds_read_b64_tr_b16 v[198:199], v131 offset:1024
    v_mfma_f32_16x16x32_bf16 v[32:35], v[172:175], v[112:115], v[32:35]
    ds_read_b64_tr_b16 v[200:201], v131 offset:32
    ds_read_b64_tr_b16 v[202:203], v131 offset:1056
    v_mfma_f32_16x16x32_bf16 v[120:123], v[172:175], v[116:119], v[120:123]
    v_mfma_f32_16x16x32_bf16 v[4:7], v[176:179], v[108:111], v[4:7]
    v_mfma_f32_16x16x32_bf16 v[36:39], v[176:179], v[112:115], v[36:39]
    v_mfma_f32_16x16x32_bf16 v[124:127], v[176:179], v[116:119], v[124:127]
    s_waitcnt lgkmcnt(8)
    v_mfma_f32_16x16x32_bf16 v[8:11], v[180:183], v[108:111], v[8:11]
    v_mfma_f32_16x16x32_bf16 v[40:43], v[180:183], v[112:115], v[40:43]
    v_mfma_f32_16x16x32_bf16 v[12:15], v[184:187], v[108:111], v[12:15]
    v_mfma_f32_16x16x32_bf16 v[44:47], v[184:187], v[112:115], v[44:47]
    s_waitcnt lgkmcnt(0)
    s_barrier
    v_mfma_f32_16x16x32_bf16 v[16:19], v[188:191], v[108:111], v[16:19]
    v_mfma_f32_16x16x32_bf16 v[48:51], v[188:191], v[112:115], v[48:51]
    v_mfma_f32_16x16x32_bf16 v[20:23], v[192:195], v[108:111], v[20:23]
    v_mfma_f32_16x16x32_bf16 v[52:55], v[192:195], v[112:115], v[52:55]
    v_mfma_f32_16x16x32_bf16 v[24:27], v[196:199], v[108:111], v[24:27]
    v_mfma_f32_16x16x32_bf16 v[56:59], v[196:199], v[112:115], v[56:59]
    v_mfma_f32_16x16x32_bf16 v[28:31], v[200:203], v[108:111], v[28:31]
    v_mfma_f32_16x16x32_bf16 v[60:63], v[200:203], v[112:115], v[60:63]
    s_lshl_b32 s62, s77, 2
    s_add_u32 s62, s62, s52
    s_lshl_b32 s62, s62, 10
    s_add_u32 s62, s62, 147456
    v_add_u32 v172, s62, v255
    v_mul_f32 v120, s69, v120
    v_mul_f32 v121, s69, v121
    v_mul_f32 v122, s69, v122
    v_mul_f32 v123, s69, v123
    v_mul_f32 v124, s69, v124
    v_mul_f32 v125, s69, v125
    v_mul_f32 v126, s69, v126
    v_mul_f32 v127, s69, v127
    v_cvt_pk_bf16_f32 v128, v120, v121
    v_cvt_pk_bf16_f32 v130, v124, v125
    v_cvt_pk_bf16_f32 v129, v122, v123
    v_cvt_pk_bf16_f32 v131, v126, v127
    s_add_u32 m0, s14, 0
    s_mov_b32 s73, s55
    buffer_load_dwordx4 v248, s[40:43], s73 offen nt lds
    v_mul_f32 v0, s69, v0
    v_mul_f32 v1, s69, v1
    v_mul_f32 v2, s69, v2
    v_mul_f32 v3, s69, v3
    v_mul_f32 v4, s69, v4
    v_mul_f32 v5, s69, v5
    v_mul_f32 v6, s69, v6
    v_mul_f32 v7, s69, v7
    v_cvt_pk_bf16_f32 v96, v0, v1
    v_cvt_pk_bf16_f32 v98, v4, v5
    v_cvt_pk_bf16_f32 v97, v2, v3
    v_cvt_pk_bf16_f32 v99, v6, v7
    v_permlane32_swap_b32 v128, v130
    v_permlane32_swap_b32 v129, v131
    s_add_u32 m0, s14, 32
    s_add_u32 s55, s55, 8192
    buffer_load_dwordx4 v248, s[40:43], s73 offen offset:1024 nt lds
    v_mul_f32 v8, s69, v8
    v_mul_f32 v9, s69, v9
    v_mul_f32 v10, s69, v10
    v_mul_f32 v11, s69, v11
    v_mul_f32 v12, s69, v12
    v_mul_f32 v13, s69, v13
    v_mul_f32 v14, s69, v14
    v_mul_f32 v15, s69, v15
    v_cvt_pk_bf16_f32 v100, v8, v9
    v_cvt_pk_bf16_f32 v102, v12, v13
    v_cvt_pk_bf16_f32 v101, v10, v11
    v_cvt_pk_bf16_f32 v103, v14, v15
    v_permlane32_swap_b32 v96, v98
    v_permlane32_swap_b32 v97, v99
    v_permlane16_swap_b32 v128, v130
    v_permlane16_swap_b32 v129, v131
    s_add_u32 m0, s14, 8448
    s_mov_b32 s73, s56
    buffer_load_dwordx4 v248, s[44:47], s73 offen nt lds
    ds_write_b128 v172, v[128:131]
    v_mul_f32 v16, s69, v16
    v_mul_f32 v17, s69, v17
    v_mul_f32 v18, s69, v18
    v_mul_f32 v19, s69, v19
    v_mul_f32 v20, s69, v20
    v_mul_f32 v21, s69, v21
    v_mul_f32 v22, s69, v22
    v_mul_f32 v23, s69, v23
    v_cvt_pk_bf16_f32 v104, v16, v17
    v_cvt_pk_bf16_f32 v106, v20, v21
    v_cvt_pk_bf16_f32 v105, v18, v19
    v_cvt_pk_bf16_f32 v107, v22, v23
    v_permlane32_swap_b32 v100, v102
    v_permlane32_swap_b32 v101, v103
    v_permlane16_swap_b32 v96, v98
    v_permlane16_swap_b32 v97, v99
    s_add_u32 m0, s14, 8480
    s_add_u32 s56, s56, 8192
    buffer_load_dwordx4 v248, s[44:47], s73 offen offset:1024 nt lds
    s_add_u32 s14, s14, 33792
    s_cmp_ge_u32 s14, 135680
    s_cselect_b32 s73, 135168, 0
    s_sub_u32 s14, s14, s73
    v_mul_f32 v24, s69, v24
    v_mul_f32 v25, s69, v25
    v_mul_f32 v26, s69, v26
    v_mul_f32 v27, s69, v27
    v_mul_f32 v28, s69, v28
    v_mul_f32 v29, s69, v29
    v_mul_f32 v30, s69, v30
    v_mul_f32 v31, s69, v31
    v_cvt_pk_bf16_f32 v108, v24, v25
    v_cvt_pk_bf16_f32 v110, v28, v29
    v_cvt_pk_bf16_f32 v109, v26, v27
    v_cvt_pk_bf16_f32 v111, v30, v31
    v_permlane32_swap_b32 v104, v106
    v_permlane32_swap_b32 v105, v107
    v_permlane16_swap_b32 v100, v102
    v_permlane16_swap_b32 v101, v103
    s_add_u32 m0, s14, 0
    s_mov_b32 s73, s55
    buffer_load_dwordx4 v248, s[40:43], s73 offen nt lds
    v_mul_f32 v32, s69, v32
    v_mul_f32 v33, s69, v33
    v_mul_f32 v34, s69, v34
    v_mul_f32 v35, s69, v35
    v_mul_f32 v36, s69, v36
    v_mul_f32 v37, s69, v37
    v_mul_f32 v38, s69, v38
    v_mul_f32 v39, s69, v39
    v_cvt_pk_bf16_f32 v112, v32, v33
    v_cvt_pk_bf16_f32 v114, v36, v37
    v_cvt_pk_bf16_f32 v113, v34, v35
    v_cvt_pk_bf16_f32 v115, v38, v39
    v_permlane32_swap_b32 v108, v110
    v_permlane32_swap_b32 v109, v111
    v_permlane16_swap_b32 v104, v106
    v_permlane16_swap_b32 v105, v107
    s_add_u32 m0, s14, 32
    s_add_u32 s55, s55, 8192
    buffer_load_dwordx4 v248, s[40:43], s73 offen offset:1024 nt lds
    v_mul_f32 v40, s69, v40
    v_mul_f32 v41, s69, v41
    v_mul_f32 v42, s69, v42
    v_mul_f32 v43, s69, v43
    v_mul_f32 v44, s69, v44
    v_mul_f32 v45, s69, v45
    v_mul_f32 v46, s69, v46
    v_mul_f32 v47, s69, v47
    v_cvt_pk_bf16_f32 v116, v40, v41
    v_cvt_pk_bf16_f32 v118, v44, v45
    v_cvt_pk_bf16_f32 v117, v42, v43
    v_cvt_pk_bf16_f32 v119, v46, v47
    v_permlane32_swap_b32 v112, v114
    v_permlane32_swap_b32 v113, v115
    v_permlane16_swap_b32 v108, v110
    v_permlane16_swap_b32 v109, v111
    s_add_u32 m0, s14, 8448
    s_mov_b32 s73, s56
    buffer_load_dwordx4 v248, s[44:47], s73 offen nt lds
    v_mul_f32 v48, s69, v48
    v_mul_f32 v49, s69, v49
    v_mul_f32 v50, s69, v50
    v_mul_f32 v51, s69, v51
    v_mul_f32 v52, s69, v52
    v_mul_f32 v53, s69, v53
    v_mul_f32 v54, s69, v54
    v_mul_f32 v55, s69, v55
    v_cvt_pk_bf16_f32 v120, v48, v49
    v_cvt_pk_bf16_f32 v122, v52, v53
    v_cvt_pk_bf16_f32 v121, v50, v51
    v_cvt_pk_bf16_f32 v123, v54, v55
    v_permlane32_swap_b32 v116, v118
    v_permlane32_swap_b32 v117, v119
    v_permlane16_swap_b32 v112, v114
    v_permlane16_swap_b32 v113, v115
    s_add_u32 m0, s14, 8480
    s_add_u32 s56, s56, 8192
    buffer_load_dwordx4 v248, s[44:47], s73 offen offset:1024 nt lds
    s_add_u32 s14, s14, 33792
    s_cmp_ge_u32 s14, 135680
    s_cselect_b32 s73, 135168, 0
    s_sub_u32 s14, s14, s73
    v_mul_f32 v56, s69, v56
    v_mul_f32 v57, s69, v57
    v_mul_f32 v58, s69, v58
    v_mul_f32 v59, s69, v59
    v_mul_f32 v60, s69, v60
    v_mul_f32 v61, s69, v61
    v_mul_f32 v62, s69, v62
    v_mul_f32 v63, s69, v63
    v_cvt_pk_bf16_f32 v124, v56, v57
    v_cvt_pk_bf16_f32 v126, v60, v61
    v_cvt_pk_bf16_f32 v125, v58, v59
    v_cvt_pk_bf16_f32 v127, v62, v63
    v_permlane32_swap_b32 v120, v122
    v_permlane32_swap_b32 v121, v123
    v_permlane16_swap_b32 v116, v118
    v_permlane16_swap_b32 v117, v119
    v_permlane32_swap_b32 v124, v126
    v_permlane32_swap_b32 v125, v127
    v_permlane16_swap_b32 v120, v122
    v_permlane16_swap_b32 v121, v123
    v_permlane16_swap_b32 v124, v126
    v_permlane16_swap_b32 v125, v127
    v_mov_b32 v152, 0
    v_mov_b32 v168, 0x3f803f80
    v_mov_b32 v153, 0
    v_mov_b32 v169, 0x3f803f80
    v_mov_b32 v154, 0
    v_mov_b32 v170, 0x3f803f80
    v_mov_b32 v155, 0
    v_mov_b32 v171, 0x3f803f80
    v_xor_b32 v173, 1024, v172
    v_xor_b32 v174, 2048, v172
    v_xor_b32 v175, 3072, v172
    s_waitcnt lgkmcnt(0)
    s_waitcnt vmcnt(12)
    s_barrier
    ds_read_b128 v[132:135], v173
    ds_read_b128 v[136:139], v174
    ds_read_b128 v[140:143], v175
    ds_read_b128 v[216:219], v240 offset:0
    ds_read_b128 v[220:223], v241 offset:0
    ds_read_b128 v[232:235], v240 offset:4224
    ds_read_b128 v[236:239], v241 offset:4224
    ds_read_b128 v[224:227], v242 offset:0
    ds_read_b128 v[228:231], v243 offset:0
    s_waitcnt lgkmcnt(4)
    v_mfma_f32_16x16x32_bf16 v[172:175], v[216:219], v[96:99], 0
    v_mfma_f32_16x16x32_bf16 v[180:183], v[216:219], v[112:115], 0
    v_mfma_f32_16x16x32_bf16 v[188:191], v[216:219], v[128:131], 0
    ds_read_b128 v[216:219], v242 offset:4224
    v_mfma_f32_16x16x32_bf16 v[172:175], v[220:223], v[100:103], v[172:175]
    v_mfma_f32_16x16x32_bf16 v[180:183], v[220:223], v[116:119], v[180:183]
    v_mfma_f32_16x16x32_bf16 v[188:191], v[220:223], v[132:135], v[188:191]
    ds_read_b128 v[220:223], v243 offset:4224
    s_waitcnt lgkmcnt(2)
    v_mfma_f32_16x16x32_bf16 v[172:175], v[224:227], v[104:107], v[172:175]
    v_mfma_f32_16x16x32_bf16 v[180:183], v[224:227], v[120:123], v[180:183]
    v_mfma_f32_16x16x32_bf16 v[188:191], v[224:227], v[136:139], v[188:191]
    v_mfma_f32_16x16x32_bf16 v[172:175], v[228:231], v[108:111], v[172:175]
    v_mfma_f32_16x16x32_bf16 v[180:183], v[228:231], v[124:127], v[180:183]
    v_mfma_f32_16x16x32_bf16 v[188:191], v[228:231], v[140:143], v[188:191]
    s_add_u32 s16, s16, s17
    s_cmp_eq_u32 s16, 135168
    s_cselect_b32 s15, s18, s17
    s_cselect_b32 s16, 0, s16
    v_mfma_f32_16x16x32_bf16 v[176:179], v[232:235], v[96:99], 0
    v_mfma_f32_16x16x32_bf16 v[184:187], v[232:235], v[112:115], 0
    v_mfma_f32_16x16x32_bf16 v[192:195], v[232:235], v[128:131], 0
    v_mfma_f32_16x16x32_bf16 v[176:179], v[236:239], v[100:103], v[176:179]
    v_mfma_f32_16x16x32_bf16 v[184:187], v[236:239], v[116:119], v[184:187]
    v_mfma_f32_16x16x32_bf16 v[192:195], v[236:239], v[132:135], v[192:195]
    s_waitcnt lgkmcnt(0)
    v_mfma_f32_16x16x32_bf16 v[176:179], v[216:219], v[104:107], v[176:179]
    v_mfma_f32_16x16x32_bf16 v[184:187], v[216:219], v[120:123], v[184:187]
    v_mfma_f32_16x16x32_bf16 v[192:195], v[216:219], v[136:139], v[192:195]
    v_mfma_f32_16x16x32_bf16 v[176:179], v[220:223], v[108:111], v[176:179]
    v_mfma_f32_16x16x32_bf16 v[184:187], v[220:223], v[124:127], v[184:187]
    v_mfma_f32_16x16x32_bf16 v[192:195], v[220:223], v[140:143], v[192:195]
    s_waitcnt lgkmcnt(0)
    v_add_u32 v240, s15, v240
    v_add_u32 v241, s15, v241
    v_add_u32 v242, s15, v242
    v_add_u32 v243, s15, v243
    s_waitcnt vmcnt(8)
    s_barrier
    ds_read_b128 v[232:235], v240 offset:4224
    ds_read_b128 v[236:239], v241 offset:4224
    ds_read_b128 v[216:219], v240 offset:0
    ds_read_b128 v[220:223], v241 offset:0
    ds_read_b128 v[224:227], v242 offset:0
    ds_read_b128 v[228:231], v243 offset:0
    v_max3_f32 v249, v172, v173, v174
    v_max3_f32 v250, v175, v176, v177
    v_max3_f32 v249, v178, v179, v249
    v_max_f32 v249, v249, v250
    v_mov_b32 v250, v249
    s_nop 1
    v_permlane32_swap_b32 v249, v250
    v_max_f32 v249, v249, v250
    v_mov_b32 v250, v249
    s_nop 1
    v_permlane16_swap_b32 v249, v250
    v_max_f32 v249, v249, v250
    v_add_f32 v249, 0x40e00000, v249
    v_sub_f32 v156, 0, v249
    v_sub_f32 v157, 0, v249
    v_sub_f32 v158, 0, v249
    v_sub_f32 v159, 0, v249
    v_sub_f32 v250, v172, v249
    v_sub_f32 v251, v173, v249
    v_exp_f32 v250, v250
    v_exp_f32 v251, v251
    s_nop 0
    v_cvt_pk_bf16_f32 v196, v250, v251
    v_sub_f32 v250, v174, v249
    v_sub_f32 v251, v175, v249
    v_exp_f32 v250, v250
    v_exp_f32 v251, v251
    s_nop 0
    v_cvt_pk_bf16_f32 v197, v250, v251
    v_sub_f32 v250, v176, v249
    v_sub_f32 v251, v177, v249
    v_exp_f32 v250, v250
    v_exp_f32 v251, v251
    s_nop 0
    v_cvt_pk_bf16_f32 v198, v250, v251
    v_sub_f32 v250, v178, v249
    v_sub_f32 v251, v179, v249
    v_exp_f32 v250, v250
    v_exp_f32 v251, v251
    s_nop 0
    v_cvt_pk_bf16_f32 v199, v250, v251
    v_max3_f32 v249, v180, v181, v182
    v_max3_f32 v250, v183, v184, v185
    v_max3_f32 v249, v186, v187, v249
    v_max_f32 v249, v249, v250
    v_mov_b32 v250, v249
    s_nop 1
    v_permlane32_swap_b32 v249, v250
    v_max_f32 v249, v249, v250
    v_mov_b32 v250, v249
    s_nop 1
    v_permlane16_swap_b32 v249, v250
    v_max_f32 v249, v249, v250
    v_add_f32 v249, 0x40e00000, v249
    v_sub_f32 v160, 0, v249
    v_sub_f32 v161, 0, v249
    v_sub_f32 v162, 0, v249
    v_sub_f32 v163, 0, v249
    v_sub_f32 v250, v180, v249
    v_sub_f32 v251, v181, v249
    v_exp_f32 v250, v250
    v_exp_f32 v251, v251
    s_nop 0
    v_cvt_pk_bf16_f32 v200, v250, v251
    v_sub_f32 v250, v182, v249
    v_sub_f32 v251, v183, v249
    v_exp_f32 v250, v250
    v_exp_f32 v251, v251
    s_nop 0
    v_cvt_pk_bf16_f32 v201, v250, v251
    v_sub_f32 v250, v184, v249
    v_sub_f32 v251, v185, v249
    v_exp_f32 v250, v250
    v_exp_f32 v251, v251
    s_nop 0
    v_cvt_pk_bf16_f32 v202, v250, v251
    v_sub_f32 v250, v186, v249
    v_sub_f32 v251, v187, v249
    v_exp_f32 v250, v250
    v_exp_f32 v251, v251
    s_nop 0
    v_cvt_pk_bf16_f32 v203, v250, v251
    v_max3_f32 v249, v188, v189, v190
    v_max3_f32 v250, v191, v192, v193
    v_max3_f32 v249, v194, v195, v249
    v_max_f32 v249, v249, v250
    v_mov_b32 v250, v249
    s_nop 1
    v_permlane32_swap_b32 v249, v250
    v_max_f32 v249, v249, v250
    v_mov_b32 v250, v249
    s_nop 1
    v_permlane16_swap_b32 v249, v250
    v_max_f32 v249, v249, v250
    v_add_f32 v249, 0x40e00000, v249
    v_sub_f32 v164, 0, v249
    v_sub_f32 v165, 0, v249
    v_sub_f32 v166, 0, v249
    v_sub_f32 v167, 0, v249
    v_sub_f32 v250, v188, v249
    v_sub_f32 v251, v189, v249
    v_exp_f32 v250, v250
    v_exp_f32 v251, v251
    s_nop 0
    v_cvt_pk_bf16_f32 v212, v250, v251
    v_sub_f32 v250, v190, v249
    v_sub_f32 v251, v191, v249
    v_exp_f32 v250, v250
    v_exp_f32 v251, v251
    s_nop 0
    v_cvt_pk_bf16_f32 v213, v250, v251
    v_sub_f32 v250, v192, v249
    v_sub_f32 v251, v193, v249
    v_exp_f32 v250, v250
    v_exp_f32 v251, v251
    s_nop 0
    v_cvt_pk_bf16_f32 v214, v250, v251
    v_sub_f32 v250, v194, v249
    v_sub_f32 v251, v195, v249
    v_exp_f32 v250, v250
    v_exp_f32 v251, v251
    s_nop 0
    v_cvt_pk_bf16_f32 v215, v250, v251
    s_cmp_eq_u32 s31, 1
    s_cbranch_scc1 L_s1_A
    s_cmp_eq_u32 s31, 0
    s_cbranch_scc1 L_s1_B
    s_waitcnt lgkmcnt(2)
    v_mfma_f32_16x16x32_bf16 v[172:175], v[216:219], v[96:99], v[156:159]
    v_add_u32 v244, s15, v244
    v_add_u32 v245, s15, v245
    v_mfma_f32_16x16x32_bf16 v[180:183], v[216:219], v[112:115], v[160:163]
    ds_read_b128 v[216:219], v242 offset:4224
    v_mfma_f32_16x16x32_bf16 v[172:175], v[220:223], v[100:103], v[172:175]
    v_add_u32 v246, s15, v246
    v_add_u32 v247, s15, v247
    v_mfma_f32_16x16x32_bf16 v[180:183], v[220:223], v[116:119], v[180:183]
    ds_read_b128 v[220:223], v243 offset:4224
    s_waitcnt lgkmcnt(2)
    v_mfma_f32_16x16x32_bf16 v[172:175], v[224:227], v[104:107], v[172:175]
    s_add_u32 m0, s14, 0
    s_mov_b32 s73, s55
    buffer_load_dwordx4 v248, s[40:43], s73 offen nt lds
    v_mfma_f32_16x16x32_bf16 v[180:183], v[224:227], v[120:123], v[180:183]
    ds_read_b64_tr_b16 v[224:225], v244 offset:0
    ds_read_b64_tr_b16 v[226:227], v244 offset:4224
    v_mfma_f32_16x16x32_bf16 v[172:175], v[228:231], v[108:111], v[172:175]
    s_add_u32 m0, s14, 32
    s_add_u32 s55, s55, 8192
    buffer_load_dwordx4 v248, s[40:43], s73 offen offset:1024 nt lds
    v_mfma_f32_16x16x32_bf16 v[180:183], v[228:231], v[124:127], v[180:183]
    ds_read_b64_tr_b16 v[228:229], v244 offset:32
    ds_read_b64_tr_b16 v[230:231], v244 offset:4256
    s_add_u32 s16, s16, s17
    s_cmp_eq_u32 s16, 135168
    s_cselect_b32 s15, s18, s17
    s_cselect_b32 s16, 0, s16
    v_mfma_f32_16x16x32_bf16 v[176:179], v[232:235], v[96:99], v[156:159]
    s_add_u32 m0, s14, 8448
    s_mov_b32 s73, s56
    buffer_load_dwordx4 v248, s[44:47], s73 offen nt lds
    v_mfma_f32_16x16x32_bf16 v[184:187], v[232:235], v[112:115], v[160:163]
    ds_read_b64_tr_b16 v[232:233], v245 offset:0
    ds_read_b64_tr_b16 v[234:235], v245 offset:4224
    v_mfma_f32_16x16x32_bf16 v[176:179], v[236:239], v[100:103], v[176:179]
    v_exp_f32 v249, v172
    v_mfma_f32_16x16x32_bf16 v[184:187], v[236:239], v[116:119], v[184:187]
    ds_read_b64_tr_b16 v[236:237], v245 offset:32
    ds_read_b64_tr_b16 v[238:239], v245 offset:4256
    s_waitcnt lgkmcnt(8)
    v_mfma_f32_16x16x32_bf16 v[176:179], v[216:219], v[104:107], v[176:179]
    v_exp_f32 v250, v173
    v_mfma_f32_16x16x32_bf16 v[184:187], v[216:219], v[120:123], v[184:187]
    ds_read_b64_tr_b16 v[216:217], v246 offset:0
    ds_read_b64_tr_b16 v[218:219], v246 offset:4224
    v_mfma_f32_16x16x32_bf16 v[176:179], v[220:223], v[108:111], v[176:179]
    v_cvt_pk_bf16_f32 v204, v249, v250
    v_mfma_f32_16x16x32_bf16 v[184:187], v[220:223], v[124:127], v[184:187]
    ds_read_b64_tr_b16 v[220:221], v246 offset:32
    ds_read_b64_tr_b16 v[222:223], v246 offset:4256
    v_mfma_f32_16x16x32_bf16 v[144:147], v[168:171], v[196:199], 0
    v_exp_f32 v249, v174
    s_add_u32 m0, s14, 8480
    s_add_u32 s56, s56, 8192
    buffer_load_dwordx4 v248, s[44:47], s73 offen offset:1024 nt lds
    s_add_u32 s14, s14, 33792
    s_cmp_ge_u32 s14, 135680
    s_cselect_b32 s73, 135168, 0
    s_sub_u32 s14, s14, s73
    v_mfma_f32_16x16x32_bf16 v[148:151], v[168:171], v[200:203], 0
    v_exp_f32 v250, v175
    s_waitcnt lgkmcnt(8)
    v_mfma_f32_16x16x32_bf16 v[0:3], v[224:227], v[196:199], 0
    v_cvt_pk_bf16_f32 v205, v249, v250
    v_mfma_f32_16x16x32_bf16 v[32:35], v[224:227], v[200:203], 0
    ds_read_b64_tr_b16 v[224:225], v247 offset:0
    ds_read_b64_tr_b16 v[226:227], v247 offset:4224
    v_add_u32 v240, s15, v240
    v_exp_f32 v249, v180
    v_mfma_f32_16x16x32_bf16 v[4:7], v[228:231], v[196:199], 0
    v_exp_f32 v250, v181
    v_mfma_f32_16x16x32_bf16 v[36:39], v[228:231], v[200:203], 0
    ds_read_b64_tr_b16 v[228:229], v247 offset:32
    ds_read_b64_tr_b16 v[230:231], v247 offset:4256
    v_add_u32 v241, s15, v241
    v_cvt_pk_bf16_f32 v208, v249, v250
    s_waitcnt lgkmcnt(8)
    v_mfma_f32_16x16x32_bf16 v[8:11], v[232:235], v[196:199], 0
    v_exp_f32 v249, v182
    v_exp_f32 v250, v183
    v_mfma_f32_16x16x32_bf16 v[40:43], v[232:235], v[200:203], 0
    v_add_u32 v242, s15, v242
    v_cvt_pk_bf16_f32 v209, v249, v250
    v_mfma_f32_16x16x32_bf16 v[12:15], v[236:239], v[196:199], 0
    v_exp_f32 v249, v176
    v_exp_f32 v250, v177
    v_mfma_f32_16x16x32_bf16 v[44:47], v[236:239], v[200:203], 0
    v_add_u32 v243, s15, v243
    v_cvt_pk_bf16_f32 v206, v249, v250
    s_waitcnt lgkmcnt(0)
    s_waitcnt vmcnt(8)
    s_barrier
    ds_read_b128 v[232:235], v240 offset:4224
    ds_read_b128 v[236:239], v241 offset:4224
    v_mfma_f32_16x16x32_bf16 v[16:19], v[216:219], v[196:199], 0
    v_exp_f32 v249, v178
    v_exp_f32 v250, v179
    v_mfma_f32_16x16x32_bf16 v[48:51], v[216:219], v[200:203], 0
    v_cvt_pk_bf16_f32 v207, v249, v250
    ds_read_b128 v[216:219], v240 offset:0
    v_mfma_f32_16x16x32_bf16 v[20:23], v[220:223], v[196:199], 0
    v_exp_f32 v249, v184
    v_exp_f32 v250, v185
    v_mfma_f32_16x16x32_bf16 v[52:55], v[220:223], v[200:203], 0
    v_cvt_pk_bf16_f32 v210, v249, v250
    ds_read_b128 v[220:223], v241 offset:0
    v_mfma_f32_16x16x32_bf16 v[24:27], v[224:227], v[196:199], 0
    v_exp_f32 v249, v186
    v_exp_f32 v250, v187
    v_mfma_f32_16x16x32_bf16 v[56:59], v[224:227], v[200:203], 0
    v_cvt_pk_bf16_f32 v211, v249, v250
    ds_read_b128 v[224:227], v242 offset:0
    v_mfma_f32_16x16x32_bf16 v[28:31], v[228:231], v[196:199], 0
    v_or3_b32 v251, v204, v205, v206
    v_or3_b32 v251, v207, v208, v251
    v_mfma_f32_16x16x32_bf16 v[60:63], v[228:231], v[200:203], 0
    v_or3_b32 v251, v209, v210, v251
    ds_read_b128 v[228:231], v243 offset:0
    v_or_b32 v251, v211, v251
    v_and_b32 v251, 0x40004000, v251
    v_cmp_ne_u32 vcc, 0, v251
    s_cbranch_vccnz L_s1_C_rare
    s_branch L_s1_next
L_s1_A:
    s_waitcnt lgkmcnt(2)
    v_mfma_f32_16x16x32_bf16 v[172:175], v[216:219], v[96:99], v[156:159]
    v_add_u32 v244, s15, v244
    v_add_u32 v245, s15, v245
    v_mfma_f32_16x16x32_bf16 v[180:183], v[216:219], v[112:115], v[160:163]
    v_add_u32 v246, s15, v246
    v_add_u32 v247, s15, v247
    v_mfma_f32_16x16x32_bf16 v[188:191], v[216:219], v[128:131], v[164:167]
    ds_read_b128 v[216:219], v242 offset:4224
    v_mfma_f32_16x16x32_bf16 v[172:175], v[220:223], v[100:103], v[172:175]
    s_add_u32 m0, s14, 0
    s_mov_b32 s73, s55
    buffer_load_dwordx4 v248, s[40:43], s73 offen nt lds
    v_mfma_f32_16x16x32_bf16 v[180:183], v[220:223], v[116:119], v[180:183]
    s_add_u32 m0, s14, 32
    s_add_u32 s55, s55, 8192
    buffer_load_dwordx4 v248, s[40:43], s73 offen offset:1024 nt lds
    v_mfma_f32_16x16x32_bf16 v[188:191], v[220:223], v[132:135], v[188:191]
    ds_read_b128 v[220:223], v243 offset:4224
    s_waitcnt lgkmcnt(2)
    v_mfma_f32_16x16x32_bf16 v[172:175], v[224:227], v[104:107], v[172:175]
    s_add_u32 m0, s14, 8448
    s_mov_b32 s73, s56
    buffer_load_dwordx4 v248, s[44:47], s73 offen nt lds
    v_mfma_f32_16x16x32_bf16 v[180:183], v[224:227], v[120:123], v[180:183]
    s_add_u32 m0, s14, 8480
    s_add_u32 s56, s56, 8192
    buffer_load_dwordx4 v248, s[44:47], s73 offen offset:1024 nt lds
    s_add_u32 s14, s14, 33792
    s_cmp_ge_u32 s14, 135680
    s_cselect_b32 s73, 135168, 0
    s_sub_u32 s14, s14, s73
    v_mfma_f32_16x16x32_bf16 v[188:191], v[224:227], v[136:139], v[188:191]
    ds_read_b64_tr_b16 v[224:225], v244 offset:0
    ds_read_b64_tr_b16 v[226:227], v244 offset:4224
    v_mfma_f32_16x16x32_bf16 v[172:175], v[228:231], v[108:111], v[172:175]
    v_mfma_f32_16x16x32_bf16 v[180:183], v[228:231], v[124:127], v[180:183]
    v_mfma_f32_16x16x32_bf16 v[188:191], v[228:231], v[140:143], v[188:191]
    ds_read_b64_tr_b16 v[228:229], v244 offset:32
    ds_read_b64_tr_b16 v[230:231], v244 offset:4256
    s_add_u32 s16, s16, s17
    s_cmp_eq_u32 s16, 135168
    s_cselect_b32 s15, s18, s17
    s_cselect_b32 s16, 0, s16
    v_mfma_f32_16x16x32_bf16 v[176:179], v[232:235], v[96:99], v[156:159]
    v_mfma_f32_16x16x32_bf16 v[184:187], v[232:235], v[112:115], v[160:163]
    v_exp_f32 v249, v172
    v_mfma_f32_16x16x32_bf16 v[192:195], v[232:235], v[128:131], v[164:167]
    ds_read_b64_tr_b16 v[232:233], v245 offset:0
    ds_read_b64_tr_b16 v[234:235], v245 offset:4224
    v_mfma_f32_16x16x32_bf16 v[176:179], v[236:239], v[100:103], v[176:179]
    v_exp_f32 v250, v173
    v_mfma_f32_16x16x32_bf16 v[184:187], v[236:239], v[116:119], v[184:187]
    v_cvt_pk_bf16_f32 v204, v249, v250
    v_mfma_f32_16x16x32_bf16 v[192:195], v[236:239], v[132:135], v[192:195]
    ds_read_b64_tr_b16 v[236:237], v245 offset:32
    ds_read_b64_tr_b16 v[238:239], v245 offset:4256
    s_waitcnt lgkmcnt(8)
    v_mfma_f32_16x16x32_bf16 v[176:179], v[216:219], v[104:107], v[176:179]
    v_exp_f32 v249, v174
    v_mfma_f32_16x16x32_bf16 v[184:187], v[216:219], v[120:123], v[184:187]
    v_exp_f32 v250, v175
    v_mfma_f32_16x16x32_bf16 v[192:195], v[216:219], v[136:139], v[192:195]
    ds_read_b64_tr_b16 v[216:217], v246 offset:0
    ds_read_b64_tr_b16 v[218:219], v246 offset:4224
    v_mfma_f32_16x16x32_bf16 v[176:179], v[220:223], v[108:111], v[176:179]
    v_cvt_pk_bf16_f32 v205, v249, v250
    v_mfma_f32_16x16x32_bf16 v[184:187], v[220:223], v[124:127], v[184:187]
    v_exp_f32 v249, v180
    v_mfma_f32_16x16x32_bf16 v[192:195], v[220:223], v[140:143], v[192:195]
    ds_read_b64_tr_b16 v[220:221], v246 offset:32
    ds_read_b64_tr_b16 v[222:223], v246 offset:4256
    v_mfma_f32_16x16x32_bf16 v[144:147], v[168:171], v[196:199], 0
    v_exp_f32 v250, v181
    v_mfma_f32_16x16x32_bf16 v[148:151], v[168:171], v[200:203], 0
    v_cvt_pk_bf16_f32 v208, v249, v250
    s_waitcnt lgkmcnt(8)
    v_mfma_f32_16x16x32_bf16 v[0:3], v[224:227], v[196:199], 0
    v_exp_f32 v249, v182
    v_mfma_f32_16x16x32_bf16 v[32:35], v[224:227], v[200:203], 0
    ds_read_b64_tr_b16 v[224:225], v247 offset:0
    ds_read_b64_tr_b16 v[226:227], v247 offset:4224
    v_add_u32 v240, s15, v240
    v_exp_f32 v250, v183
    v_mfma_f32_16x16x32_bf16 v[4:7], v[228:231], v[196:199], 0
    v_cvt_pk_bf16_f32 v209, v249, v250
    v_mfma_f32_16x16x32_bf16 v[36:39], v[228:231], v[200:203], 0
    ds_read_b64_tr_b16 v[228:229], v247 offset:32
    ds_read_b64_tr_b16 v[230:231], v247 offset:4256
    v_add_u32 v241, s15, v241
    v_exp_f32 v249, v188
    s_waitcnt lgkmcnt(8)
    v_mfma_f32_16x16x32_bf16 v[8:11], v[232:235], v[196:199], 0
    v_exp_f32 v250, v189
    s_nop 0
    v_cvt_pk_bf16_f32 v212, v249, v250
    v_mfma_f32_16x16x32_bf16 v[40:43], v[232:235], v[200:203], 0
    v_add_u32 v242, s15, v242
    v_exp_f32 v249, v190
    v_mfma_f32_16x16x32_bf16 v[12:15], v[236:239], v[196:199], 0
    v_exp_f32 v250, v191
    s_nop 0
    v_cvt_pk_bf16_f32 v213, v249, v250
    v_mfma_f32_16x16x32_bf16 v[44:47], v[236:239], v[200:203], 0
    v_add_u32 v243, s15, v243
    v_exp_f32 v249, v176
    s_waitcnt lgkmcnt(0)
    s_waitcnt vmcnt(8)
    s_barrier
    ds_read_b128 v[232:235], v240 offset:4224
    ds_read_b128 v[236:239], v241 offset:4224
    v_mfma_f32_16x16x32_bf16 v[16:19], v[216:219], v[196:199], 0
    v_exp_f32 v250, v177
    s_nop 0
    v_cvt_pk_bf16_f32 v206, v249, v250
    v_mfma_f32_16x16x32_bf16 v[48:51], v[216:219], v[200:203], 0
    v_exp_f32 v249, v178
    ds_read_b128 v[216:219], v240 offset:0
    v_mfma_f32_16x16x32_bf16 v[20:23], v[220:223], v[196:199], 0
    v_exp_f32 v250, v179
    s_nop 0
    v_cvt_pk_bf16_f32 v207, v249, v250
    v_mfma_f32_16x16x32_bf16 v[52:55], v[220:223], v[200:203], 0
    v_exp_f32 v249, v184
    ds_read_b128 v[220:223], v241 offset:0
    v_mfma_f32_16x16x32_bf16 v[24:27], v[224:227], v[196:199], 0
    v_exp_f32 v250, v185
    s_nop 0
    v_cvt_pk_bf16_f32 v210, v249, v250
    v_mfma_f32_16x16x32_bf16 v[56:59], v[224:227], v[200:203], 0
    v_exp_f32 v249, v186
    ds_read_b128 v[224:227], v242 offset:0
    v_mfma_f32_16x16x32_bf16 v[28:31], v[228:231], v[196:199], 0
    v_exp_f32 v250, v187
    s_nop 0
    v_cvt_pk_bf16_f32 v211, v249, v250
    v_mfma_f32_16x16x32_bf16 v[60:63], v[228:231], v[200:203], 0
    v_exp_f32 v249, v192
    ds_read_b128 v[228:231], v243 offset:0
    v_exp_f32 v250, v193
    s_nop 0
    v_cvt_pk_bf16_f32 v214, v249, v250
    v_exp_f32 v249, v194
    v_exp_f32 v250, v195
    s_nop 0
    v_cvt_pk_bf16_f32 v215, v249, v250
    v_or3_b32 v251, v204, v205, v206
    v_or3_b32 v251, v207, v208, v251
    v_or3_b32 v251, v209, v210, v251
    v_or3_b32 v251, v211, v212, v251
    v_or3_b32 v251, v213, v214, v251
    v_or_b32 v251, v215, v251
    v_and_b32 v251, 0x40004000, v251
    v_cmp_ne_u32 vcc, 0, v251
    s_cbranch_vccnz L_s1_A_rare
    s_branch L_s1_next
L_s1_B:
    s_waitcnt lgkmcnt(2)
    v_mfma_f32_16x16x32_bf16 v[172:175], v[216:219], v[96:99], v[156:159]
    v_add_u32 v244, s15, v244
    v_add_u32 v245, s15, v245
    v_mfma_f32_16x16x32_bf16 v[180:183], v[216:219], v[112:115], v[160:163]
    ds_read_b128 v[216:219], v242 offset:4224
    v_mfma_f32_16x16x32_bf16 v[172:175], v[220:223], v[100:103], v[172:175]
    v_add_u32 v246, s15, v246
    v_add_u32 v247, s15, v247
    v_mfma_f32_16x16x32_bf16 v[180:183], v[220:223], v[116:119], v[180:183]
    ds_read_b128 v[220:223], v243 offset:4224
    s_waitcnt lgkmcnt(2)
    v_mfma_f32_16x16x32_bf16 v[172:175], v[224:227], v[104:107], v[172:175]
    s_add_u32 m0, s14, 0
    s_mov_b32 s73, s55
    buffer_load_dwordx4 v248, s[40:43], s73 offen nt lds
    v_mfma_f32_16x16x32_bf16 v[180:183], v[224:227], v[120:123], v[180:183]
    ds_read_b64_tr_b16 v[224:225], v244 offset:0
    ds_read_b64_tr_b16 v[226:227], v244 offset:4224
    v_mfma_f32_16x16x32_bf16 v[172:175], v[228:231], v[108:111], v[172:175]
    s_add_u32 m0, s14, 32
    s_add_u32 s55, s55, 8192
    buffer_load_dwordx4 v248, s[40:43], s73 offen offset:1024 nt lds
    v_mfma_f32_16x16x32_bf16 v[180:183], v[228:231], v[124:127], v[180:183]
    ds_read_b64_tr_b16 v[228:229], v244 offset:32
    ds_read_b64_tr_b16 v[230:231], v244 offset:4256
    s_add_u32 s16, s16, s17
    s_cmp_eq_u32 s16, 135168
    s_cselect_b32 s15, s18, s17
    s_cselect_b32 s16, 0, s16
    v_mfma_f32_16x16x32_bf16 v[176:179], v[232:235], v[96:99], v[156:159]
    s_add_u32 m0, s14, 8448
    s_mov_b32 s73, s56
    buffer_load_dwordx4 v248, s[44:47], s73 offen nt lds
    v_mfma_f32_16x16x32_bf16 v[184:187], v[232:235], v[112:115], v[160:163]
    ds_read_b64_tr_b16 v[232:233], v245 offset:0
    ds_read_b64_tr_b16 v[234:235], v245 offset:4224
    v_mfma_f32_16x16x32_bf16 v[176:179], v[236:239], v[100:103], v[176:179]
    v_exp_f32 v249, v172
    v_mfma_f32_16x16x32_bf16 v[184:187], v[236:239], v[116:119], v[184:187]
    ds_read_b64_tr_b16 v[236:237], v245 offset:32
    ds_read_b64_tr_b16 v[238:239], v245 offset:4256
    s_waitcnt lgkmcnt(8)
    v_mfma_f32_16x16x32_bf16 v[176:179], v[216:219], v[104:107], v[176:179]
    v_exp_f32 v250, v173
    v_mfma_f32_16x16x32_bf16 v[184:187], v[216:219], v[120:123], v[184:187]
    ds_read_b64_tr_b16 v[216:217], v246 offset:0
    ds_read_b64_tr_b16 v[218:219], v246 offset:4224
    v_mfma_f32_16x16x32_bf16 v[176:179], v[220:223], v[108:111], v[176:179]
    v_cvt_pk_bf16_f32 v204, v249, v250
    v_mfma_f32_16x16x32_bf16 v[184:187], v[220:223], v[124:127], v[184:187]
    ds_read_b64_tr_b16 v[220:221], v246 offset:32
    ds_read_b64_tr_b16 v[222:223], v246 offset:4256
    v_mfma_f32_16x16x32_bf16 v[144:147], v[168:171], v[196:199], 0
    v_exp_f32 v249, v174
    s_add_u32 m0, s14, 8480
    s_add_u32 s56, s56, 8192
    buffer_load_dwordx4 v248, s[44:47], s73 offen offset:1024 nt lds
    s_add_u32 s14, s14, 33792
    s_cmp_ge_u32 s14, 135680
    s_cselect_b32 s73, 135168, 0
    s_sub_u32 s14, s14, s73
    v_mfma_f32_16x16x32_bf16 v[148:151], v[168:171], v[200:203], 0
    v_exp_f32 v250, v175
    v_mfma_f32_16x16x32_bf16 v[152:155], v[168:171], v[212:215], v[152:155]
    v_cvt_pk_bf16_f32 v205, v249, v250
    s_waitcnt lgkmcnt(8)
    v_mfma_f32_16x16x32_bf16 v[0:3], v[224:227], v[196:199], 0
    v_exp_f32 v249, v180
    v_mfma_f32_16x16x32_bf16 v[32:35], v[224:227], v[200:203], 0
    v_exp_f32 v250, v181
    v_mfma_f32_16x16x32_bf16 v[64:67], v[224:227], v[212:215], v[64:67]
    ds_read_b64_tr_b16 v[224:225], v247 offset:0
    ds_read_b64_tr_b16 v[226:227], v247 offset:4224
    v_add_u32 v240, s15, v240
    v_cvt_pk_bf16_f32 v208, v249, v250
    v_mfma_f32_16x16x32_bf16 v[4:7], v[228:231], v[196:199], 0
    v_exp_f32 v249, v182
    v_mfma_f32_16x16x32_bf16 v[36:39], v[228:231], v[200:203], 0
    v_exp_f32 v250, v183
    v_mfma_f32_16x16x32_bf16 v[68:71], v[228:231], v[212:215], v[68:71]
    ds_read_b64_tr_b16 v[228:229], v247 offset:32
    ds_read_b64_tr_b16 v[230:231], v247 offset:4256
    v_add_u32 v241, s15, v241
    v_cvt_pk_bf16_f32 v209, v249, v250
    s_waitcnt lgkmcnt(8)
    v_mfma_f32_16x16x32_bf16 v[8:11], v[232:235], v[196:199], 0
    v_exp_f32 v249, v176
    v_exp_f32 v250, v177
    v_mfma_f32_16x16x32_bf16 v[40:43], v[232:235], v[200:203], 0
    v_cvt_pk_bf16_f32 v206, v249, v250
    v_exp_f32 v249, v178
    v_mfma_f32_16x16x32_bf16 v[72:75], v[232:235], v[212:215], v[72:75]
    v_add_u32 v242, s15, v242
    v_exp_f32 v250, v179
    v_mfma_f32_16x16x32_bf16 v[12:15], v[236:239], v[196:199], 0
    v_cvt_pk_bf16_f32 v207, v249, v250
    v_exp_f32 v249, v184
    v_mfma_f32_16x16x32_bf16 v[44:47], v[236:239], v[200:203], 0
    v_exp_f32 v250, v185
    s_nop 0
    v_cvt_pk_bf16_f32 v210, v249, v250
    v_mfma_f32_16x16x32_bf16 v[76:79], v[236:239], v[212:215], v[76:79]
    v_add_u32 v243, s15, v243
    v_exp_f32 v249, v186
    s_waitcnt lgkmcnt(0)
    s_waitcnt vmcnt(8)
    s_barrier
    ds_read_b128 v[232:235], v240 offset:4224
    ds_read_b128 v[236:239], v241 offset:4224
    v_mfma_f32_16x16x32_bf16 v[16:19], v[216:219], v[196:199], 0
    v_exp_f32 v250, v187
    s_nop 0
    v_cvt_pk_bf16_f32 v211, v249, v250
    v_mfma_f32_16x16x32_bf16 v[48:51], v[216:219], v[200:203], 0
    v_or3_b32 v251, v204, v205, v206
    v_or3_b32 v251, v207, v208, v251
    v_mfma_f32_16x16x32_bf16 v[80:83], v[216:219], v[212:215], v[80:83]
    v_or3_b32 v251, v209, v210, v251
    ds_read_b128 v[216:219], v240 offset:0
    v_mfma_f32_16x16x32_bf16 v[20:23], v[220:223], v[196:199], 0
    v_or_b32 v251, v211, v251
    v_and_b32 v251, 0x40004000, v251
    v_mfma_f32_16x16x32_bf16 v[52:55], v[220:223], v[200:203], 0
    v_cmp_ne_u32 vcc, 0, v251
    v_mfma_f32_16x16x32_bf16 v[84:87], v[220:223], v[212:215], v[84:87]
    ds_read_b128 v[220:223], v241 offset:0
    v_mfma_f32_16x16x32_bf16 v[24:27], v[224:227], v[196:199], 0
    v_mfma_f32_16x16x32_bf16 v[56:59], v[224:227], v[200:203], 0
    v_mfma_f32_16x16x32_bf16 v[88:91], v[224:227], v[212:215], v[88:91]
    ds_read_b128 v[224:227], v242 offset:0
    v_mfma_f32_16x16x32_bf16 v[28:31], v[228:231], v[196:199], 0
    v_mfma_f32_16x16x32_bf16 v[60:63], v[228:231], v[200:203], 0
    v_mfma_f32_16x16x32_bf16 v[92:95], v[228:231], v[212:215], v[92:95]
    ds_read_b128 v[228:231], v243 offset:0
    s_cbranch_vccnz L_s1_B_rare
L_s1_next:
    s_mov_b32 s61, 3
L_loop:
    s_cmp_eq_u32 s31, 2
    s_cbranch_scc1 L_lp2_A
    s_cmp_eq_u32 s31, 1
    s_cbranch_scc1 L_lp2_B
    s_waitcnt lgkmcnt(2)
    v_mfma_f32_16x16x32_bf16 v[172:175], v[216:219], v[96:99], v[156:159]
    v_add_u32 v244, s15, v244
    v_add_u32 v245, s15, v245
    v_mfma_f32_16x16x32_bf16 v[180:183], v[216:219], v[112:115], v[160:163]
    ds_read_b128 v[216:219], v242 offset:4224
    v_mfma_f32_16x16x32_bf16 v[172:175], v[220:223], v[100:103], v[172:175]
    v_add_u32 v246, s15, v246
    v_add_u32 v247, s15, v247
    v_mfma_f32_16x16x32_bf16 v[180:183], v[220:223], v[116:119], v[180:183]
    ds_read_b128 v[220:223], v243 offset:4224
    s_waitcnt lgkmcnt(2)
    v_mfma_f32_16x16x32_bf16 v[172:175], v[224:227], v[104:107], v[172:175]
    s_add_u32 m0, s14, 0
    s_mov_b32 s73, s55
    buffer_load_dwordx4 v248, s[40:43], s73 offen nt lds
    v_mfma_f32_16x16x32_bf16 v[180:183], v[224:227], v[120:123], v[180:183]
    ds_read_b64_tr_b16 v[224:225], v244 offset:0
    ds_read_b64_tr_b16 v[226:227], v244 offset:4224
    v_mfma_f32_16x16x32_bf16 v[172:175], v[228:231], v[108:111], v[172:175]
    s_add_u32 m0, s14, 32
    s_add_u32 s55, s55, 8192
    buffer_load_dwordx4 v248, s[40:43], s73 offen offset:1024 nt lds
    v_mfma_f32_16x16x32_bf16 v[180:183], v[228:231], v[124:127], v[180:183]
    ds_read_b64_tr_b16 v[228:229], v244 offset:32
    ds_read_b64_tr_b16 v[230:231], v244 offset:4256
    s_add_u32 s16, s16, s17
    s_cmp_eq_u32 s16, 135168
    s_cselect_b32 s15, s18, s17
    s_cselect_b32 s16, 0, s16
    v_mfma_f32_16x16x32_bf16 v[176:179], v[232:235], v[96:99], v[156:159]
    s_add_u32 m0, s14, 8448
    s_mov_b32 s73, s56
    buffer_load_dwordx4 v248, s[44:47], s73 offen nt lds
    v_mfma_f32_16x16x32_bf16 v[184:187], v[232:235], v[112:115], v[160:163]
    ds_read_b64_tr_b16 v[232:233], v245 offset:0
    ds_read_b64_tr_b16 v[234:235], v245 offset:4224
    v_mfma_f32_16x16x32_bf16 v[176:179], v[236:239], v[100:103], v[176:179]
    v_exp_f32 v249, v172
    v_mfma_f32_16x16x32_bf16 v[184:187], v[236:239], v[116:119], v[184:187]
    ds_read_b64_tr_b16 v[236:237], v245 offset:32
    ds_read_b64_tr_b16 v[238:239], v245 offset:4256
    s_waitcnt lgkmcnt(8)
    v_mfma_f32_16x16x32_bf16 v[176:179], v[216:219], v[104:107], v[176:179]
    v_exp_f32 v250, v173
    v_mfma_f32_16x16x32_bf16 v[184:187], v[216:219], v[120:123], v[184:187]
    ds_read_b64_tr_b16 v[216:217], v246 offset:0
    ds_read_b64_tr_b16 v[218:219], v246 offset:4224
    v_mfma_f32_16x16x32_bf16 v[176:179], v[220:223], v[108:111], v[176:179]
    v_cvt_pk_bf16_f32 v196, v249, v250
    v_mfma_f32_16x16x32_bf16 v[184:187], v[220:223], v[124:127], v[184:187]
    ds_read_b64_tr_b16 v[220:221], v246 offset:32
    ds_read_b64_tr_b16 v[222:223], v246 offset:4256
    v_mfma_f32_16x16x32_bf16 v[144:147], v[168:171], v[204:207], v[144:147]
    v_exp_f32 v249, v174
    s_add_u32 m0, s14, 8480
    s_add_u32 s56, s56, 8192
    buffer_load_dwordx4 v248, s[44:47], s73 offen offset:1024 nt lds
    s_add_u32 s14, s14, 33792
    s_cmp_ge_u32 s14, 135680
    s_cselect_b32 s73, 135168, 0
    s_sub_u32 s14, s14, s73
    v_mfma_f32_16x16x32_bf16 v[148:151], v[168:171], v[208:211], v[148:151]
    v_exp_f32 v250, v175
    s_waitcnt lgkmcnt(8)
    v_mfma_f32_16x16x32_bf16 v[0:3], v[224:227], v[204:207], v[0:3]
    v_cvt_pk_bf16_f32 v197, v249, v250
    v_mfma_f32_16x16x32_bf16 v[32:35], v[224:227], v[208:211], v[32:35]
    ds_read_b64_tr_b16 v[224:225], v247 offset:0
    ds_read_b64_tr_b16 v[226:227], v247 offset:4224
    v_add_u32 v240, s15, v240
    v_exp_f32 v249, v180
    v_mfma_f32_16x16x32_bf16 v[4:7], v[228:231], v[204:207], v[4:7]
    v_exp_f32 v250, v181
    v_mfma_f32_16x16x32_bf16 v[36:39], v[228:231], v[208:211], v[36:39]
    ds_read_b64_tr_b16 v[228:229], v247 offset:32
    ds_read_b64_tr_b16 v[230:231], v247 offset:4256
    v_add_u32 v241, s15, v241
    v_cvt_pk_bf16_f32 v200, v249, v250
    s_waitcnt lgkmcnt(8)
    v_mfma_f32_16x16x32_bf16 v[8:11], v[232:235], v[204:207], v[8:11]
    v_exp_f32 v249, v182
    v_exp_f32 v250, v183
    v_mfma_f32_16x16x32_bf16 v[40:43], v[232:235], v[208:211], v[40:43]
    v_add_u32 v242, s15, v242
    v_cvt_pk_bf16_f32 v201, v249, v250
    v_mfma_f32_16x16x32_bf16 v[12:15], v[236:239], v[204:207], v[12:15]
    v_exp_f32 v249, v176
    v_exp_f32 v250, v177
    v_mfma_f32_16x16x32_bf16 v[44:47], v[236:239], v[208:211], v[44:47]
    v_add_u32 v243, s15, v243
    v_cvt_pk_bf16_f32 v198, v249, v250
    s_waitcnt lgkmcnt(0)
    s_waitcnt vmcnt(8)
    s_barrier
    ds_read_b128 v[232:235], v240 offset:4224
    ds_read_b128 v[236:239], v241 offset:4224
    v_mfma_f32_16x16x32_bf16 v[16:19], v[216:219], v[204:207], v[16:19]
    v_exp_f32 v249, v178
    v_exp_f32 v250, v179
    v_mfma_f32_16x16x32_bf16 v[48:51], v[216:219], v[208:211], v[48:51]
    v_cvt_pk_bf16_f32 v199, v249, v250
    ds_read_b128 v[216:219], v240 offset:0
    v_mfma_f32_16x16x32_bf16 v[20:23], v[220:223], v[204:207], v[20:23]
    v_exp_f32 v249, v184
    v_exp_f32 v250, v185
    v_mfma_f32_16x16x32_bf16 v[52:55], v[220:223], v[208:211], v[52:55]
    v_cvt_pk_bf16_f32 v202, v249, v250
    ds_read_b128 v[220:223], v241 offset:0
    v_mfma_f32_16x16x32_bf16 v[24:27], v[224:227], v[204:207], v[24:27]
    v_exp_f32 v249, v186
    v_exp_f32 v250, v187
    v_mfma_f32_16x16x32_bf16 v[56:59], v[224:227], v[208:211], v[56:59]
    v_cvt_pk_bf16_f32 v203, v249, v250
    ds_read_b128 v[224:227], v242 offset:0
    v_mfma_f32_16x16x32_bf16 v[28:31], v[228:231], v[204:207], v[28:31]
    v_or3_b32 v251, v196, v197, v198
    v_or3_b32 v251, v199, v200, v251
    v_mfma_f32_16x16x32_bf16 v[60:63], v[228:231], v[208:211], v[60:63]
    v_or3_b32 v251, v201, v202, v251
    ds_read_b128 v[228:231], v243 offset:0
    v_or_b32 v251, v203, v251
    v_and_b32 v251, 0x40004000, v251
    v_cmp_ne_u32 vcc, 0, v251
    s_cbranch_vccnz L_lp2_C_rare
    s_branch L_lp2_next
L_lp2_A:
    s_waitcnt lgkmcnt(2)
    v_mfma_f32_16x16x32_bf16 v[172:175], v[216:219], v[96:99], v[156:159]
    v_add_u32 v244, s15, v244
    v_add_u32 v245, s15, v245
    v_mfma_f32_16x16x32_bf16 v[180:183], v[216:219], v[112:115], v[160:163]
    v_add_u32 v246, s15, v246
    v_add_u32 v247, s15, v247
    v_mfma_f32_16x16x32_bf16 v[188:191], v[216:219], v[128:131], v[164:167]
    ds_read_b128 v[216:219], v242 offset:4224
    v_mfma_f32_16x16x32_bf16 v[172:175], v[220:223], v[100:103], v[172:175]
    s_add_u32 m0, s14, 0
    s_mov_b32 s73, s55
    buffer_load_dwordx4 v248, s[40:43], s73 offen nt lds
    v_mfma_f32_16x16x32_bf16 v[180:183], v[220:223], v[116:119], v[180:183]
    s_add_u32 m0, s14, 32
    s_add_u32 s55, s55, 8192
    buffer_load_dwordx4 v248, s[40:43], s73 offen offset:1024 nt lds
    v_mfma_f32_16x16x32_bf16 v[188:191], v[220:223], v[132:135], v[188:191]
    ds_read_b128 v[220:223], v243 offset:4224
    s_waitcnt lgkmcnt(2)
    v_mfma_f32_16x16x32_bf16 v[172:175], v[224:227], v[104:107], v[172:175]
    s_add_u32 m0, s14, 8448
    s_mov_b32 s73, s56
    buffer_load_dwordx4 v248, s[44:47], s73 offen nt lds
    v_mfma_f32_16x16x32_bf16 v[180:183], v[224:227], v[120:123], v[180:183]
    s_add_u32 m0, s14, 8480
    s_add_u32 s56, s56, 8192
    buffer_load_dwordx4 v248, s[44:47], s73 offen offset:1024 nt lds
    s_add_u32 s14, s14, 33792
    s_cmp_ge_u32 s14, 135680
    s_cselect_b32 s73, 135168, 0
    s_sub_u32 s14, s14, s73
    v_mfma_f32_16x16x32_bf16 v[188:191], v[224:227], v[136:139], v[188:191]
    ds_read_b64_tr_b16 v[224:225], v244 offset:0
    ds_read_b64_tr_b16 v[226:227], v244 offset:4224
    v_mfma_f32_16x16x32_bf16 v[172:175], v[228:231], v[108:111], v[172:175]
    v_mfma_f32_16x16x32_bf16 v[180:183], v[228:231], v[124:127], v[180:183]
    v_mfma_f32_16x16x32_bf16 v[188:191], v[228:231], v[140:143], v[188:191]
    ds_read_b64_tr_b16 v[228:229], v244 offset:32
    ds_read_b64_tr_b16 v[230:231], v244 offset:4256
    s_add_u32 s16, s16, s17
    s_cmp_eq_u32 s16, 135168
    s_cselect_b32 s15, s18, s17
    s_cselect_b32 s16, 0, s16
    v_mfma_f32_16x16x32_bf16 v[176:179], v[232:235], v[96:99], v[156:159]
    v_mfma_f32_16x16x32_bf16 v[184:187], v[232:235], v[112:115], v[160:163]
    v_exp_f32 v249, v172
    v_mfma_f32_16x16x32_bf16 v[192:195], v[232:235], v[128:131], v[164:167]
    ds_read_b64_tr_b16 v[232:233], v245 offset:0
    ds_read_b64_tr_b16 v[234:235], v245 offset:4224
    v_mfma_f32_16x16x32_bf16 v[176:179], v[236:239], v[100:103], v[176:179]
    v_exp_f32 v250, v173
    v_mfma_f32_16x16x32_bf16 v[184:187], v[236:239], v[116:119], v[184:187]
    v_cvt_pk_bf16_f32 v196, v249, v250
    v_mfma_f32_16x16x32_bf16 v[192:195], v[236:239], v[132:135], v[192:195]
    ds_read_b64_tr_b16 v[236:237], v245 offset:32
    ds_read_b64_tr_b16 v[238:239], v245 offset:4256
    s_waitcnt lgkmcnt(8)
    v_mfma_f32_16x16x32_bf16 v[176:179], v[216:219], v[104:107], v[176:179]
    v_exp_f32 v249, v174
    v_mfma_f32_16x16x32_bf16 v[184:187], v[216:219], v[120:123], v[184:187]
    v_exp_f32 v250, v175
    v_mfma_f32_16x16x32_bf16 v[192:195], v[216:219], v[136:139], v[192:195]
    ds_read_b64_tr_b16 v[216:217], v246 offset:0
    ds_read_b64_tr_b16 v[218:219], v246 offset:4224
    v_mfma_f32_16x16x32_bf16 v[176:179], v[220:223], v[108:111], v[176:179]
    v_cvt_pk_bf16_f32 v197, v249, v250
    v_mfma_f32_16x16x32_bf16 v[184:187], v[220:223], v[124:127], v[184:187]
    v_exp_f32 v249, v180
    v_mfma_f32_16x16x32_bf16 v[192:195], v[220:223], v[140:143], v[192:195]
    ds_read_b64_tr_b16 v[220:221], v246 offset:32
    ds_read_b64_tr_b16 v[222:223], v246 offset:4256
    v_mfma_f32_16x16x32_bf16 v[144:147], v[168:171], v[204:207], v[144:147]
    v_exp_f32 v250, v181
    v_mfma_f32_16x16x32_bf16 v[148:151], v[168:171], v[208:211], v[148:151]
    v_cvt_pk_bf16_f32 v200, v249, v250
    s_waitcnt lgkmcnt(8)
    v_mfma_f32_16x16x32_bf16 v[0:3], v[224:227], v[204:207], v[0:3]
    v_exp_f32 v249, v182
    v_mfma_f32_16x16x32_bf16 v[32:35], v[224:227], v[208:211], v[32:35]
    ds_read_b64_tr_b16 v[224:225], v247 offset:0
    ds_read_b64_tr_b16 v[226:227], v247 offset:4224
    v_add_u32 v240, s15, v240
    v_exp_f32 v250, v183
    v_mfma_f32_16x16x32_bf16 v[4:7], v[228:231], v[204:207], v[4:7]
    v_cvt_pk_bf16_f32 v201, v249, v250
    v_mfma_f32_16x16x32_bf16 v[36:39], v[228:231], v[208:211], v[36:39]
    ds_read_b64_tr_b16 v[228:229], v247 offset:32
    ds_read_b64_tr_b16 v[230:231], v247 offset:4256
    v_add_u32 v241, s15, v241
    v_exp_f32 v249, v188
    s_waitcnt lgkmcnt(8)
    v_mfma_f32_16x16x32_bf16 v[8:11], v[232:235], v[204:207], v[8:11]
    v_exp_f32 v250, v189
    s_nop 0
    v_cvt_pk_bf16_f32 v212, v249, v250
    v_mfma_f32_16x16x32_bf16 v[40:43], v[232:235], v[208:211], v[40:43]
    v_add_u32 v242, s15, v242
    v_exp_f32 v249, v190
    v_mfma_f32_16x16x32_bf16 v[12:15], v[236:239], v[204:207], v[12:15]
    v_exp_f32 v250, v191
    s_nop 0
    v_cvt_pk_bf16_f32 v213, v249, v250
    v_mfma_f32_16x16x32_bf16 v[44:47], v[236:239], v[208:211], v[44:47]
    v_add_u32 v243, s15, v243
    v_exp_f32 v249, v176
    s_waitcnt lgkmcnt(0)
    s_waitcnt vmcnt(8)
    s_barrier
    ds_read_b128 v[232:235], v240 offset:4224
    ds_read_b128 v[236:239], v241 offset:4224
    v_mfma_f32_16x16x32_bf16 v[16:19], v[216:219], v[204:207], v[16:19]
    v_exp_f32 v250, v177
    s_nop 0
    v_cvt_pk_bf16_f32 v198, v249, v250
    v_mfma_f32_16x16x32_bf16 v[48:51], v[216:219], v[208:211], v[48:51]
    v_exp_f32 v249, v178
    ds_read_b128 v[216:219], v240 offset:0
    v_mfma_f32_16x16x32_bf16 v[20:23], v[220:223], v[204:207], v[20:23]
    v_exp_f32 v250, v179
    s_nop 0
    v_cvt_pk_bf16_f32 v199, v249, v250
    v_mfma_f32_16x16x32_bf16 v[52:55], v[220:223], v[208:211], v[52:55]
    v_exp_f32 v249, v184
    ds_read_b128 v[220:223], v241 offset:0
    v_mfma_f32_16x16x32_bf16 v[24:27], v[224:227], v[204:207], v[24:27]
    v_exp_f32 v250, v185
    s_nop 0
    v_cvt_pk_bf16_f32 v202, v249, v250
    v_mfma_f32_16x16x32_bf16 v[56:59], v[224:227], v[208:211], v[56:59]
    v_exp_f32 v249, v186
    ds_read_b128 v[224:227], v242 offset:0
    v_mfma_f32_16x16x32_bf16 v[28:31], v[228:231], v[204:207], v[28:31]
    v_exp_f32 v250, v187
    s_nop 0
    v_cvt_pk_bf16_f32 v203, v249, v250
    v_mfma_f32_16x16x32_bf16 v[60:63], v[228:231], v[208:211], v[60:63]
    v_exp_f32 v249, v192
    ds_read_b128 v[228:231], v243 offset:0
    v_exp_f32 v250, v193
    s_nop 0
    v_cvt_pk_bf16_f32 v214, v249, v250
    v_exp_f32 v249, v194
    v_exp_f32 v250, v195
    s_nop 0
    v_cvt_pk_bf16_f32 v215, v249, v250
    v_or3_b32 v251, v196, v197, v198
    v_or3_b32 v251, v199, v200, v251
    v_or3_b32 v251, v201, v202, v251
    v_or3_b32 v251, v203, v212, v251
    v_or3_b32 v251, v213, v214, v251
    v_or_b32 v251, v215, v251
    v_and_b32 v251, 0x40004000, v251
    v_cmp_ne_u32 vcc, 0, v251
    s_cbranch_vccnz L_lp2_A_rare
    s_branch L_lp2_next
L_lp2_B:
    s_waitcnt lgkmcnt(2)
    v_mfma_f32_16x16x32_bf16 v[172:175], v[216:219], v[96:99], v[156:159]
    v_add_u32 v244, s15, v244
    v_add_u32 v245, s15, v245
    v_mfma_f32_16x16x32_bf16 v[180:183], v[216:219], v[112:115], v[160:163]
    ds_read_b128 v[216:219], v242 offset:4224
    v_mfma_f32_16x16x32_bf16 v[172:175], v[220:223], v[100:103], v[172:175]
    v_add_u32 v246, s15, v246
    v_add_u32 v247, s15, v247
    v_mfma_f32_16x16x32_bf16 v[180:183], v[220:223], v[116:119], v[180:183]
    ds_read_b128 v[220:223], v243 offset:4224
    s_waitcnt lgkmcnt(2)
    v_mfma_f32_16x16x32_bf16 v[172:175], v[224:227], v[104:107], v[172:175]
    s_add_u32 m0, s14, 0
    s_mov_b32 s73, s55
    buffer_load_dwordx4 v248, s[40:43], s73 offen nt lds
    v_mfma_f32_16x16x32_bf16 v[180:183], v[224:227], v[120:123], v[180:183]
    ds_read_b64_tr_b16 v[224:225], v244 offset:0
    ds_read_b64_tr_b16 v[226:227], v244 offset:4224
    v_mfma_f32_16x16x32_bf16 v[172:175], v[228:231], v[108:111], v[172:175]
    s_add_u32 m0, s14, 32
    s_add_u32 s55, s55, 8192
    buffer_load_dwordx4 v248, s[40:43], s73 offen offset:1024 nt lds
    v_mfma_f32_16x16x32_bf16 v[180:183], v[228:231], v[124:127], v[180:183]
    ds_read_b64_tr_b16 v[228:229], v244 offset:32
    ds_read_b64_tr_b16 v[230:231], v244 offset:4256
    s_add_u32 s16, s16, s17
    s_cmp_eq_u32 s16, 135168
    s_cselect_b32 s15, s18, s17
    s_cselect_b32 s16, 0, s16
    v_mfma_f32_16x16x32_bf16 v[176:179], v[232:235], v[96:99], v[156:159]
    s_add_u32 m0, s14, 8448
    s_mov_b32 s73, s56
    buffer_load_dwordx4 v248, s[44:47], s73 offen nt lds
    v_mfma_f32_16x16x32_bf16 v[184:187], v[232:235], v[112:115], v[160:163]
    ds_read_b64_tr_b16 v[232:233], v245 offset:0
    ds_read_b64_tr_b16 v[234:235], v245 offset:4224
    v_mfma_f32_16x16x32_bf16 v[176:179], v[236:239], v[100:103], v[176:179]
    v_exp_f32 v249, v172
    v_mfma_f32_16x16x32_bf16 v[184:187], v[236:239], v[116:119], v[184:187]
    ds_read_b64_tr_b16 v[236:237], v245 offset:32
    ds_read_b64_tr_b16 v[238:239], v245 offset:4256
    s_waitcnt lgkmcnt(8)
    v_mfma_f32_16x16x32_bf16 v[176:179], v[216:219], v[104:107], v[176:179]
    v_exp_f32 v250, v173
    v_mfma_f32_16x16x32_bf16 v[184:187], v[216:219], v[120:123], v[184:187]
    ds_read_b64_tr_b16 v[216:217], v246 offset:0
    ds_read_b64_tr_b16 v[218:219], v246 offset:4224
    v_mfma_f32_16x16x32_bf16 v[176:179], v[220:223], v[108:111], v[176:179]
    v_cvt_pk_bf16_f32 v196, v249, v250
    v_mfma_f32_16x16x32_bf16 v[184:187], v[220:223], v[124:127], v[184:187]
    ds_read_b64_tr_b16 v[220:221], v246 offset:32
    ds_read_b64_tr_b16 v[222:223], v246 offset:4256
    v_mfma_f32_16x16x32_bf16 v[144:147], v[168:171], v[204:207], v[144:147]
    v_exp_f32 v249, v174
    s_add_u32 m0, s14, 8480
    s_add_u32 s56, s56, 8192
    buffer_load_dwordx4 v248, s[44:47], s73 offen offset:1024 nt lds
    s_add_u32 s14, s14, 33792
    s_cmp_ge_u32 s14, 135680
    s_cselect_b32 s73, 135168, 0
    s_sub_u32 s14, s14, s73
    v_mfma_f32_16x16x32_bf16 v[148:151], v[168:171], v[208:211], v[148:151]
    v_exp_f32 v250, v175
    v_mfma_f32_16x16x32_bf16 v[152:155], v[168:171], v[212:215], v[152:155]
    v_cvt_pk_bf16_f32 v197, v249, v250
    s_waitcnt lgkmcnt(8)
    v_mfma_f32_16x16x32_bf16 v[0:3], v[224:227], v[204:207], v[0:3]
    v_exp_f32 v249, v180
    v_mfma_f32_16x16x32_bf16 v[32:35], v[224:227], v[208:211], v[32:35]
    v_exp_f32 v250, v181
    v_mfma_f32_16x16x32_bf16 v[64:67], v[224:227], v[212:215], v[64:67]
    ds_read_b64_tr_b16 v[224:225], v247 offset:0
    ds_read_b64_tr_b16 v[226:227], v247 offset:4224
    v_add_u32 v240, s15, v240
    v_cvt_pk_bf16_f32 v200, v249, v250
    v_mfma_f32_16x16x32_bf16 v[4:7], v[228:231], v[204:207], v[4:7]
    v_exp_f32 v249, v182
    v_mfma_f32_16x16x32_bf16 v[36:39], v[228:231], v[208:211], v[36:39]
    v_exp_f32 v250, v183
    v_mfma_f32_16x16x32_bf16 v[68:71], v[228:231], v[212:215], v[68:71]
    ds_read_b64_tr_b16 v[228:229], v247 offset:32
    ds_read_b64_tr_b16 v[230:231], v247 offset:4256
    v_add_u32 v241, s15, v241
    v_cvt_pk_bf16_f32 v201, v249, v250
    s_waitcnt lgkmcnt(8)
    v_mfma_f32_16x16x32_bf16 v[8:11], v[232:235], v[204:207], v[8:11]
    v_exp_f32 v249, v176
    v_exp_f32 v250, v177
    v_mfma_f32_16x16x32_bf16 v[40:43], v[232:235], v[208:211], v[40:43]
    v_cvt_pk_bf16_f32 v198, v249, v250
    v_exp_f32 v249, v178
    v_mfma_f32_16x16x32_bf16 v[72:75], v[232:235], v[212:215], v[72:75]
    v_add_u32 v242, s15, v242
    v_exp_f32 v250, v179
    v_mfma_f32_16x16x32_bf16 v[12:15], v[236:239], v[204:207], v[12:15]
    v_cvt_pk_bf16_f32 v199, v249, v250
    v_exp_f32 v249, v184
    v_mfma_f32_16x16x32_bf16 v[44:47], v[236:239], v[208:211], v[44:47]
    v_exp_f32 v250, v185
    s_nop 0
    v_cvt_pk_bf16_f32 v202, v249, v250
    v_mfma_f32_16x16x32_bf16 v[76:79], v[236:239], v[212:215], v[76:79]
    v_add_u32 v243, s15, v243
    v_exp_f32 v249, v186
    s_waitcnt lgkmcnt(0)
    s_waitcnt vmcnt(8)
    s_barrier
    ds_read_b128 v[232:235], v240 offset:4224
    ds_read_b128 v[236:239], v241 offset:4224
    v_mfma_f32_16x16x32_bf16 v[16:19], v[216:219], v[204:207], v[16:19]
    v_exp_f32 v250, v187
    s_nop 0
    v_cvt_pk_bf16_f32 v203, v249, v250
    v_mfma_f32_16x16x32_bf16 v[48:51], v[216:219], v[208:211], v[48:51]
    v_or3_b32 v251, v196, v197, v198
    v_or3_b32 v251, v199, v200, v251
    v_mfma_f32_16x16x32_bf16 v[80:83], v[216:219], v[212:215], v[80:83]
    v_or3_b32 v251, v201, v202, v251
    ds_read_b128 v[216:219], v240 offset:0
    v_mfma_f32_16x16x32_bf16 v[20:23], v[220:223], v[204:207], v[20:23]
    v_or_b32 v251, v203, v251
    v_and_b32 v251, 0x40004000, v251
    v_mfma_f32_16x16x32_bf16 v[52:55], v[220:223], v[208:211], v[52:55]
    v_cmp_ne_u32 vcc, 0, v251
    v_mfma_f32_16x16x32_bf16 v[84:87], v[220:223], v[212:215], v[84:87]
    ds_read_b128 v[220:223], v241 offset:0
    v_mfma_f32_16x16x32_bf16 v[24:27], v[224:227], v[204:207], v[24:27]
    v_mfma_f32_16x16x32_bf16 v[56:59], v[224:227], v[208:211], v[56:59]
    v_mfma_f32_16x16x32_bf16 v[88:91], v[224:227], v[212:215], v[88:91]
    ds_read_b128 v[224:227], v242 offset:0
    v_mfma_f32_16x16x32_bf16 v[28:31], v[228:231], v[204:207], v[28:31]
    v_mfma_f32_16x16x32_bf16 v[60:63], v[228:231], v[208:211], v[60:63]
    v_mfma_f32_16x16x32_bf16 v[92:95], v[228:231], v[212:215], v[92:95]
    ds_read_b128 v[228:231], v243 offset:0
    s_cbranch_vccnz L_lp2_B_rare
L_lp2_next:
    s_cmp_eq_u32 s31, 3
    s_cbranch_scc1 L_lp3_A
    s_cmp_eq_u32 s31, 2
    s_cbranch_scc1 L_lp3_B
    s_waitcnt lgkmcnt(2)
    v_mfma_f32_16x16x32_bf16 v[172:175], v[216:219], v[96:99], v[156:159]
    v_add_u32 v244, s15, v244
    v_add_u32 v245, s15, v245
    v_mfma_f32_16x16x32_bf16 v[180:183], v[216:219], v[112:115], v[160:163]
    ds_read_b128 v[216:219], v242 offset:4224
    v_mfma_f32_16x16x32_bf16 v[172:175], v[220:223], v[100:103], v[172:175]
    v_add_u32 v246, s15, v246
    v_add_u32 v247, s15, v247
    v_mfma_f32_16x16x32_bf16 v[180:183], v[220:223], v[116:119], v[180:183]
    ds_read_b128 v[220:223], v243 offset:4224
    s_waitcnt lgkmcnt(2)
    v_mfma_f32_16x16x32_bf16 v[172:175], v[224:227], v[104:107], v[172:175]
    s_add_u32 m0, s14, 0
    s_mov_b32 s73, s55
    buffer_load_dwordx4 v248, s[40:43], s73 offen nt lds
    v_mfma_f32_16x16x32_bf16 v[180:183], v[224:227], v[120:123], v[180:183]
    ds_read_b64_tr_b16 v[224:225], v244 offset:0
    ds_read_b64_tr_b16 v[226:227], v244 offset:4224
    v_mfma_f32_16x16x32_bf16 v[172:175], v[228:231], v[108:111], v[172:175]
    s_add_u32 m0, s14, 32
    s_add_u32 s55, s55, 8192
    buffer_load_dwordx4 v248, s[40:43], s73 offen offset:1024 nt lds
    v_mfma_f32_16x16x32_bf16 v[180:183], v[228:231], v[124:127], v[180:183]
    ds_read_b64_tr_b16 v[228:229], v244 offset:32
    ds_read_b64_tr_b16 v[230:231], v244 offset:4256
    s_add_u32 s16, s16, s17
    s_cmp_eq_u32 s16, 135168
    s_cselect_b32 s15, s18, s17
    s_cselect_b32 s16, 0, s16
    v_mfma_f32_16x16x32_bf16 v[176:179], v[232:235], v[96:99], v[156:159]
    s_add_u32 m0, s14, 8448
    s_mov_b32 s73, s56
    buffer_load_dwordx4 v248, s[44:47], s73 offen nt lds
    v_mfma_f32_16x16x32_bf16 v[184:187], v[232:235], v[112:115], v[160:163]
    ds_read_b64_tr_b16 v[232:233], v245 offset:0
    ds_read_b64_tr_b16 v[234:235], v245 offset:4224
    v_mfma_f32_16x16x32_bf16 v[176:179], v[236:239], v[100:103], v[176:179]
    v_exp_f32 v249, v172
    v_mfma_f32_16x16x32_bf16 v[184:187], v[236:239], v[116:119], v[184:187]
    ds_read_b64_tr_b16 v[236:237], v245 offset:32
    ds_read_b64_tr_b16 v[238:239], v245 offset:4256
    s_waitcnt lgkmcnt(8)
    v_mfma_f32_16x16x32_bf16 v[176:179], v[216:219], v[104:107], v[176:179]
    v_exp_f32 v250, v173
    v_mfma_f32_16x16x32_bf16 v[184:187], v[216:219], v[120:123], v[184:187]
    ds_read_b64_tr_b16 v[216:217], v246 offset:0
    ds_read_b64_tr_b16 v[218:219], v246 offset:4224
    v_mfma_f32_16x16x32_bf16 v[176:179], v[220:223], v[108:111], v[176:179]
    v_cvt_pk_bf16_f32 v204, v249, v250
    v_mfma_f32_16x16x32_bf16 v[184:187], v[220:223], v[124:127], v[184:187]
    ds_read_b64_tr_b16 v[220:221], v246 offset:32
    ds_read_b64_tr_b16 v[222:223], v246 offset:4256
    v_mfma_f32_16x16x32_bf16 v[144:147], v[168:171], v[196:199], v[144:147]
    v_exp_f32 v249, v174
    s_add_u32 m0, s14, 8480
    s_add_u32 s56, s56, 8192
    buffer_load_dwordx4 v248, s[44:47], s73 offen offset:1024 nt lds
    s_add_u32 s14, s14, 33792
    s_cmp_ge_u32 s14, 135680
    s_cselect_b32 s73, 135168, 0
    s_sub_u32 s14, s14, s73
    v_mfma_f32_16x16x32_bf16 v[148:151], v[168:171], v[200:203], v[148:151]
    v_exp_f32 v250, v175
    s_waitcnt lgkmcnt(8)
    v_mfma_f32_16x16x32_bf16 v[0:3], v[224:227], v[196:199], v[0:3]
    v_cvt_pk_bf16_f32 v205, v249, v250
    v_mfma_f32_16x16x32_bf16 v[32:35], v[224:227], v[200:203], v[32:35]
    ds_read_b64_tr_b16 v[224:225], v247 offset:0
    ds_read_b64_tr_b16 v[226:227], v247 offset:4224
    v_add_u32 v240, s15, v240
    v_exp_f32 v249, v180
    v_mfma_f32_16x16x32_bf16 v[4:7], v[228:231], v[196:199], v[4:7]
    v_exp_f32 v250, v181
    v_mfma_f32_16x16x32_bf16 v[36:39], v[228:231], v[200:203], v[36:39]
    ds_read_b64_tr_b16 v[228:229], v247 offset:32
    ds_read_b64_tr_b16 v[230:231], v247 offset:4256
    v_add_u32 v241, s15, v241
    v_cvt_pk_bf16_f32 v208, v249, v250
    s_waitcnt lgkmcnt(8)
    v_mfma_f32_16x16x32_bf16 v[8:11], v[232:235], v[196:199], v[8:11]
    v_exp_f32 v249, v182
    v_exp_f32 v250, v183
    v_mfma_f32_16x16x32_bf16 v[40:43], v[232:235], v[200:203], v[40:43]
    v_add_u32 v242, s15, v242
    v_cvt_pk_bf16_f32 v209, v249, v250
    v_mfma_f32_16x16x32_bf16 v[12:15], v[236:239], v[196:199], v[12:15]
    v_exp_f32 v249, v176
    v_exp_f32 v250, v177
    v_mfma_f32_16x16x32_bf16 v[44:47], v[236:239], v[200:203], v[44:47]
    v_add_u32 v243, s15, v243
    v_cvt_pk_bf16_f32 v206, v249, v250
    s_waitcnt lgkmcnt(0)
    s_waitcnt vmcnt(8)
    s_barrier
    ds_read_b128 v[232:235], v240 offset:4224
    ds_read_b128 v[236:239], v241 offset:4224
    v_mfma_f32_16x16x32_bf16 v[16:19], v[216:219], v[196:199], v[16:19]
    v_exp_f32 v249, v178
    v_exp_f32 v250, v179
    v_mfma_f32_16x16x32_bf16 v[48:51], v[216:219], v[200:203], v[48:51]
    v_cvt_pk_bf16_f32 v207, v249, v250
    ds_read_b128 v[216:219], v240 offset:0
    v_mfma_f32_16x16x32_bf16 v[20:23], v[220:223], v[196:199], v[20:23]
    v_exp_f32 v249, v184
    v_exp_f32 v250, v185
    v_mfma_f32_16x16x32_bf16 v[52:55], v[220:223], v[200:203], v[52:55]
    v_cvt_pk_bf16_f32 v210, v249, v250
    ds_read_b128 v[220:223], v241 offset:0
    v_mfma_f32_16x16x32_bf16 v[24:27], v[224:227], v[196:199], v[24:27]
    v_exp_f32 v249, v186
    v_exp_f32 v250, v187
    v_mfma_f32_16x16x32_bf16 v[56:59], v[224:227], v[200:203], v[56:59]
    v_cvt_pk_bf16_f32 v211, v249, v250
    ds_read_b128 v[224:227], v242 offset:0
    v_mfma_f32_16x16x32_bf16 v[28:31], v[228:231], v[196:199], v[28:31]
    v_or3_b32 v251, v204, v205, v206
    v_or3_b32 v251, v207, v208, v251
    v_mfma_f32_16x16x32_bf16 v[60:63], v[228:231], v[200:203], v[60:63]
    v_or3_b32 v251, v209, v210, v251
    ds_read_b128 v[228:231], v243 offset:0
    v_or_b32 v251, v211, v251
    v_and_b32 v251, 0x40004000, v251
    v_cmp_ne_u32 vcc, 0, v251
    s_cbranch_vccnz L_lp3_C_rare
    s_branch L_lp3_next
L_lp3_A:
    s_waitcnt lgkmcnt(2)
    v_mfma_f32_16x16x32_bf16 v[172:175], v[216:219], v[96:99], v[156:159]
    v_add_u32 v244, s15, v244
    v_add_u32 v245, s15, v245
    v_mfma_f32_16x16x32_bf16 v[180:183], v[216:219], v[112:115], v[160:163]
    v_add_u32 v246, s15, v246
    v_add_u32 v247, s15, v247
    v_mfma_f32_16x16x32_bf16 v[188:191], v[216:219], v[128:131], v[164:167]
    ds_read_b128 v[216:219], v242 offset:4224
    v_mfma_f32_16x16x32_bf16 v[172:175], v[220:223], v[100:103], v[172:175]
    s_add_u32 m0, s14, 0
    s_mov_b32 s73, s55
    buffer_load_dwordx4 v248, s[40:43], s73 offen nt lds
    v_mfma_f32_16x16x32_bf16 v[180:183], v[220:223], v[116:119], v[180:183]
    s_add_u32 m0, s14, 32
    s_add_u32 s55, s55, 8192
    buffer_load_dwordx4 v248, s[40:43], s73 offen offset:1024 nt lds
    v_mfma_f32_16x16x32_bf16 v[188:191], v[220:223], v[132:135], v[188:191]
    ds_read_b128 v[220:223], v243 offset:4224
    s_waitcnt lgkmcnt(2)
    v_mfma_f32_16x16x32_bf16 v[172:175], v[224:227], v[104:107], v[172:175]
    s_add_u32 m0, s14, 8448
    s_mov_b32 s73, s56
    buffer_load_dwordx4 v248, s[44:47], s73 offen nt lds
    v_mfma_f32_16x16x32_bf16 v[180:183], v[224:227], v[120:123], v[180:183]
    s_add_u32 m0, s14, 8480
    s_add_u32 s56, s56, 8192
    buffer_load_dwordx4 v248, s[44:47], s73 offen offset:1024 nt lds
    s_add_u32 s14, s14, 33792
    s_cmp_ge_u32 s14, 135680
    s_cselect_b32 s73, 135168, 0
    s_sub_u32 s14, s14, s73
    v_mfma_f32_16x16x32_bf16 v[188:191], v[224:227], v[136:139], v[188:191]
    ds_read_b64_tr_b16 v[224:225], v244 offset:0
    ds_read_b64_tr_b16 v[226:227], v244 offset:4224
    v_mfma_f32_16x16x32_bf16 v[172:175], v[228:231], v[108:111], v[172:175]
    v_mfma_f32_16x16x32_bf16 v[180:183], v[228:231], v[124:127], v[180:183]
    v_mfma_f32_16x16x32_bf16 v[188:191], v[228:231], v[140:143], v[188:191]
    ds_read_b64_tr_b16 v[228:229], v244 offset:32
    ds_read_b64_tr_b16 v[230:231], v244 offset:4256
    s_add_u32 s16, s16, s17
    s_cmp_eq_u32 s16, 135168
    s_cselect_b32 s15, s18, s17
    s_cselect_b32 s16, 0, s16
    v_mfma_f32_16x16x32_bf16 v[176:179], v[232:235], v[96:99], v[156:159]
    v_mfma_f32_16x16x32_bf16 v[184:187], v[232:235], v[112:115], v[160:163]
    v_exp_f32 v249, v172
    v_mfma_f32_16x16x32_bf16 v[192:195], v[232:235], v[128:131], v[164:167]
    ds_read_b64_tr_b16 v[232:233], v245 offset:0
    ds_read_b64_tr_b16 v[234:235], v245 offset:4224
    v_mfma_f32_16x16x32_bf16 v[176:179], v[236:239], v[100:103], v[176:179]
    v_exp_f32 v250, v173
    v_mfma_f32_16x16x32_bf16 v[184:187], v[236:239], v[116:119], v[184:187]
    v_cvt_pk_bf16_f32 v204, v249, v250
    v_mfma_f32_16x16x32_bf16 v[192:195], v[236:239], v[132:135], v[192:195]
    ds_read_b64_tr_b16 v[236:237], v245 offset:32
    ds_read_b64_tr_b16 v[238:239], v245 offset:4256
    s_waitcnt lgkmcnt(8)
    v_mfma_f32_16x16x32_bf16 v[176:179], v[216:219], v[104:107], v[176:179]
    v_exp_f32 v249, v174
    v_mfma_f32_16x16x32_bf16 v[184:187], v[216:219], v[120:123], v[184:187]
    v_exp_f32 v250, v175
    v_mfma_f32_16x16x32_bf16 v[192:195], v[216:219], v[136:139], v[192:195]
    ds_read_b64_tr_b16 v[216:217], v246 offset:0
    ds_read_b64_tr_b16 v[218:219], v246 offset:4224
    v_mfma_f32_16x16x32_bf16 v[176:179], v[220:223], v[108:111], v[176:179]
    v_cvt_pk_bf16_f32 v205, v249, v250
    v_mfma_f32_16x16x32_bf16 v[184:187], v[220:223], v[124:127], v[184:187]
    v_exp_f32 v249, v180
    v_mfma_f32_16x16x32_bf16 v[192:195], v[220:223], v[140:143], v[192:195]
    ds_read_b64_tr_b16 v[220:221], v246 offset:32
    ds_read_b64_tr_b16 v[222:223], v246 offset:4256
    v_mfma_f32_16x16x32_bf16 v[144:147], v[168:171], v[196:199], v[144:147]
    v_exp_f32 v250, v181
    v_mfma_f32_16x16x32_bf16 v[148:151], v[168:171], v[200:203], v[148:151]
    v_cvt_pk_bf16_f32 v208, v249, v250
    s_waitcnt lgkmcnt(8)
    v_mfma_f32_16x16x32_bf16 v[0:3], v[224:227], v[196:199], v[0:3]
    v_exp_f32 v249, v182
    v_mfma_f32_16x16x32_bf16 v[32:35], v[224:227], v[200:203], v[32:35]
    ds_read_b64_tr_b16 v[224:225], v247 offset:0
    ds_read_b64_tr_b16 v[226:227], v247 offset:4224
    v_add_u32 v240, s15, v240
    v_exp_f32 v250, v183
    v_mfma_f32_16x16x32_bf16 v[4:7], v[228:231], v[196:199], v[4:7]
    v_cvt_pk_bf16_f32 v209, v249, v250
    v_mfma_f32_16x16x32_bf16 v[36:39], v[228:231], v[200:203], v[36:39]
    ds_read_b64_tr_b16 v[228:229], v247 offset:32
    ds_read_b64_tr_b16 v[230:231], v247 offset:4256
    v_add_u32 v241, s15, v241
    v_exp_f32 v249, v188
    s_waitcnt lgkmcnt(8)
    v_mfma_f32_16x16x32_bf16 v[8:11], v[232:235], v[196:199], v[8:11]
    v_exp_f32 v250, v189
    s_nop 0
    v_cvt_pk_bf16_f32 v212, v249, v250
    v_mfma_f32_16x16x32_bf16 v[40:43], v[232:235], v[200:203], v[40:43]
    v_add_u32 v242, s15, v242
    v_exp_f32 v249, v190
    v_mfma_f32_16x16x32_bf16 v[12:15], v[236:239], v[196:199], v[12:15]
    v_exp_f32 v250, v191
    s_nop 0
    v_cvt_pk_bf16_f32 v213, v249, v250
    v_mfma_f32_16x16x32_bf16 v[44:47], v[236:239], v[200:203], v[44:47]
    v_add_u32 v243, s15, v243
    v_exp_f32 v249, v176
    s_waitcnt lgkmcnt(0)
    s_waitcnt vmcnt(8)
    s_barrier
    ds_read_b128 v[232:235], v240 offset:4224
    ds_read_b128 v[236:239], v241 offset:4224
    v_mfma_f32_16x16x32_bf16 v[16:19], v[216:219], v[196:199], v[16:19]
    v_exp_f32 v250, v177
    s_nop 0
    v_cvt_pk_bf16_f32 v206, v249, v250
    v_mfma_f32_16x16x32_bf16 v[48:51], v[216:219], v[200:203], v[48:51]
    v_exp_f32 v249, v178
    ds_read_b128 v[216:219], v240 offset:0
    v_mfma_f32_16x16x32_bf16 v[20:23], v[220:223], v[196:199], v[20:23]
    v_exp_f32 v250, v179
    s_nop 0
    v_cvt_pk_bf16_f32 v207, v249, v250
    v_mfma_f32_16x16x32_bf16 v[52:55], v[220:223], v[200:203], v[52:55]
    v_exp_f32 v249, v184
    ds_read_b128 v[220:223], v241 offset:0
    v_mfma_f32_16x16x32_bf16 v[24:27], v[224:227], v[196:199], v[24:27]
    v_exp_f32 v250, v185
    s_nop 0
    v_cvt_pk_bf16_f32 v210, v249, v250
    v_mfma_f32_16x16x32_bf16 v[56:59], v[224:227], v[200:203], v[56:59]
    v_exp_f32 v249, v186
    ds_read_b128 v[224:227], v242 offset:0
    v_mfma_f32_16x16x32_bf16 v[28:31], v[228:231], v[196:199], v[28:31]
    v_exp_f32 v250, v187
    s_nop 0
    v_cvt_pk_bf16_f32 v211, v249, v250
    v_mfma_f32_16x16x32_bf16 v[60:63], v[228:231], v[200:203], v[60:63]
    v_exp_f32 v249, v192
    ds_read_b128 v[228:231], v243 offset:0
    v_exp_f32 v250, v193
    s_nop 0
    v_cvt_pk_bf16_f32 v214, v249, v250
    v_exp_f32 v249, v194
    v_exp_f32 v250, v195
    s_nop 0
    v_cvt_pk_bf16_f32 v215, v249, v250
    v_or3_b32 v251, v204, v205, v206
    v_or3_b32 v251, v207, v208, v251
    v_or3_b32 v251, v209, v210, v251
    v_or3_b32 v251, v211, v212, v251
    v_or3_b32 v251, v213, v214, v251
    v_or_b32 v251, v215, v251
    v_and_b32 v251, 0x40004000, v251
    v_cmp_ne_u32 vcc, 0, v251
    s_cbranch_vccnz L_lp3_A_rare
    s_branch L_lp3_next
L_lp3_B:
    s_waitcnt lgkmcnt(2)
    v_mfma_f32_16x16x32_bf16 v[172:175], v[216:219], v[96:99], v[156:159]
    v_add_u32 v244, s15, v244
    v_add_u32 v245, s15, v245
    v_mfma_f32_16x16x32_bf16 v[180:183], v[216:219], v[112:115], v[160:163]
    ds_read_b128 v[216:219], v242 offset:4224
    v_mfma_f32_16x16x32_bf16 v[172:175], v[220:223], v[100:103], v[172:175]
    v_add_u32 v246, s15, v246
    v_add_u32 v247, s15, v247
    v_mfma_f32_16x16x32_bf16 v[180:183], v[220:223], v[116:119], v[180:183]
    ds_read_b128 v[220:223], v243 offset:4224
    s_waitcnt lgkmcnt(2)
    v_mfma_f32_16x16x32_bf16 v[172:175], v[224:227], v[104:107], v[172:175]
    s_add_u32 m0, s14, 0
    s_mov_b32 s73, s55
    buffer_load_dwordx4 v248, s[40:43], s73 offen nt lds
    v_mfma_f32_16x16x32_bf16 v[180:183], v[224:227], v[120:123], v[180:183]
    ds_read_b64_tr_b16 v[224:225], v244 offset:0
    ds_read_b64_tr_b16 v[226:227], v244 offset:4224
    v_mfma_f32_16x16x32_bf16 v[172:175], v[228:231], v[108:111], v[172:175]
    s_add_u32 m0, s14, 32
    s_add_u32 s55, s55, 8192
    buffer_load_dwordx4 v248, s[40:43], s73 offen offset:1024 nt lds
    v_mfma_f32_16x16x32_bf16 v[180:183], v[228:231], v[124:127], v[180:183]
    ds_read_b64_tr_b16 v[228:229], v244 offset:32
    ds_read_b64_tr_b16 v[230:231], v244 offset:4256
    s_add_u32 s16, s16, s17
    s_cmp_eq_u32 s16, 135168
    s_cselect_b32 s15, s18, s17
    s_cselect_b32 s16, 0, s16
    v_mfma_f32_16x16x32_bf16 v[176:179], v[232:235], v[96:99], v[156:159]
    s_add_u32 m0, s14, 8448
    s_mov_b32 s73, s56
    buffer_load_dwordx4 v248, s[44:47], s73 offen nt lds
    v_mfma_f32_16x16x32_bf16 v[184:187], v[232:235], v[112:115], v[160:163]
    ds_read_b64_tr_b16 v[232:233], v245 offset:0
    ds_read_b64_tr_b16 v[234:235], v245 offset:4224
    v_mfma_f32_16x16x32_bf16 v[176:179], v[236:239], v[100:103], v[176:179]
    v_exp_f32 v249, v172
    v_mfma_f32_16x16x32_bf16 v[184:187], v[236:239], v[116:119], v[184:187]
    ds_read_b64_tr_b16 v[236:237], v245 offset:32
    ds_read_b64_tr_b16 v[238:239], v245 offset:4256
    s_waitcnt lgkmcnt(8)
    v_mfma_f32_16x16x32_bf16 v[176:179], v[216:219], v[104:107], v[176:179]
    v_exp_f32 v250, v173
    v_mfma_f32_16x16x32_bf16 v[184:187], v[216:219], v[120:123], v[184:187]
    ds_read_b64_tr_b16 v[216:217], v246 offset:0
    ds_read_b64_tr_b16 v[218:219], v246 offset:4224
    v_mfma_f32_16x16x32_bf16 v[176:179], v[220:223], v[108:111], v[176:179]
    v_cvt_pk_bf16_f32 v204, v249, v250
    v_mfma_f32_16x16x32_bf16 v[184:187], v[220:223], v[124:127], v[184:187]
    ds_read_b64_tr_b16 v[220:221], v246 offset:32
    ds_read_b64_tr_b16 v[222:223], v246 offset:4256
    v_mfma_f32_16x16x32_bf16 v[144:147], v[168:171], v[196:199], v[144:147]
    v_exp_f32 v249, v174
    s_add_u32 m0, s14, 8480
    s_add_u32 s56, s56, 8192
    buffer_load_dwordx4 v248, s[44:47], s73 offen offset:1024 nt lds
    s_add_u32 s14, s14, 33792
    s_cmp_ge_u32 s14, 135680
    s_cselect_b32 s73, 135168, 0
    s_sub_u32 s14, s14, s73
    v_mfma_f32_16x16x32_bf16 v[148:151], v[168:171], v[200:203], v[148:151]
    v_exp_f32 v250, v175
    v_mfma_f32_16x16x32_bf16 v[152:155], v[168:171], v[212:215], v[152:155]
    v_cvt_pk_bf16_f32 v205, v249, v250
    s_waitcnt lgkmcnt(8)
    v_mfma_f32_16x16x32_bf16 v[0:3], v[224:227], v[196:199], v[0:3]
    v_exp_f32 v249, v180
    v_mfma_f32_16x16x32_bf16 v[32:35], v[224:227], v[200:203], v[32:35]
    v_exp_f32 v250, v181
    v_mfma_f32_16x16x32_bf16 v[64:67], v[224:227], v[212:215], v[64:67]
    ds_read_b64_tr_b16 v[224:225], v247 offset:0
    ds_read_b64_tr_b16 v[226:227], v247 offset:4224
    v_add_u32 v240, s15, v240
    v_cvt_pk_bf16_f32 v208, v249, v250
    v_mfma_f32_16x16x32_bf16 v[4:7], v[228:231], v[196:199], v[4:7]
    v_exp_f32 v249, v182
    v_mfma_f32_16x16x32_bf16 v[36:39], v[228:231], v[200:203], v[36:39]
    v_exp_f32 v250, v183
    v_mfma_f32_16x16x32_bf16 v[68:71], v[228:231], v[212:215], v[68:71]
    ds_read_b64_tr_b16 v[228:229], v247 offset:32
    ds_read_b64_tr_b16 v[230:231], v247 offset:4256
    v_add_u32 v241, s15, v241
    v_cvt_pk_bf16_f32 v209, v249, v250
    s_waitcnt lgkmcnt(8)
    v_mfma_f32_16x16x32_bf16 v[8:11], v[232:235], v[196:199], v[8:11]
    v_exp_f32 v249, v176
    v_exp_f32 v250, v177
    v_mfma_f32_16x16x32_bf16 v[40:43], v[232:235], v[200:203], v[40:43]
    v_cvt_pk_bf16_f32 v206, v249, v250
    v_exp_f32 v249, v178
    v_mfma_f32_16x16x32_bf16 v[72:75], v[232:235], v[212:215], v[72:75]
    v_add_u32 v242, s15, v242
    v_exp_f32 v250, v179
    v_mfma_f32_16x16x32_bf16 v[12:15], v[236:239], v[196:199], v[12:15]
    v_cvt_pk_bf16_f32 v207, v249, v250
    v_exp_f32 v249, v184
    v_mfma_f32_16x16x32_bf16 v[44:47], v[236:239], v[200:203], v[44:47]
    v_exp_f32 v250, v185
    s_nop 0
    v_cvt_pk_bf16_f32 v210, v249, v250
    v_mfma_f32_16x16x32_bf16 v[76:79], v[236:239], v[212:215], v[76:79]
    v_add_u32 v243, s15, v243
    v_exp_f32 v249, v186
    s_waitcnt lgkmcnt(0)
    s_waitcnt vmcnt(8)
    s_barrier
    ds_read_b128 v[232:235], v240 offset:4224
    ds_read_b128 v[236:239], v241 offset:4224
    v_mfma_f32_16x16x32_bf16 v[16:19], v[216:219], v[196:199], v[16:19]
    v_exp_f32 v250, v187
    s_nop 0
    v_cvt_pk_bf16_f32 v211, v249, v250
    v_mfma_f32_16x16x32_bf16 v[48:51], v[216:219], v[200:203], v[48:51]
    v_or3_b32 v251, v204, v205, v206
    v_or3_b32 v251, v207, v208, v251
    v_mfma_f32_16x16x32_bf16 v[80:83], v[216:219], v[212:215], v[80:83]
    v_or3_b32 v251, v209, v210, v251
    ds_read_b128 v[216:219], v240 offset:0
    v_mfma_f32_16x16x32_bf16 v[20:23], v[220:223], v[196:199], v[20:23]
    v_or_b32 v251, v211, v251
    v_and_b32 v251, 0x40004000, v251
    v_mfma_f32_16x16x32_bf16 v[52:55], v[220:223], v[200:203], v[52:55]
    v_cmp_ne_u32 vcc, 0, v251
    v_mfma_f32_16x16x32_bf16 v[84:87], v[220:223], v[212:215], v[84:87]
    ds_read_b128 v[220:223], v241 offset:0
    v_mfma_f32_16x16x32_bf16 v[24:27], v[224:227], v[196:199], v[24:27]
    v_mfma_f32_16x16x32_bf16 v[56:59], v[224:227], v[200:203], v[56:59]
    v_mfma_f32_16x16x32_bf16 v[88:91], v[224:227], v[212:215], v[88:91]
    ds_read_b128 v[224:227], v242 offset:0
    v_mfma_f32_16x16x32_bf16 v[28:31], v[228:231], v[196:199], v[28:31]
    v_mfma_f32_16x16x32_bf16 v[60:63], v[228:231], v[200:203], v[60:63]
    v_mfma_f32_16x16x32_bf16 v[92:95], v[228:231], v[212:215], v[92:95]
    ds_read_b128 v[228:231], v243 offset:0
    s_cbranch_vccnz L_lp3_B_rare
L_lp3_next:
    s_cmp_eq_u32 s31, 0
    s_cbranch_scc1 L_lp4_A
    s_cmp_eq_u32 s31, 3
    s_cbranch_scc1 L_lp4_B
    s_waitcnt lgkmcnt(2)
    v_mfma_f32_16x16x32_bf16 v[172:175], v[216:219], v[96:99], v[156:159]
    v_add_u32 v244, s15, v244
    v_add_u32 v245, s15, v245
    v_mfma_f32_16x16x32_bf16 v[180:183], v[216:219], v[112:115], v[160:163]
    ds_read_b128 v[216:219], v242 offset:4224
    v_mfma_f32_16x16x32_bf16 v[172:175], v[220:223], v[100:103], v[172:175]
    v_add_u32 v246, s15, v246
    v_add_u32 v247, s15, v247
    v_mfma_f32_16x16x32_bf16 v[180:183], v[220:223], v[116:119], v[180:183]
    ds_read_b128 v[220:223], v243 offset:4224
    s_waitcnt lgkmcnt(2)
    v_mfma_f32_16x16x32_bf16 v[172:175], v[224:227], v[104:107], v[172:175]
    s_add_u32 m0, s14, 0
    s_mov_b32 s73, s55
    buffer_load_dwordx4 v248, s[40:43], s73 offen nt lds
    v_mfma_f32_16x16x32_bf16 v[180:183], v[224:227], v[120:123], v[180:183]
    ds_read_b64_tr_b16 v[224:225], v244 offset:0
    ds_read_b64_tr_b16 v[226:227], v244 offset:4224
    v_mfma_f32_16x16x32_bf16 v[172:175], v[228:231], v[108:111], v[172:175]
    s_add_u32 m0, s14, 32
    s_add_u32 s55, s55, 8192
    buffer_load_dwordx4 v248, s[40:43], s73 offen offset:1024 nt lds
    v_mfma_f32_16x16x32_bf16 v[180:183], v[228:231], v[124:127], v[180:183]
    ds_read_b64_tr_b16 v[228:229], v244 offset:32
    ds_read_b64_tr_b16 v[230:231], v244 offset:4256
    s_add_u32 s16, s16, s17
    s_cmp_eq_u32 s16, 135168
    s_cselect_b32 s15, s18, s17
    s_cselect_b32 s16, 0, s16
    v_mfma_f32_16x16x32_bf16 v[176:179], v[232:235], v[96:99], v[156:159]
    s_add_u32 m0, s14, 8448
    s_mov_b32 s73, s56
    buffer_load_dwordx4 v248, s[44:47], s73 offen nt lds
    v_mfma_f32_16x16x32_bf16 v[184:187], v[232:235], v[112:115], v[160:163]
    ds_read_b64_tr_b16 v[232:233], v245 offset:0
    ds_read_b64_tr_b16 v[234:235], v245 offset:4224
    v_mfma_f32_16x16x32_bf16 v[176:179], v[236:239], v[100:103], v[176:179]
    v_exp_f32 v249, v172
    v_mfma_f32_16x16x32_bf16 v[184:187], v[236:239], v[116:119], v[184:187]
    ds_read_b64_tr_b16 v[236:237], v245 offset:32
    ds_read_b64_tr_b16 v[238:239], v245 offset:4256
    s_waitcnt lgkmcnt(8)
    v_mfma_f32_16x16x32_bf16 v[176:179], v[216:219], v[104:107], v[176:179]
    v_exp_f32 v250, v173
    v_mfma_f32_16x16x32_bf16 v[184:187], v[216:219], v[120:123], v[184:187]
    ds_read_b64_tr_b16 v[216:217], v246 offset:0
    ds_read_b64_tr_b16 v[218:219], v246 offset:4224
    v_mfma_f32_16x16x32_bf16 v[176:179], v[220:223], v[108:111], v[176:179]
    v_cvt_pk_bf16_f32 v196, v249, v250
    v_mfma_f32_16x16x32_bf16 v[184:187], v[220:223], v[124:127], v[184:187]
    ds_read_b64_tr_b16 v[220:221], v246 offset:32
    ds_read_b64_tr_b16 v[222:223], v246 offset:4256
    v_mfma_f32_16x16x32_bf16 v[144:147], v[168:171], v[204:207], v[144:147]
    v_exp_f32 v249, v174
    s_add_u32 m0, s14, 8480
    s_add_u32 s56, s56, 8192
    buffer_load_dwordx4 v248, s[44:47], s73 offen offset:1024 nt lds
    s_add_u32 s14, s14, 33792
    s_cmp_ge_u32 s14, 135680
    s_cselect_b32 s73, 135168, 0
    s_sub_u32 s14, s14, s73
    v_mfma_f32_16x16x32_bf16 v[148:151], v[168:171], v[208:211], v[148:151]
    v_exp_f32 v250, v175
    s_waitcnt lgkmcnt(8)
    v_mfma_f32_16x16x32_bf16 v[0:3], v[224:227], v[204:207], v[0:3]
    v_cvt_pk_bf16_f32 v197, v249, v250
    v_mfma_f32_16x16x32_bf16 v[32:35], v[224:227], v[208:211], v[32:35]
    ds_read_b64_tr_b16 v[224:225], v247 offset:0
    ds_read_b64_tr_b16 v[226:227], v247 offset:4224
    v_add_u32 v240, s15, v240
    v_exp_f32 v249, v180
    v_mfma_f32_16x16x32_bf16 v[4:7], v[228:231], v[204:207], v[4:7]
    v_exp_f32 v250, v181
    v_mfma_f32_16x16x32_bf16 v[36:39], v[228:231], v[208:211], v[36:39]
    ds_read_b64_tr_b16 v[228:229], v247 offset:32
    ds_read_b64_tr_b16 v[230:231], v247 offset:4256
    v_add_u32 v241, s15, v241
    v_cvt_pk_bf16_f32 v200, v249, v250
    s_waitcnt lgkmcnt(8)
    v_mfma_f32_16x16x32_bf16 v[8:11], v[232:235], v[204:207], v[8:11]
    v_exp_f32 v249, v182
    v_exp_f32 v250, v183
    v_mfma_f32_16x16x32_bf16 v[40:43], v[232:235], v[208:211], v[40:43]
    v_add_u32 v242, s15, v242
    v_cvt_pk_bf16_f32 v201, v249, v250
    v_mfma_f32_16x16x32_bf16 v[12:15], v[236:239], v[204:207], v[12:15]
    v_exp_f32 v249, v176
    v_exp_f32 v250, v177
    v_mfma_f32_16x16x32_bf16 v[44:47], v[236:239], v[208:211], v[44:47]
    v_add_u32 v243, s15, v243
    v_cvt_pk_bf16_f32 v198, v249, v250
    s_waitcnt lgkmcnt(0)
    s_waitcnt vmcnt(8)
    s_barrier
    ds_read_b128 v[232:235], v240 offset:4224
    ds_read_b128 v[236:239], v241 offset:4224
    v_mfma_f32_16x16x32_bf16 v[16:19], v[216:219], v[204:207], v[16:19]
    v_exp_f32 v249, v178
    v_exp_f32 v250, v179
    v_mfma_f32_16x16x32_bf16 v[48:51], v[216:219], v[208:211], v[48:51]
    v_cvt_pk_bf16_f32 v199, v249, v250
    ds_read_b128 v[216:219], v240 offset:0
    v_mfma_f32_16x16x32_bf16 v[20:23], v[220:223], v[204:207], v[20:23]
    v_exp_f32 v249, v184
    v_exp_f32 v250, v185
    v_mfma_f32_16x16x32_bf16 v[52:55], v[220:223], v[208:211], v[52:55]
    v_cvt_pk_bf16_f32 v202, v249, v250
    ds_read_b128 v[220:223], v241 offset:0
    v_mfma_f32_16x16x32_bf16 v[24:27], v[224:227], v[204:207], v[24:27]
    v_exp_f32 v249, v186
    v_exp_f32 v250, v187
    v_mfma_f32_16x16x32_bf16 v[56:59], v[224:227], v[208:211], v[56:59]
    v_cvt_pk_bf16_f32 v203, v249, v250
    ds_read_b128 v[224:227], v242 offset:0
    v_mfma_f32_16x16x32_bf16 v[28:31], v[228:231], v[204:207], v[28:31]
    v_or3_b32 v251, v196, v197, v198
    v_or3_b32 v251, v199, v200, v251
    v_mfma_f32_16x16x32_bf16 v[60:63], v[228:231], v[208:211], v[60:63]
    v_or3_b32 v251, v201, v202, v251
    ds_read_b128 v[228:231], v243 offset:0
    v_or_b32 v251, v203, v251
    v_and_b32 v251, 0x40004000, v251
    v_cmp_ne_u32 vcc, 0, v251
    s_cbranch_vccnz L_lp4_C_rare
    s_branch L_lp4_next
L_lp4_A:
    s_waitcnt lgkmcnt(2)
    v_mfma_f32_16x16x32_bf16 v[172:175], v[216:219], v[96:99], v[156:159]
    v_add_u32 v244, s15, v244
    v_add_u32 v245, s15, v245
    v_mfma_f32_16x16x32_bf16 v[180:183], v[216:219], v[112:115], v[160:163]
    v_add_u32 v246, s15, v246
    v_add_u32 v247, s15, v247
    v_mfma_f32_16x16x32_bf16 v[188:191], v[216:219], v[128:131], v[164:167]
    ds_read_b128 v[216:219], v242 offset:4224
    v_mfma_f32_16x16x32_bf16 v[172:175], v[220:223], v[100:103], v[172:175]
    s_add_u32 m0, s14, 0
    s_mov_b32 s73, s55
    buffer_load_dwordx4 v248, s[40:43], s73 offen nt lds
    v_mfma_f32_16x16x32_bf16 v[180:183], v[220:223], v[116:119], v[180:183]
    s_add_u32 m0, s14, 32
    s_add_u32 s55, s55, 8192
    buffer_load_dwordx4 v248, s[40:43], s73 offen offset:1024 nt lds
    v_mfma_f32_16x16x32_bf16 v[188:191], v[220:223], v[132:135], v[188:191]
    ds_read_b128 v[220:223], v243 offset:4224
    s_waitcnt lgkmcnt(2)
    v_mfma_f32_16x16x32_bf16 v[172:175], v[224:227], v[104:107], v[172:175]
    s_add_u32 m0, s14, 8448
    s_mov_b32 s73, s56
    buffer_load_dwordx4 v248, s[44:47], s73 offen nt lds
    v_mfma_f32_16x16x32_bf16 v[180:183], v[224:227], v[120:123], v[180:183]
    s_add_u32 m0, s14, 8480
    s_add_u32 s56, s56, 8192
    buffer_load_dwordx4 v248, s[44:47], s73 offen offset:1024 nt lds
    s_add_u32 s14, s14, 33792
    s_cmp_ge_u32 s14, 135680
    s_cselect_b32 s73, 135168, 0
    s_sub_u32 s14, s14, s73
    v_mfma_f32_16x16x32_bf16 v[188:191], v[224:227], v[136:139], v[188:191]
    ds_read_b64_tr_b16 v[224:225], v244 offset:0
    ds_read_b64_tr_b16 v[226:227], v244 offset:4224
    v_mfma_f32_16x16x32_bf16 v[172:175], v[228:231], v[108:111], v[172:175]
    v_mfma_f32_16x16x32_bf16 v[180:183], v[228:231], v[124:127], v[180:183]
    v_mfma_f32_16x16x32_bf16 v[188:191], v[228:231], v[140:143], v[188:191]
    ds_read_b64_tr_b16 v[228:229], v244 offset:32
    ds_read_b64_tr_b16 v[230:231], v244 offset:4256
    s_add_u32 s16, s16, s17
    s_cmp_eq_u32 s16, 135168
    s_cselect_b32 s15, s18, s17
    s_cselect_b32 s16, 0, s16
    v_mfma_f32_16x16x32_bf16 v[176:179], v[232:235], v[96:99], v[156:159]
    v_mfma_f32_16x16x32_bf16 v[184:187], v[232:235], v[112:115], v[160:163]
    v_exp_f32 v249, v172
    v_mfma_f32_16x16x32_bf16 v[192:195], v[232:235], v[128:131], v[164:167]
    ds_read_b64_tr_b16 v[232:233], v245 offset:0
    ds_read_b64_tr_b16 v[234:235], v245 offset:4224
    v_mfma_f32_16x16x32_bf16 v[176:179], v[236:239], v[100:103], v[176:179]
    v_exp_f32 v250, v173
    v_mfma_f32_16x16x32_bf16 v[184:187], v[236:239], v[116:119], v[184:187]
    v_cvt_pk_bf16_f32 v196, v249, v250
    v_mfma_f32_16x16x32_bf16 v[192:195], v[236:239], v[132:135], v[192:195]
    ds_read_b64_tr_b16 v[236:237], v245 offset:32
    ds_read_b64_tr_b16 v[238:239], v245 offset:4256
    s_waitcnt lgkmcnt(8)
    v_mfma_f32_16x16x32_bf16 v[176:179], v[216:219], v[104:107], v[176:179]
    v_exp_f32 v249, v174
    v_mfma_f32_16x16x32_bf16 v[184:187], v[216:219], v[120:123], v[184:187]
    v_exp_f32 v250, v175
    v_mfma_f32_16x16x32_bf16 v[192:195], v[216:219], v[136:139], v[192:195]
    ds_read_b64_tr_b16 v[216:217], v246 offset:0
    ds_read_b64_tr_b16 v[218:219], v246 offset:4224
    v_mfma_f32_16x16x32_bf16 v[176:179], v[220:223], v[108:111], v[176:179]
    v_cvt_pk_bf16_f32 v197, v249, v250
    v_mfma_f32_16x16x32_bf16 v[184:187], v[220:223], v[124:127], v[184:187]
    v_exp_f32 v249, v180
    v_mfma_f32_16x16x32_bf16 v[192:195], v[220:223], v[140:143], v[192:195]
    ds_read_b64_tr_b16 v[220:221], v246 offset:32
    ds_read_b64_tr_b16 v[222:223], v246 offset:4256
    v_mfma_f32_16x16x32_bf16 v[144:147], v[168:171], v[204:207], v[144:147]
    v_exp_f32 v250, v181
    v_mfma_f32_16x16x32_bf16 v[148:151], v[168:171], v[208:211], v[148:151]
    v_cvt_pk_bf16_f32 v200, v249, v250
    s_waitcnt lgkmcnt(8)
    v_mfma_f32_16x16x32_bf16 v[0:3], v[224:227], v[204:207], v[0:3]
    v_exp_f32 v249, v182
    v_mfma_f32_16x16x32_bf16 v[32:35], v[224:227], v[208:211], v[32:35]
    ds_read_b64_tr_b16 v[224:225], v247 offset:0
    ds_read_b64_tr_b16 v[226:227], v247 offset:4224
    v_add_u32 v240, s15, v240
    v_exp_f32 v250, v183
    v_mfma_f32_16x16x32_bf16 v[4:7], v[228:231], v[204:207], v[4:7]
    v_cvt_pk_bf16_f32 v201, v249, v250
    v_mfma_f32_16x16x32_bf16 v[36:39], v[228:231], v[208:211], v[36:39]
    ds_read_b64_tr_b16 v[228:229], v247 offset:32
    ds_read_b64_tr_b16 v[230:231], v247 offset:4256
    v_add_u32 v241, s15, v241
    v_exp_f32 v249, v188
    s_waitcnt lgkmcnt(8)
    v_mfma_f32_16x16x32_bf16 v[8:11], v[232:235], v[204:207], v[8:11]
    v_exp_f32 v250, v189
    s_nop 0
    v_cvt_pk_bf16_f32 v212, v249, v250
    v_mfma_f32_16x16x32_bf16 v[40:43], v[232:235], v[208:211], v[40:43]
    v_add_u32 v242, s15, v242
    v_exp_f32 v249, v190
    v_mfma_f32_16x16x32_bf16 v[12:15], v[236:239], v[204:207], v[12:15]
    v_exp_f32 v250, v191
    s_nop 0
    v_cvt_pk_bf16_f32 v213, v249, v250
    v_mfma_f32_16x16x32_bf16 v[44:47], v[236:239], v[208:211], v[44:47]
    v_add_u32 v243, s15, v243
    v_exp_f32 v249, v176
    s_waitcnt lgkmcnt(0)
    s_waitcnt vmcnt(8)
    s_barrier
    ds_read_b128 v[232:235], v240 offset:4224
    ds_read_b128 v[236:239], v241 offset:4224
    v_mfma_f32_16x16x32_bf16 v[16:19], v[216:219], v[204:207], v[16:19]
    v_exp_f32 v250, v177
    s_nop 0
    v_cvt_pk_bf16_f32 v198, v249, v250
    v_mfma_f32_16x16x32_bf16 v[48:51], v[216:219], v[208:211], v[48:51]
    v_exp_f32 v249, v178
    ds_read_b128 v[216:219], v240 offset:0
    v_mfma_f32_16x16x32_bf16 v[20:23], v[220:223], v[204:207], v[20:23]
    v_exp_f32 v250, v179
    s_nop 0
    v_cvt_pk_bf16_f32 v199, v249, v250
    v_mfma_f32_16x16x32_bf16 v[52:55], v[220:223], v[208:211], v[52:55]
    v_exp_f32 v249, v184
    ds_read_b128 v[220:223], v241 offset:0
    v_mfma_f32_16x16x32_bf16 v[24:27], v[224:227], v[204:207], v[24:27]
    v_exp_f32 v250, v185
    s_nop 0
    v_cvt_pk_bf16_f32 v202, v249, v250
    v_mfma_f32_16x16x32_bf16 v[56:59], v[224:227], v[208:211], v[56:59]
    v_exp_f32 v249, v186
    ds_read_b128 v[224:227], v242 offset:0
    v_mfma_f32_16x16x32_bf16 v[28:31], v[228:231], v[204:207], v[28:31]
    v_exp_f32 v250, v187
    s_nop 0
    v_cvt_pk_bf16_f32 v203, v249, v250
    v_mfma_f32_16x16x32_bf16 v[60:63], v[228:231], v[208:211], v[60:63]
    v_exp_f32 v249, v192
    ds_read_b128 v[228:231], v243 offset:0
    v_exp_f32 v250, v193
    s_nop 0
    v_cvt_pk_bf16_f32 v214, v249, v250
    v_exp_f32 v249, v194
    v_exp_f32 v250, v195
    s_nop 0
    v_cvt_pk_bf16_f32 v215, v249, v250
    v_or3_b32 v251, v196, v197, v198
    v_or3_b32 v251, v199, v200, v251
    v_or3_b32 v251, v201, v202, v251
    v_or3_b32 v251, v203, v212, v251
    v_or3_b32 v251, v213, v214, v251
    v_or_b32 v251, v215, v251
    v_and_b32 v251, 0x40004000, v251
    v_cmp_ne_u32 vcc, 0, v251
    s_cbranch_vccnz L_lp4_A_rare
    s_branch L_lp4_next
L_lp4_B:
    s_waitcnt lgkmcnt(2)
    v_mfma_f32_16x16x32_bf16 v[172:175], v[216:219], v[96:99], v[156:159]
    v_add_u32 v244, s15, v244
    v_add_u32 v245, s15, v245
    v_mfma_f32_16x16x32_bf16 v[180:183], v[216:219], v[112:115], v[160:163]
    ds_read_b128 v[216:219], v242 offset:4224
    v_mfma_f32_16x16x32_bf16 v[172:175], v[220:223], v[100:103], v[172:175]
    v_add_u32 v246, s15, v246
    v_add_u32 v247, s15, v247
    v_mfma_f32_16x16x32_bf16 v[180:183], v[220:223], v[116:119], v[180:183]
    ds_read_b128 v[220:223], v243 offset:4224
    s_waitcnt lgkmcnt(2)
    v_mfma_f32_16x16x32_bf16 v[172:175], v[224:227], v[104:107], v[172:175]
    s_add_u32 m0, s14, 0
    s_mov_b32 s73, s55
    buffer_load_dwordx4 v248, s[40:43], s73 offen nt lds
    v_mfma_f32_16x16x32_bf16 v[180:183], v[224:227], v[120:123], v[180:183]
    ds_read_b64_tr_b16 v[224:225], v244 offset:0
    ds_read_b64_tr_b16 v[226:227], v244 offset:4224
    v_mfma_f32_16x16x32_bf16 v[172:175], v[228:231], v[108:111], v[172:175]
    s_add_u32 m0, s14, 32
    s_add_u32 s55, s55, 8192
    buffer_load_dwordx4 v248, s[40:43], s73 offen offset:1024 nt lds
    v_mfma_f32_16x16x32_bf16 v[180:183], v[228:231], v[124:127], v[180:183]
    ds_read_b64_tr_b16 v[228:229], v244 offset:32
    ds_read_b64_tr_b16 v[230:231], v244 offset:4256
    s_add_u32 s16, s16, s17
    s_cmp_eq_u32 s16, 135168
    s_cselect_b32 s15, s18, s17
    s_cselect_b32 s16, 0, s16
    v_mfma_f32_16x16x32_bf16 v[176:179], v[232:235], v[96:99], v[156:159]
    s_add_u32 m0, s14, 8448
    s_mov_b32 s73, s56
    buffer_load_dwordx4 v248, s[44:47], s73 offen nt lds
    v_mfma_f32_16x16x32_bf16 v[184:187], v[232:235], v[112:115], v[160:163]
    ds_read_b64_tr_b16 v[232:233], v245 offset:0
    ds_read_b64_tr_b16 v[234:235], v245 offset:4224
    v_mfma_f32_16x16x32_bf16 v[176:179], v[236:239], v[100:103], v[176:179]
    v_exp_f32 v249, v172
    v_mfma_f32_16x16x32_bf16 v[184:187], v[236:239], v[116:119], v[184:187]
    ds_read_b64_tr_b16 v[236:237], v245 offset:32
    ds_read_b64_tr_b16 v[238:239], v245 offset:4256
    s_waitcnt lgkmcnt(8)
    v_mfma_f32_16x16x32_bf16 v[176:179], v[216:219], v[104:107], v[176:179]
    v_exp_f32 v250, v173
    v_mfma_f32_16x16x32_bf16 v[184:187], v[216:219], v[120:123], v[184:187]
    ds_read_b64_tr_b16 v[216:217], v246 offset:0
    ds_read_b64_tr_b16 v[218:219], v246 offset:4224
    v_mfma_f32_16x16x32_bf16 v[176:179], v[220:223], v[108:111], v[176:179]
    v_cvt_pk_bf16_f32 v196, v249, v250
    v_mfma_f32_16x16x32_bf16 v[184:187], v[220:223], v[124:127], v[184:187]
    ds_read_b64_tr_b16 v[220:221], v246 offset:32
    ds_read_b64_tr_b16 v[222:223], v246 offset:4256
    v_mfma_f32_16x16x32_bf16 v[144:147], v[168:171], v[204:207], v[144:147]
    v_exp_f32 v249, v174
    s_add_u32 m0, s14, 8480
    s_add_u32 s56, s56, 8192
    buffer_load_dwordx4 v248, s[44:47], s73 offen offset:1024 nt lds
    s_add_u32 s14, s14, 33792
    s_cmp_ge_u32 s14, 135680
    s_cselect_b32 s73, 135168, 0
    s_sub_u32 s14, s14, s73
    v_mfma_f32_16x16x32_bf16 v[148:151], v[168:171], v[208:211], v[148:151]
    v_exp_f32 v250, v175
    v_mfma_f32_16x16x32_bf16 v[152:155], v[168:171], v[212:215], v[152:155]
    v_cvt_pk_bf16_f32 v197, v249, v250
    s_waitcnt lgkmcnt(8)
    v_mfma_f32_16x16x32_bf16 v[0:3], v[224:227], v[204:207], v[0:3]
    v_exp_f32 v249, v180
    v_mfma_f32_16x16x32_bf16 v[32:35], v[224:227], v[208:211], v[32:35]
    v_exp_f32 v250, v181
    v_mfma_f32_16x16x32_bf16 v[64:67], v[224:227], v[212:215], v[64:67]
    ds_read_b64_tr_b16 v[224:225], v247 offset:0
    ds_read_b64_tr_b16 v[226:227], v247 offset:4224
    v_add_u32 v240, s15, v240
    v_cvt_pk_bf16_f32 v200, v249, v250
    v_mfma_f32_16x16x32_bf16 v[4:7], v[228:231], v[204:207], v[4:7]
    v_exp_f32 v249, v182
    v_mfma_f32_16x16x32_bf16 v[36:39], v[228:231], v[208:211], v[36:39]
    v_exp_f32 v250, v183
    v_mfma_f32_16x16x32_bf16 v[68:71], v[228:231], v[212:215], v[68:71]
    ds_read_b64_tr_b16 v[228:229], v247 offset:32
    ds_read_b64_tr_b16 v[230:231], v247 offset:4256
    v_add_u32 v241, s15, v241
    v_cvt_pk_bf16_f32 v201, v249, v250
    s_waitcnt lgkmcnt(8)
    v_mfma_f32_16x16x32_bf16 v[8:11], v[232:235], v[204:207], v[8:11]
    v_exp_f32 v249, v176
    v_exp_f32 v250, v177
    v_mfma_f32_16x16x32_bf16 v[40:43], v[232:235], v[208:211], v[40:43]
    v_cvt_pk_bf16_f32 v198, v249, v250
    v_exp_f32 v249, v178
    v_mfma_f32_16x16x32_bf16 v[72:75], v[232:235], v[212:215], v[72:75]
    v_add_u32 v242, s15, v242
    v_exp_f32 v250, v179
    v_mfma_f32_16x16x32_bf16 v[12:15], v[236:239], v[204:207], v[12:15]
    v_cvt_pk_bf16_f32 v199, v249, v250
    v_exp_f32 v249, v184
    v_mfma_f32_16x16x32_bf16 v[44:47], v[236:239], v[208:211], v[44:47]
    v_exp_f32 v250, v185
    s_nop 0
    v_cvt_pk_bf16_f32 v202, v249, v250
    v_mfma_f32_16x16x32_bf16 v[76:79], v[236:239], v[212:215], v[76:79]
    v_add_u32 v243, s15, v243
    v_exp_f32 v249, v186
    s_waitcnt lgkmcnt(0)
    s_waitcnt vmcnt(8)
    s_barrier
    ds_read_b128 v[232:235], v240 offset:4224
    ds_read_b128 v[236:239], v241 offset:4224
    v_mfma_f32_16x16x32_bf16 v[16:19], v[216:219], v[204:207], v[16:19]
    v_exp_f32 v250, v187
    s_nop 0
    v_cvt_pk_bf16_f32 v203, v249, v250
    v_mfma_f32_16x16x32_bf16 v[48:51], v[216:219], v[208:211], v[48:51]
    v_or3_b32 v251, v196, v197, v198
    v_or3_b32 v251, v199, v200, v251
    v_mfma_f32_16x16x32_bf16 v[80:83], v[216:219], v[212:215], v[80:83]
    v_or3_b32 v251, v201, v202, v251
    ds_read_b128 v[216:219], v240 offset:0
    v_mfma_f32_16x16x32_bf16 v[20:23], v[220:223], v[204:207], v[20:23]
    v_or_b32 v251, v203, v251
    v_and_b32 v251, 0x40004000, v251
    v_mfma_f32_16x16x32_bf16 v[52:55], v[220:223], v[208:211], v[52:55]
    v_cmp_ne_u32 vcc, 0, v251
    v_mfma_f32_16x16x32_bf16 v[84:87], v[220:223], v[212:215], v[84:87]
    ds_read_b128 v[220:223], v241 offset:0
    v_mfma_f32_16x16x32_bf16 v[24:27], v[224:227], v[204:207], v[24:27]
    v_mfma_f32_16x16x32_bf16 v[56:59], v[224:227], v[208:211], v[56:59]
    v_mfma_f32_16x16x32_bf16 v[88:91], v[224:227], v[212:215], v[88:91]
    ds_read_b128 v[224:227], v242 offset:0
    v_mfma_f32_16x16x32_bf16 v[28:31], v[228:231], v[204:207], v[28:31]
    v_mfma_f32_16x16x32_bf16 v[60:63], v[228:231], v[208:211], v[60:63]
    v_mfma_f32_16x16x32_bf16 v[92:95], v[228:231], v[212:215], v[92:95]
    ds_read_b128 v[228:231], v243 offset:0
    s_cbranch_vccnz L_lp4_B_rare
L_lp4_next:
    s_cmp_eq_u32 s31, 1
    s_cbranch_scc1 L_lp5_A
    s_cmp_eq_u32 s31, 0
    s_cbranch_scc1 L_lp5_B
    s_waitcnt lgkmcnt(2)
    v_mfma_f32_16x16x32_bf16 v[172:175], v[216:219], v[96:99], v[156:159]
    v_add_u32 v244, s15, v244
    v_add_u32 v245, s15, v245
    v_mfma_f32_16x16x32_bf16 v[180:183], v[216:219], v[112:115], v[160:163]
    ds_read_b128 v[216:219], v242 offset:4224
    v_mfma_f32_16x16x32_bf16 v[172:175], v[220:223], v[100:103], v[172:175]
    v_add_u32 v246, s15, v246
    v_add_u32 v247, s15, v247
    v_mfma_f32_16x16x32_bf16 v[180:183], v[220:223], v[116:119], v[180:183]
    ds_read_b128 v[220:223], v243 offset:4224
    s_waitcnt lgkmcnt(2)
    v_mfma_f32_16x16x32_bf16 v[172:175], v[224:227], v[104:107], v[172:175]
    s_add_u32 m0, s14, 0
    s_mov_b32 s73, s55
    buffer_load_dwordx4 v248, s[40:43], s73 offen nt lds
    v_mfma_f32_16x16x32_bf16 v[180:183], v[224:227], v[120:123], v[180:183]
    ds_read_b64_tr_b16 v[224:225], v244 offset:0
    ds_read_b64_tr_b16 v[226:227], v244 offset:4224
    v_mfma_f32_16x16x32_bf16 v[172:175], v[228:231], v[108:111], v[172:175]
    s_add_u32 m0, s14, 32
    s_add_u32 s55, s55, 8192
    buffer_load_dwordx4 v248, s[40:43], s73 offen offset:1024 nt lds
    v_mfma_f32_16x16x32_bf16 v[180:183], v[228:231], v[124:127], v[180:183]
    ds_read_b64_tr_b16 v[228:229], v244 offset:32
    ds_read_b64_tr_b16 v[230:231], v244 offset:4256
    s_add_u32 s16, s16, s17
    s_cmp_eq_u32 s16, 135168
    s_cselect_b32 s15, s18, s17
    s_cselect_b32 s16, 0, s16
    v_mfma_f32_16x16x32_bf16 v[176:179], v[232:235], v[96:99], v[156:159]
    s_add_u32 m0, s14, 8448
    s_mov_b32 s73, s56
    buffer_load_dwordx4 v248, s[44:47], s73 offen nt lds
    v_mfma_f32_16x16x32_bf16 v[184:187], v[232:235], v[112:115], v[160:163]
    ds_read_b64_tr_b16 v[232:233], v245 offset:0
    ds_read_b64_tr_b16 v[234:235], v245 offset:4224
    v_mfma_f32_16x16x32_bf16 v[176:179], v[236:239], v[100:103], v[176:179]
    v_exp_f32 v249, v172
    v_mfma_f32_16x16x32_bf16 v[184:187], v[236:239], v[116:119], v[184:187]
    ds_read_b64_tr_b16 v[236:237], v245 offset:32
    ds_read_b64_tr_b16 v[238:239], v245 offset:4256
    s_waitcnt lgkmcnt(8)
    v_mfma_f32_16x16x32_bf16 v[176:179], v[216:219], v[104:107], v[176:179]
    v_exp_f32 v250, v173
    v_mfma_f32_16x16x32_bf16 v[184:187], v[216:219], v[120:123], v[184:187]
    ds_read_b64_tr_b16 v[216:217], v246 offset:0
    ds_read_b64_tr_b16 v[218:219], v246 offset:4224
    v_mfma_f32_16x16x32_bf16 v[176:179], v[220:223], v[108:111], v[176:179]
    v_cvt_pk_bf16_f32 v204, v249, v250
    v_mfma_f32_16x16x32_bf16 v[184:187], v[220:223], v[124:127], v[184:187]
    ds_read_b64_tr_b16 v[220:221], v246 offset:32
    ds_read_b64_tr_b16 v[222:223], v246 offset:4256
    v_mfma_f32_16x16x32_bf16 v[144:147], v[168:171], v[196:199], v[144:147]
    v_exp_f32 v249, v174
    s_add_u32 m0, s14, 8480
    s_add_u32 s56, s56, 8192
    buffer_load_dwordx4 v248, s[44:47], s73 offen offset:1024 nt lds
    s_add_u32 s14, s14, 33792
    s_cmp_ge_u32 s14, 135680
    s_cselect_b32 s73, 135168, 0
    s_sub_u32 s14, s14, s73
    v_mfma_f32_16x16x32_bf16 v[148:151], v[168:171], v[200:203], v[148:151]
    v_exp_f32 v250, v175
    s_waitcnt lgkmcnt(8)
    v_mfma_f32_16x16x32_bf16 v[0:3], v[224:227], v[196:199], v[0:3]
    v_cvt_pk_bf16_f32 v205, v249, v250
    v_mfma_f32_16x16x32_bf16 v[32:35], v[224:227], v[200:203], v[32:35]
    ds_read_b64_tr_b16 v[224:225], v247 offset:0
    ds_read_b64_tr_b16 v[226:227], v247 offset:4224
    v_add_u32 v240, s15, v240
    v_exp_f32 v249, v180
    v_mfma_f32_16x16x32_bf16 v[4:7], v[228:231], v[196:199], v[4:7]
    v_exp_f32 v250, v181
    v_mfma_f32_16x16x32_bf16 v[36:39], v[228:231], v[200:203], v[36:39]
    ds_read_b64_tr_b16 v[228:229], v247 offset:32
    ds_read_b64_tr_b16 v[230:231], v247 offset:4256
    v_add_u32 v241, s15, v241
    v_cvt_pk_bf16_f32 v208, v249, v250
    s_waitcnt lgkmcnt(8)
    v_mfma_f32_16x16x32_bf16 v[8:11], v[232:235], v[196:199], v[8:11]
    v_exp_f32 v249, v182
    v_exp_f32 v250, v183
    v_mfma_f32_16x16x32_bf16 v[40:43], v[232:235], v[200:203], v[40:43]
    v_add_u32 v242, s15, v242
    v_cvt_pk_bf16_f32 v209, v249, v250
    v_mfma_f32_16x16x32_bf16 v[12:15], v[236:239], v[196:199], v[12:15]
    v_exp_f32 v249, v176
    v_exp_f32 v250, v177
    v_mfma_f32_16x16x32_bf16 v[44:47], v[236:239], v[200:203], v[44:47]
    v_add_u32 v243, s15, v243
    v_cvt_pk_bf16_f32 v206, v249, v250
    s_waitcnt lgkmcnt(0)
    s_waitcnt vmcnt(8)
    s_barrier
    ds_read_b128 v[232:235], v240 offset:4224
    ds_read_b128 v[236:239], v241 offset:4224
    v_mfma_f32_16x16x32_bf16 v[16:19], v[216:219], v[196:199], v[16:19]
    v_exp_f32 v249, v178
    v_exp_f32 v250, v179
    v_mfma_f32_16x16x32_bf16 v[48:51], v[216:219], v[200:203], v[48:51]
    v_cvt_pk_bf16_f32 v207, v249, v250
    ds_read_b128 v[216:219], v240 offset:0
    v_mfma_f32_16x16x32_bf16 v[20:23], v[220:223], v[196:199], v[20:23]
    v_exp_f32 v249, v184
    v_exp_f32 v250, v185
    v_mfma_f32_16x16x32_bf16 v[52:55], v[220:223], v[200:203], v[52:55]
    v_cvt_pk_bf16_f32 v210, v249, v250
    ds_read_b128 v[220:223], v241 offset:0
    v_mfma_f32_16x16x32_bf16 v[24:27], v[224:227], v[196:199], v[24:27]
    v_exp_f32 v249, v186
    v_exp_f32 v250, v187
    v_mfma_f32_16x16x32_bf16 v[56:59], v[224:227], v[200:203], v[56:59]
    v_cvt_pk_bf16_f32 v211, v249, v250
    ds_read_b128 v[224:227], v242 offset:0
    v_mfma_f32_16x16x32_bf16 v[28:31], v[228:231], v[196:199], v[28:31]
    v_or3_b32 v251, v204, v205, v206
    v_or3_b32 v251, v207, v208, v251
    v_mfma_f32_16x16x32_bf16 v[60:63], v[228:231], v[200:203], v[60:63]
    v_or3_b32 v251, v209, v210, v251
    ds_read_b128 v[228:231], v243 offset:0
    v_or_b32 v251, v211, v251
    v_and_b32 v251, 0x40004000, v251
    v_cmp_ne_u32 vcc, 0, v251
    s_cbranch_vccnz L_lp5_C_rare
    s_branch L_lp5_next
L_lp5_A:
    s_waitcnt lgkmcnt(2)
    v_mfma_f32_16x16x32_bf16 v[172:175], v[216:219], v[96:99], v[156:159]
    v_add_u32 v244, s15, v244
    v_add_u32 v245, s15, v245
    v_mfma_f32_16x16x32_bf16 v[180:183], v[216:219], v[112:115], v[160:163]
    v_add_u32 v246, s15, v246
    v_add_u32 v247, s15, v247
    v_mfma_f32_16x16x32_bf16 v[188:191], v[216:219], v[128:131], v[164:167]
    ds_read_b128 v[216:219], v242 offset:4224
    v_mfma_f32_16x16x32_bf16 v[172:175], v[220:223], v[100:103], v[172:175]
    s_add_u32 m0, s14, 0
    s_mov_b32 s73, s55
    buffer_load_dwordx4 v248, s[40:43], s73 offen nt lds
    v_mfma_f32_16x16x32_bf16 v[180:183], v[220:223], v[116:119], v[180:183]
    s_add_u32 m0, s14, 32
    s_add_u32 s55, s55, 8192
    buffer_load_dwordx4 v248, s[40:43], s73 offen offset:1024 nt lds
    v_mfma_f32_16x16x32_bf16 v[188:191], v[220:223], v[132:135], v[188:191]
    ds_read_b128 v[220:223], v243 offset:4224
    s_waitcnt lgkmcnt(2)
    v_mfma_f32_16x16x32_bf16 v[172:175], v[224:227], v[104:107], v[172:175]
    s_add_u32 m0, s14, 8448
    s_mov_b32 s73, s56
    buffer_load_dwordx4 v248, s[44:47], s73 offen nt lds
    v_mfma_f32_16x16x32_bf16 v[180:183], v[224:227], v[120:123], v[180:183]
    s_add_u32 m0, s14, 8480
    s_add_u32 s56, s56, 8192
    buffer_load_dwordx4 v248, s[44:47], s73 offen offset:1024 nt lds
    s_add_u32 s14, s14, 33792
    s_cmp_ge_u32 s14, 135680
    s_cselect_b32 s73, 135168, 0
    s_sub_u32 s14, s14, s73
    v_mfma_f32_16x16x32_bf16 v[188:191], v[224:227], v[136:139], v[188:191]
    ds_read_b64_tr_b16 v[224:225], v244 offset:0
    ds_read_b64_tr_b16 v[226:227], v244 offset:4224
    v_mfma_f32_16x16x32_bf16 v[172:175], v[228:231], v[108:111], v[172:175]
    v_mfma_f32_16x16x32_bf16 v[180:183], v[228:231], v[124:127], v[180:183]
    v_mfma_f32_16x16x32_bf16 v[188:191], v[228:231], v[140:143], v[188:191]
    ds_read_b64_tr_b16 v[228:229], v244 offset:32
    ds_read_b64_tr_b16 v[230:231], v244 offset:4256
    s_add_u32 s16, s16, s17
    s_cmp_eq_u32 s16, 135168
    s_cselect_b32 s15, s18, s17
    s_cselect_b32 s16, 0, s16
    v_mfma_f32_16x16x32_bf16 v[176:179], v[232:235], v[96:99], v[156:159]
    v_mfma_f32_16x16x32_bf16 v[184:187], v[232:235], v[112:115], v[160:163]
    v_exp_f32 v249, v172
    v_mfma_f32_16x16x32_bf16 v[192:195], v[232:235], v[128:131], v[164:167]
    ds_read_b64_tr_b16 v[232:233], v245 offset:0
    ds_read_b64_tr_b16 v[234:235], v245 offset:4224
    v_mfma_f32_16x16x32_bf16 v[176:179], v[236:239], v[100:103], v[176:179]
    v_exp_f32 v250, v173
    v_mfma_f32_16x16x32_bf16 v[184:187], v[236:239], v[116:119], v[184:187]
    v_cvt_pk_bf16_f32 v204, v249, v250
    v_mfma_f32_16x16x32_bf16 v[192:195], v[236:239], v[132:135], v[192:195]
    ds_read_b64_tr_b16 v[236:237], v245 offset:32
    ds_read_b64_tr_b16 v[238:239], v245 offset:4256
    s_waitcnt lgkmcnt(8)
    v_mfma_f32_16x16x32_bf16 v[176:179], v[216:219], v[104:107], v[176:179]
    v_exp_f32 v249, v174
    v_mfma_f32_16x16x32_bf16 v[184:187], v[216:219], v[120:123], v[184:187]
    v_exp_f32 v250, v175
    v_mfma_f32_16x16x32_bf16 v[192:195], v[216:219], v[136:139], v[192:195]
    ds_read_b64_tr_b16 v[216:217], v246 offset:0
    ds_read_b64_tr_b16 v[218:219], v246 offset:4224
    v_mfma_f32_16x16x32_bf16 v[176:179], v[220:223], v[108:111], v[176:179]
    v_cvt_pk_bf16_f32 v205, v249, v250
    v_mfma_f32_16x16x32_bf16 v[184:187], v[220:223], v[124:127], v[184:187]
    v_exp_f32 v249, v180
    v_mfma_f32_16x16x32_bf16 v[192:195], v[220:223], v[140:143], v[192:195]
    ds_read_b64_tr_b16 v[220:221], v246 offset:32
    ds_read_b64_tr_b16 v[222:223], v246 offset:4256
    v_mfma_f32_16x16x32_bf16 v[144:147], v[168:171], v[196:199], v[144:147]
    v_exp_f32 v250, v181
    v_mfma_f32_16x16x32_bf16 v[148:151], v[168:171], v[200:203], v[148:151]
    v_cvt_pk_bf16_f32 v208, v249, v250
    s_waitcnt lgkmcnt(8)
    v_mfma_f32_16x16x32_bf16 v[0:3], v[224:227], v[196:199], v[0:3]
    v_exp_f32 v249, v182
    v_mfma_f32_16x16x32_bf16 v[32:35], v[224:227], v[200:203], v[32:35]
    ds_read_b64_tr_b16 v[224:225], v247 offset:0
    ds_read_b64_tr_b16 v[226:227], v247 offset:4224
    v_add_u32 v240, s15, v240
    v_exp_f32 v250, v183
    v_mfma_f32_16x16x32_bf16 v[4:7], v[228:231], v[196:199], v[4:7]
    v_cvt_pk_bf16_f32 v209, v249, v250
    v_mfma_f32_16x16x32_bf16 v[36:39], v[228:231], v[200:203], v[36:39]
    ds_read_b64_tr_b16 v[228:229], v247 offset:32
    ds_read_b64_tr_b16 v[230:231], v247 offset:4256
    v_add_u32 v241, s15, v241
    v_exp_f32 v249, v188
    s_waitcnt lgkmcnt(8)
    v_mfma_f32_16x16x32_bf16 v[8:11], v[232:235], v[196:199], v[8:11]
    v_exp_f32 v250, v189
    s_nop 0
    v_cvt_pk_bf16_f32 v212, v249, v250
    v_mfma_f32_16x16x32_bf16 v[40:43], v[232:235], v[200:203], v[40:43]
    v_add_u32 v242, s15, v242
    v_exp_f32 v249, v190
    v_mfma_f32_16x16x32_bf16 v[12:15], v[236:239], v[196:199], v[12:15]
    v_exp_f32 v250, v191
    s_nop 0
    v_cvt_pk_bf16_f32 v213, v249, v250
    v_mfma_f32_16x16x32_bf16 v[44:47], v[236:239], v[200:203], v[44:47]
    v_add_u32 v243, s15, v243
    v_exp_f32 v249, v176
    s_waitcnt lgkmcnt(0)
    s_waitcnt vmcnt(8)
    s_barrier
    ds_read_b128 v[232:235], v240 offset:4224
    ds_read_b128 v[236:239], v241 offset:4224
    v_mfma_f32_16x16x32_bf16 v[16:19], v[216:219], v[196:199], v[16:19]
    v_exp_f32 v250, v177
    s_nop 0
    v_cvt_pk_bf16_f32 v206, v249, v250
    v_mfma_f32_16x16x32_bf16 v[48:51], v[216:219], v[200:203], v[48:51]
    v_exp_f32 v249, v178
    ds_read_b128 v[216:219], v240 offset:0
    v_mfma_f32_16x16x32_bf16 v[20:23], v[220:223], v[196:199], v[20:23]
    v_exp_f32 v250, v179
    s_nop 0
    v_cvt_pk_bf16_f32 v207, v249, v250
    v_mfma_f32_16x16x32_bf16 v[52:55], v[220:223], v[200:203], v[52:55]
    v_exp_f32 v249, v184
    ds_read_b128 v[220:223], v241 offset:0
    v_mfma_f32_16x16x32_bf16 v[24:27], v[224:227], v[196:199], v[24:27]
    v_exp_f32 v250, v185
    s_nop 0
    v_cvt_pk_bf16_f32 v210, v249, v250
    v_mfma_f32_16x16x32_bf16 v[56:59], v[224:227], v[200:203], v[56:59]
    v_exp_f32 v249, v186
    ds_read_b128 v[224:227], v242 offset:0
    v_mfma_f32_16x16x32_bf16 v[28:31], v[228:231], v[196:199], v[28:31]
    v_exp_f32 v250, v187
    s_nop 0
    v_cvt_pk_bf16_f32 v211, v249, v250
    v_mfma_f32_16x16x32_bf16 v[60:63], v[228:231], v[200:203], v[60:63]
    v_exp_f32 v249, v192
    ds_read_b128 v[228:231], v243 offset:0
    v_exp_f32 v250, v193
    s_nop 0
    v_cvt_pk_bf16_f32 v214, v249, v250
    v_exp_f32 v249, v194
    v_exp_f32 v250, v195
    s_nop 0
    v_cvt_pk_bf16_f32 v215, v249, v250
    v_or3_b32 v251, v204, v205, v206
    v_or3_b32 v251, v207, v208, v251
    v_or3_b32 v251, v209, v210, v251
    v_or3_b32 v251, v211, v212, v251
    v_or3_b32 v251, v213, v214, v251
    v_or_b32 v251, v215, v251
    v_and_b32 v251, 0x40004000, v251
    v_cmp_ne_u32 vcc, 0, v251
    s_cbranch_vccnz L_lp5_A_rare
    s_branch L_lp5_next
L_lp5_B:
    s_waitcnt lgkmcnt(2)
    v_mfma_f32_16x16x32_bf16 v[172:175], v[216:219], v[96:99], v[156:159]
    v_add_u32 v244, s15, v244
    v_add_u32 v245, s15, v245
    v_mfma_f32_16x16x32_bf16 v[180:183], v[216:219], v[112:115], v[160:163]
    ds_read_b128 v[216:219], v242 offset:4224
    v_mfma_f32_16x16x32_bf16 v[172:175], v[220:223], v[100:103], v[172:175]
    v_add_u32 v246, s15, v246
    v_add_u32 v247, s15, v247
    v_mfma_f32_16x16x32_bf16 v[180:183], v[220:223], v[116:119], v[180:183]
    ds_read_b128 v[220:223], v243 offset:4224
    s_waitcnt lgkmcnt(2)
    v_mfma_f32_16x16x32_bf16 v[172:175], v[224:227], v[104:107], v[172:175]
    s_add_u32 m0, s14, 0
    s_mov_b32 s73, s55
    buffer_load_dwordx4 v248, s[40:43], s73 offen nt lds
    v_mfma_f32_16x16x32_bf16 v[180:183], v[224:227], v[120:123], v[180:183]
    ds_read_b64_tr_b16 v[224:225], v244 offset:0
    ds_read_b64_tr_b16 v[226:227], v244 offset:4224
    v_mfma_f32_16x16x32_bf16 v[172:175], v[228:231], v[108:111], v[172:175]
    s_add_u32 m0, s14, 32
    s_add_u32 s55, s55, 8192
    buffer_load_dwordx4 v248, s[40:43], s73 offen offset:1024 nt lds
    v_mfma_f32_16x16x32_bf16 v[180:183], v[228:231], v[124:127], v[180:183]
    ds_read_b64_tr_b16 v[228:229], v244 offset:32
    ds_read_b64_tr_b16 v[230:231], v244 offset:4256
    s_add_u32 s16, s16, s17
    s_cmp_eq_u32 s16, 135168
    s_cselect_b32 s15, s18, s17
    s_cselect_b32 s16, 0, s16
    v_mfma_f32_16x16x32_bf16 v[176:179], v[232:235], v[96:99], v[156:159]
    s_add_u32 m0, s14, 8448
    s_mov_b32 s73, s56
    buffer_load_dwordx4 v248, s[44:47], s73 offen nt lds
    v_mfma_f32_16x16x32_bf16 v[184:187], v[232:235], v[112:115], v[160:163]
    ds_read_b64_tr_b16 v[232:233], v245 offset:0
    ds_read_b64_tr_b16 v[234:235], v245 offset:4224
    v_mfma_f32_16x16x32_bf16 v[176:179], v[236:239], v[100:103], v[176:179]
    v_exp_f32 v249, v172
    v_mfma_f32_16x16x32_bf16 v[184:187], v[236:239], v[116:119], v[184:187]
    ds_read_b64_tr_b16 v[236:237], v245 offset:32
    ds_read_b64_tr_b16 v[238:239], v245 offset:4256
    s_waitcnt lgkmcnt(8)
    v_mfma_f32_16x16x32_bf16 v[176:179], v[216:219], v[104:107], v[176:179]
    v_exp_f32 v250, v173
    v_mfma_f32_16x16x32_bf16 v[184:187], v[216:219], v[120:123], v[184:187]
    ds_read_b64_tr_b16 v[216:217], v246 offset:0
    ds_read_b64_tr_b16 v[218:219], v246 offset:4224
    v_mfma_f32_16x16x32_bf16 v[176:179], v[220:223], v[108:111], v[176:179]
    v_cvt_pk_bf16_f32 v204, v249, v250
    v_mfma_f32_16x16x32_bf16 v[184:187], v[220:223], v[124:127], v[184:187]
    ds_read_b64_tr_b16 v[220:221], v246 offset:32
    ds_read_b64_tr_b16 v[222:223], v246 offset:4256
    v_mfma_f32_16x16x32_bf16 v[144:147], v[168:171], v[196:199], v[144:147]
    v_exp_f32 v249, v174
    s_add_u32 m0, s14, 8480
    s_add_u32 s56, s56, 8192
    buffer_load_dwordx4 v248, s[44:47], s73 offen offset:1024 nt lds
    s_add_u32 s14, s14, 33792
    s_cmp_ge_u32 s14, 135680
    s_cselect_b32 s73, 135168, 0
    s_sub_u32 s14, s14, s73
    v_mfma_f32_16x16x32_bf16 v[148:151], v[168:171], v[200:203], v[148:151]
    v_exp_f32 v250, v175
    v_mfma_f32_16x16x32_bf16 v[152:155], v[168:171], v[212:215], v[152:155]
    v_cvt_pk_bf16_f32 v205, v249, v250
    s_waitcnt lgkmcnt(8)
    v_mfma_f32_16x16x32_bf16 v[0:3], v[224:227], v[196:199], v[0:3]
    v_exp_f32 v249, v180
    v_mfma_f32_16x16x32_bf16 v[32:35], v[224:227], v[200:203], v[32:35]
    v_exp_f32 v250, v181
    v_mfma_f32_16x16x32_bf16 v[64:67], v[224:227], v[212:215], v[64:67]
    ds_read_b64_tr_b16 v[224:225], v247 offset:0
    ds_read_b64_tr_b16 v[226:227], v247 offset:4224
    v_add_u32 v240, s15, v240
    v_cvt_pk_bf16_f32 v208, v249, v250
    v_mfma_f32_16x16x32_bf16 v[4:7], v[228:231], v[196:199], v[4:7]
    v_exp_f32 v249, v182
    v_mfma_f32_16x16x32_bf16 v[36:39], v[228:231], v[200:203], v[36:39]
    v_exp_f32 v250, v183
    v_mfma_f32_16x16x32_bf16 v[68:71], v[228:231], v[212:215], v[68:71]
    ds_read_b64_tr_b16 v[228:229], v247 offset:32
    ds_read_b64_tr_b16 v[230:231], v247 offset:4256
    v_add_u32 v241, s15, v241
    v_cvt_pk_bf16_f32 v209, v249, v250
    s_waitcnt lgkmcnt(8)
    v_mfma_f32_16x16x32_bf16 v[8:11], v[232:235], v[196:199], v[8:11]
    v_exp_f32 v249, v176
    v_exp_f32 v250, v177
    v_mfma_f32_16x16x32_bf16 v[40:43], v[232:235], v[200:203], v[40:43]
    v_cvt_pk_bf16_f32 v206, v249, v250
    v_exp_f32 v249, v178
    v_mfma_f32_16x16x32_bf16 v[72:75], v[232:235], v[212:215], v[72:75]
    v_add_u32 v242, s15, v242
    v_exp_f32 v250, v179
    v_mfma_f32_16x16x32_bf16 v[12:15], v[236:239], v[196:199], v[12:15]
    v_cvt_pk_bf16_f32 v207, v249, v250
    v_exp_f32 v249, v184
    v_mfma_f32_16x16x32_bf16 v[44:47], v[236:239], v[200:203], v[44:47]
    v_exp_f32 v250, v185
    s_nop 0
    v_cvt_pk_bf16_f32 v210, v249, v250
    v_mfma_f32_16x16x32_bf16 v[76:79], v[236:239], v[212:215], v[76:79]
    v_add_u32 v243, s15, v243
    v_exp_f32 v249, v186
    s_waitcnt lgkmcnt(0)
    s_waitcnt vmcnt(8)
    s_barrier
    ds_read_b128 v[232:235], v240 offset:4224
    ds_read_b128 v[236:239], v241 offset:4224
    v_mfma_f32_16x16x32_bf16 v[16:19], v[216:219], v[196:199], v[16:19]
    v_exp_f32 v250, v187
    s_nop 0
    v_cvt_pk_bf16_f32 v211, v249, v250
    v_mfma_f32_16x16x32_bf16 v[48:51], v[216:219], v[200:203], v[48:51]
    v_or3_b32 v251, v204, v205, v206
    v_or3_b32 v251, v207, v208, v251
    v_mfma_f32_16x16x32_bf16 v[80:83], v[216:219], v[212:215], v[80:83]
    v_or3_b32 v251, v209, v210, v251
    ds_read_b128 v[216:219], v240 offset:0
    v_mfma_f32_16x16x32_bf16 v[20:23], v[220:223], v[196:199], v[20:23]
    v_or_b32 v251, v211, v251
    v_and_b32 v251, 0x40004000, v251
    v_mfma_f32_16x16x32_bf16 v[52:55], v[220:223], v[200:203], v[52:55]
    v_cmp_ne_u32 vcc, 0, v251
    v_mfma_f32_16x16x32_bf16 v[84:87], v[220:223], v[212:215], v[84:87]
    ds_read_b128 v[220:223], v241 offset:0
    v_mfma_f32_16x16x32_bf16 v[24:27], v[224:227], v[196:199], v[24:27]
    v_mfma_f32_16x16x32_bf16 v[56:59], v[224:227], v[200:203], v[56:59]
    v_mfma_f32_16x16x32_bf16 v[88:91], v[224:227], v[212:215], v[88:91]
    ds_read_b128 v[224:227], v242 offset:0
    v_mfma_f32_16x16x32_bf16 v[28:31], v[228:231], v[196:199], v[28:31]
    v_mfma_f32_16x16x32_bf16 v[60:63], v[228:231], v[200:203], v[60:63]
    v_mfma_f32_16x16x32_bf16 v[92:95], v[228:231], v[212:215], v[92:95]
    ds_read_b128 v[228:231], v243 offset:0
    s_cbranch_vccnz L_lp5_B_rare
L_lp5_next:
    s_sub_u32 s61, s61, 1
    s_cmp_lg_u32 s61, 0
    s_cbranch_scc1 L_loop
    s_cmp_eq_u32 s31, 2
    s_cbranch_scc1 L_tl14_A
    s_cmp_eq_u32 s31, 1
    s_cbranch_scc1 L_tl14_B
    s_waitcnt lgkmcnt(2)
    v_mfma_f32_16x16x32_bf16 v[172:175], v[216:219], v[96:99], v[156:159]
    v_add_u32 v244, s15, v244
    v_add_u32 v245, s15, v245
    v_mfma_f32_16x16x32_bf16 v[180:183], v[216:219], v[112:115], v[160:163]
    ds_read_b128 v[216:219], v242 offset:4224
    v_mfma_f32_16x16x32_bf16 v[172:175], v[220:223], v[100:103], v[172:175]
    v_add_u32 v246, s15, v246
    v_add_u32 v247, s15, v247
    v_mfma_f32_16x16x32_bf16 v[180:183], v[220:223], v[116:119], v[180:183]
    ds_read_b128 v[220:223], v243 offset:4224
    s_waitcnt lgkmcnt(2)
    v_mfma_f32_16x16x32_bf16 v[172:175], v[224:227], v[104:107], v[172:175]
    v_mfma_f32_16x16x32_bf16 v[180:183], v[224:227], v[120:123], v[180:183]
    ds_read_b64_tr_b16 v[224:225], v244 offset:0
    ds_read_b64_tr_b16 v[226:227], v244 offset:4224
    v_mfma_f32_16x16x32_bf16 v[172:175], v[228:231], v[108:111], v[172:175]
    v_mfma_f32_16x16x32_bf16 v[180:183], v[228:231], v[124:127], v[180:183]
    ds_read_b64_tr_b16 v[228:229], v244 offset:32
    ds_read_b64_tr_b16 v[230:231], v244 offset:4256
    s_add_u32 s16, s16, s17
    s_cmp_eq_u32 s16, 135168
    s_cselect_b32 s15, s18, s17
    s_cselect_b32 s16, 0, s16
    v_mfma_f32_16x16x32_bf16 v[176:179], v[232:235], v[96:99], v[156:159]
    v_mfma_f32_16x16x32_bf16 v[184:187], v[232:235], v[112:115], v[160:163]
    ds_read_b64_tr_b16 v[232:233], v245 offset:0
    ds_read_b64_tr_b16 v[234:235], v245 offset:4224
    v_mfma_f32_16x16x32_bf16 v[176:179], v[236:239], v[100:103], v[176:179]
    v_exp_f32 v249, v172
    v_mfma_f32_16x16x32_bf16 v[184:187], v[236:239], v[116:119], v[184:187]
    ds_read_b64_tr_b16 v[236:237], v245 offset:32
    ds_read_b64_tr_b16 v[238:239], v245 offset:4256
    s_waitcnt lgkmcnt(8)
    v_mfma_f32_16x16x32_bf16 v[176:179], v[216:219], v[104:107], v[176:179]
    v_exp_f32 v250, v173
    v_mfma_f32_16x16x32_bf16 v[184:187], v[216:219], v[120:123], v[184:187]
    ds_read_b64_tr_b16 v[216:217], v246 offset:0
    ds_read_b64_tr_b16 v[218:219], v246 offset:4224
    v_mfma_f32_16x16x32_bf16 v[176:179], v[220:223], v[108:111], v[176:179]
    v_cvt_pk_bf16_f32 v196, v249, v250
    v_mfma_f32_16x16x32_bf16 v[184:187], v[220:223], v[124:127], v[184:187]
    ds_read_b64_tr_b16 v[220:221], v246 offset:32
    ds_read_b64_tr_b16 v[222:223], v246 offset:4256
    v_mfma_f32_16x16x32_bf16 v[144:147], v[168:171], v[204:207], v[144:147]
    v_exp_f32 v249, v174
    v_mfma_f32_16x16x32_bf16 v[148:151], v[168:171], v[208:211], v[148:151]
    v_exp_f32 v250, v175
    s_waitcnt lgkmcnt(8)
    v_mfma_f32_16x16x32_bf16 v[0:3], v[224:227], v[204:207], v[0:3]
    v_cvt_pk_bf16_f32 v197, v249, v250
    v_mfma_f32_16x16x32_bf16 v[32:35], v[224:227], v[208:211], v[32:35]
    ds_read_b64_tr_b16 v[224:225], v247 offset:0
    ds_read_b64_tr_b16 v[226:227], v247 offset:4224
    v_add_u32 v240, s15, v240
    v_exp_f32 v249, v180
    v_mfma_f32_16x16x32_bf16 v[4:7], v[228:231], v[204:207], v[4:7]
    v_exp_f32 v250, v181
    v_mfma_f32_16x16x32_bf16 v[36:39], v[228:231], v[208:211], v[36:39]
    ds_read_b64_tr_b16 v[228:229], v247 offset:32
    ds_read_b64_tr_b16 v[230:231], v247 offset:4256
    v_add_u32 v241, s15, v241
    v_cvt_pk_bf16_f32 v200, v249, v250
    s_waitcnt lgkmcnt(8)
    v_mfma_f32_16x16x32_bf16 v[8:11], v[232:235], v[204:207], v[8:11]
    v_exp_f32 v249, v182
    v_exp_f32 v250, v183
    v_mfma_f32_16x16x32_bf16 v[40:43], v[232:235], v[208:211], v[40:43]
    v_add_u32 v242, s15, v242
    v_cvt_pk_bf16_f32 v201, v249, v250
    v_mfma_f32_16x16x32_bf16 v[12:15], v[236:239], v[204:207], v[12:15]
    v_exp_f32 v249, v176
    v_exp_f32 v250, v177
    v_mfma_f32_16x16x32_bf16 v[44:47], v[236:239], v[208:211], v[44:47]
    v_add_u32 v243, s15, v243
    v_cvt_pk_bf16_f32 v198, v249, v250
    s_waitcnt lgkmcnt(0)
    s_waitcnt vmcnt(4)
    s_barrier
    ds_read_b128 v[232:235], v240 offset:4224
    ds_read_b128 v[236:239], v241 offset:4224
    v_mfma_f32_16x16x32_bf16 v[16:19], v[216:219], v[204:207], v[16:19]
    v_exp_f32 v249, v178
    v_exp_f32 v250, v179
    v_mfma_f32_16x16x32_bf16 v[48:51], v[216:219], v[208:211], v[48:51]
    v_cvt_pk_bf16_f32 v199, v249, v250
    ds_read_b128 v[216:219], v240 offset:0
    v_mfma_f32_16x16x32_bf16 v[20:23], v[220:223], v[204:207], v[20:23]
    v_exp_f32 v249, v184
    v_exp_f32 v250, v185
    v_mfma_f32_16x16x32_bf16 v[52:55], v[220:223], v[208:211], v[52:55]
    v_cvt_pk_bf16_f32 v202, v249, v250
    ds_read_b128 v[220:223], v241 offset:0
    v_mfma_f32_16x16x32_bf16 v[24:27], v[224:227], v[204:207], v[24:27]
    v_exp_f32 v249, v186
    v_exp_f32 v250, v187
    v_mfma_f32_16x16x32_bf16 v[56:59], v[224:227], v[208:211], v[56:59]
    v_cvt_pk_bf16_f32 v203, v249, v250
    ds_read_b128 v[224:227], v242 offset:0
    v_mfma_f32_16x16x32_bf16 v[28:31], v[228:231], v[204:207], v[28:31]
    v_or3_b32 v251, v196, v197, v198
    v_or3_b32 v251, v199, v200, v251
    v_mfma_f32_16x16x32_bf16 v[60:63], v[228:231], v[208:211], v[60:63]
    v_or3_b32 v251, v201, v202, v251
    ds_read_b128 v[228:231], v243 offset:0
    v_or_b32 v251, v203, v251
    v_and_b32 v251, 0x40004000, v251
    v_cmp_ne_u32 vcc, 0, v251
    s_cbranch_vccnz L_tl14_C_rare
    s_branch L_tl14_next
L_tl14_A:
    s_waitcnt lgkmcnt(2)
    v_mfma_f32_16x16x32_bf16 v[172:175], v[216:219], v[96:99], v[156:159]
    v_add_u32 v244, s15, v244
    v_add_u32 v245, s15, v245
    v_mfma_f32_16x16x32_bf16 v[180:183], v[216:219], v[112:115], v[160:163]
    v_add_u32 v246, s15, v246
    v_add_u32 v247, s15, v247
    v_mfma_f32_16x16x32_bf16 v[188:191], v[216:219], v[128:131], v[164:167]
    ds_read_b128 v[216:219], v242 offset:4224
    v_mfma_f32_16x16x32_bf16 v[172:175], v[220:223], v[100:103], v[172:175]
    v_mfma_f32_16x16x32_bf16 v[180:183], v[220:223], v[116:119], v[180:183]
    v_mfma_f32_16x16x32_bf16 v[188:191], v[220:223], v[132:135], v[188:191]
    ds_read_b128 v[220:223], v243 offset:4224
    s_waitcnt lgkmcnt(2)
    v_mfma_f32_16x16x32_bf16 v[172:175], v[224:227], v[104:107], v[172:175]
    v_mfma_f32_16x16x32_bf16 v[180:183], v[224:227], v[120:123], v[180:183]
    v_mfma_f32_16x16x32_bf16 v[188:191], v[224:227], v[136:139], v[188:191]
    ds_read_b64_tr_b16 v[224:225], v244 offset:0
    ds_read_b64_tr_b16 v[226:227], v244 offset:4224
    v_mfma_f32_16x16x32_bf16 v[172:175], v[228:231], v[108:111], v[172:175]
    v_mfma_f32_16x16x32_bf16 v[180:183], v[228:231], v[124:127], v[180:183]
    v_mfma_f32_16x16x32_bf16 v[188:191], v[228:231], v[140:143], v[188:191]
    ds_read_b64_tr_b16 v[228:229], v244 offset:32
    ds_read_b64_tr_b16 v[230:231], v244 offset:4256
    s_add_u32 s16, s16, s17
    s_cmp_eq_u32 s16, 135168
    s_cselect_b32 s15, s18, s17
    s_cselect_b32 s16, 0, s16
    v_mfma_f32_16x16x32_bf16 v[176:179], v[232:235], v[96:99], v[156:159]
    v_mfma_f32_16x16x32_bf16 v[184:187], v[232:235], v[112:115], v[160:163]
    v_exp_f32 v249, v172
    v_mfma_f32_16x16x32_bf16 v[192:195], v[232:235], v[128:131], v[164:167]
    ds_read_b64_tr_b16 v[232:233], v245 offset:0
    ds_read_b64_tr_b16 v[234:235], v245 offset:4224
    v_mfma_f32_16x16x32_bf16 v[176:179], v[236:239], v[100:103], v[176:179]
    v_exp_f32 v250, v173
    v_mfma_f32_16x16x32_bf16 v[184:187], v[236:239], v[116:119], v[184:187]
    v_cvt_pk_bf16_f32 v196, v249, v250
    v_mfma_f32_16x16x32_bf16 v[192:195], v[236:239], v[132:135], v[192:195]
    ds_read_b64_tr_b16 v[236:237], v245 offset:32
    ds_read_b64_tr_b16 v[238:239], v245 offset:4256
    s_waitcnt lgkmcnt(8)
    v_mfma_f32_16x16x32_bf16 v[176:179], v[216:219], v[104:107], v[176:179]
    v_exp_f32 v249, v174
    v_mfma_f32_16x16x32_bf16 v[184:187], v[216:219], v[120:123], v[184:187]
    v_exp_f32 v250, v175
    v_mfma_f32_16x16x32_bf16 v[192:195], v[216:219], v[136:139], v[192:195]
    ds_read_b64_tr_b16 v[216:217], v246 offset:0
    ds_read_b64_tr_b16 v[218:219], v246 offset:4224
    v_mfma_f32_16x16x32_bf16 v[176:179], v[220:223], v[108:111], v[176:179]
    v_cvt_pk_bf16_f32 v197, v249, v250
    v_mfma_f32_16x16x32_bf16 v[184:187], v[220:223], v[124:127], v[184:187]
    v_exp_f32 v249, v180
    v_mfma_f32_16x16x32_bf16 v[192:195], v[220:223], v[140:143], v[192:195]
    ds_read_b64_tr_b16 v[220:221], v246 offset:32
    ds_read_b64_tr_b16 v[222:223], v246 offset:4256
    v_mfma_f32_16x16x32_bf16 v[144:147], v[168:171], v[204:207], v[144:147]
    v_exp_f32 v250, v181
    v_mfma_f32_16x16x32_bf16 v[148:151], v[168:171], v[208:211], v[148:151]
    v_cvt_pk_bf16_f32 v200, v249, v250
    s_waitcnt lgkmcnt(8)
    v_mfma_f32_16x16x32_bf16 v[0:3], v[224:227], v[204:207], v[0:3]
    v_exp_f32 v249, v182
    v_mfma_f32_16x16x32_bf16 v[32:35], v[224:227], v[208:211], v[32:35]
    ds_read_b64_tr_b16 v[224:225], v247 offset:0
    ds_read_b64_tr_b16 v[226:227], v247 offset:4224
    v_add_u32 v240, s15, v240
    v_exp_f32 v250, v183
    v_mfma_f32_16x16x32_bf16 v[4:7], v[228:231], v[204:207], v[4:7]
    v_cvt_pk_bf16_f32 v201, v249, v250
    v_mfma_f32_16x16x32_bf16 v[36:39], v[228:231], v[208:211], v[36:39]
    ds_read_b64_tr_b16 v[228:229], v247 offset:32
    ds_read_b64_tr_b16 v[230:231], v247 offset:4256
    v_add_u32 v241, s15, v241
    v_exp_f32 v249, v188
    s_waitcnt lgkmcnt(8)
    v_mfma_f32_16x16x32_bf16 v[8:11], v[232:235], v[204:207], v[8:11]
    v_exp_f32 v250, v189
    s_nop 0
    v_cvt_pk_bf16_f32 v212, v249, v250
    v_mfma_f32_16x16x32_bf16 v[40:43], v[232:235], v[208:211], v[40:43]
    v_add_u32 v242, s15, v242
    v_exp_f32 v249, v190
    v_mfma_f32_16x16x32_bf16 v[12:15], v[236:239], v[204:207], v[12:15]
    v_exp_f32 v250, v191
    s_nop 0
    v_cvt_pk_bf16_f32 v213, v249, v250
    v_mfma_f32_16x16x32_bf16 v[44:47], v[236:239], v[208:211], v[44:47]
    v_add_u32 v243, s15, v243
    v_exp_f32 v249, v176
    s_waitcnt lgkmcnt(0)
    s_waitcnt vmcnt(4)
    s_barrier
    ds_read_b128 v[232:235], v240 offset:4224
    ds_read_b128 v[236:239], v241 offset:4224
    v_mfma_f32_16x16x32_bf16 v[16:19], v[216:219], v[204:207], v[16:19]
    v_exp_f32 v250, v177
    s_nop 0
    v_cvt_pk_bf16_f32 v198, v249, v250
    v_mfma_f32_16x16x32_bf16 v[48:51], v[216:219], v[208:211], v[48:51]
    v_exp_f32 v249, v178
    ds_read_b128 v[216:219], v240 offset:0
    v_mfma_f32_16x16x32_bf16 v[20:23], v[220:223], v[204:207], v[20:23]
    v_exp_f32 v250, v179
    s_nop 0
    v_cvt_pk_bf16_f32 v199, v249, v250
    v_mfma_f32_16x16x32_bf16 v[52:55], v[220:223], v[208:211], v[52:55]
    v_exp_f32 v249, v184
    ds_read_b128 v[220:223], v241 offset:0
    v_mfma_f32_16x16x32_bf16 v[24:27], v[224:227], v[204:207], v[24:27]
    v_exp_f32 v250, v185
    s_nop 0
    v_cvt_pk_bf16_f32 v202, v249, v250
    v_mfma_f32_16x16x32_bf16 v[56:59], v[224:227], v[208:211], v[56:59]
    v_exp_f32 v249, v186
    ds_read_b128 v[224:227], v242 offset:0
    v_mfma_f32_16x16x32_bf16 v[28:31], v[228:231], v[204:207], v[28:31]
    v_exp_f32 v250, v187
    s_nop 0
    v_cvt_pk_bf16_f32 v203, v249, v250
    v_mfma_f32_16x16x32_bf16 v[60:63], v[228:231], v[208:211], v[60:63]
    v_exp_f32 v249, v192
    ds_read_b128 v[228:231], v243 offset:0
    v_exp_f32 v250, v193
    s_nop 0
    v_cvt_pk_bf16_f32 v214, v249, v250
    v_exp_f32 v249, v194
    v_exp_f32 v250, v195
    s_nop 0
    v_cvt_pk_bf16_f32 v215, v249, v250
    v_or3_b32 v251, v196, v197, v198
    v_or3_b32 v251, v199, v200, v251
    v_or3_b32 v251, v201, v202, v251
    v_or3_b32 v251, v203, v212, v251
    v_or3_b32 v251, v213, v214, v251
    v_or_b32 v251, v215, v251
    v_and_b32 v251, 0x40004000, v251
    v_cmp_ne_u32 vcc, 0, v251
    s_cbranch_vccnz L_tl14_A_rare
    s_branch L_tl14_next
L_tl14_B:
    s_waitcnt lgkmcnt(2)
    v_mfma_f32_16x16x32_bf16 v[172:175], v[216:219], v[96:99], v[156:159]
    v_add_u32 v244, s15, v244
    v_add_u32 v245, s15, v245
    v_mfma_f32_16x16x32_bf16 v[180:183], v[216:219], v[112:115], v[160:163]
    ds_read_b128 v[216:219], v242 offset:4224
    v_mfma_f32_16x16x32_bf16 v[172:175], v[220:223], v[100:103], v[172:175]
    v_add_u32 v246, s15, v246
    v_add_u32 v247, s15, v247
    v_mfma_f32_16x16x32_bf16 v[180:183], v[220:223], v[116:119], v[180:183]
    ds_read_b128 v[220:223], v243 offset:4224
    s_waitcnt lgkmcnt(2)
    v_mfma_f32_16x16x32_bf16 v[172:175], v[224:227], v[104:107], v[172:175]
    v_mfma_f32_16x16x32_bf16 v[180:183], v[224:227], v[120:123], v[180:183]
    ds_read_b64_tr_b16 v[224:225], v244 offset:0
    ds_read_b64_tr_b16 v[226:227], v244 offset:4224
    v_mfma_f32_16x16x32_bf16 v[172:175], v[228:231], v[108:111], v[172:175]
    v_mfma_f32_16x16x32_bf16 v[180:183], v[228:231], v[124:127], v[180:183]
    ds_read_b64_tr_b16 v[228:229], v244 offset:32
    ds_read_b64_tr_b16 v[230:231], v244 offset:4256
    s_add_u32 s16, s16, s17
    s_cmp_eq_u32 s16, 135168
    s_cselect_b32 s15, s18, s17
    s_cselect_b32 s16, 0, s16
    v_mfma_f32_16x16x32_bf16 v[176:179], v[232:235], v[96:99], v[156:159]
    v_mfma_f32_16x16x32_bf16 v[184:187], v[232:235], v[112:115], v[160:163]
    ds_read_b64_tr_b16 v[232:233], v245 offset:0
    ds_read_b64_tr_b16 v[234:235], v245 offset:4224
    v_mfma_f32_16x16x32_bf16 v[176:179], v[236:239], v[100:103], v[176:179]
    v_exp_f32 v249, v172
    v_mfma_f32_16x16x32_bf16 v[184:187], v[236:239], v[116:119], v[184:187]
    ds_read_b64_tr_b16 v[236:237], v245 offset:32
    ds_read_b64_tr_b16 v[238:239], v245 offset:4256
    s_waitcnt lgkmcnt(8)
    v_mfma_f32_16x16x32_bf16 v[176:179], v[216:219], v[104:107], v[176:179]
    v_exp_f32 v250, v173
    v_mfma_f32_16x16x32_bf16 v[184:187], v[216:219], v[120:123], v[184:187]
    ds_read_b64_tr_b16 v[216:217], v246 offset:0
    ds_read_b64_tr_b16 v[218:219], v246 offset:4224
    v_mfma_f32_16x16x32_bf16 v[176:179], v[220:223], v[108:111], v[176:179]
    v_cvt_pk_bf16_f32 v196, v249, v250
    v_mfma_f32_16x16x32_bf16 v[184:187], v[220:223], v[124:127], v[184:187]
    ds_read_b64_tr_b16 v[220:221], v246 offset:32
    ds_read_b64_tr_b16 v[222:223], v246 offset:4256
    v_mfma_f32_16x16x32_bf16 v[144:147], v[168:171], v[204:207], v[144:147]
    v_exp_f32 v249, v174
    v_mfma_f32_16x16x32_bf16 v[148:151], v[168:171], v[208:211], v[148:151]
    v_exp_f32 v250, v175
    v_mfma_f32_16x16x32_bf16 v[152:155], v[168:171], v[212:215], v[152:155]
    v_cvt_pk_bf16_f32 v197, v249, v250
    s_waitcnt lgkmcnt(8)
    v_mfma_f32_16x16x32_bf16 v[0:3], v[224:227], v[204:207], v[0:3]
    v_exp_f32 v249, v180
    v_mfma_f32_16x16x32_bf16 v[32:35], v[224:227], v[208:211], v[32:35]
    v_exp_f32 v250, v181
    v_mfma_f32_16x16x32_bf16 v[64:67], v[224:227], v[212:215], v[64:67]
    ds_read_b64_tr_b16 v[224:225], v247 offset:0
    ds_read_b64_tr_b16 v[226:227], v247 offset:4224
    v_add_u32 v240, s15, v240
    v_cvt_pk_bf16_f32 v200, v249, v250
    v_mfma_f32_16x16x32_bf16 v[4:7], v[228:231], v[204:207], v[4:7]
    v_exp_f32 v249, v182
    v_mfma_f32_16x16x32_bf16 v[36:39], v[228:231], v[208:211], v[36:39]
    v_exp_f32 v250, v183
    v_mfma_f32_16x16x32_bf16 v[68:71], v[228:231], v[212:215], v[68:71]
    ds_read_b64_tr_b16 v[228:229], v247 offset:32
    ds_read_b64_tr_b16 v[230:231], v247 offset:4256
    v_add_u32 v241, s15, v241
    v_cvt_pk_bf16_f32 v201, v249, v250
    s_waitcnt lgkmcnt(8)
    v_mfma_f32_16x16x32_bf16 v[8:11], v[232:235], v[204:207], v[8:11]
    v_exp_f32 v249, v176
    v_exp_f32 v250, v177
    v_mfma_f32_16x16x32_bf16 v[40:43], v[232:235], v[208:211], v[40:43]
    v_cvt_pk_bf16_f32 v198, v249, v250
    v_exp_f32 v249, v178
    v_mfma_f32_16x16x32_bf16 v[72:75], v[232:235], v[212:215], v[72:75]
    v_add_u32 v242, s15, v242
    v_exp_f32 v250, v179
    v_mfma_f32_16x16x32_bf16 v[12:15], v[236:239], v[204:207], v[12:15]
    v_cvt_pk_bf16_f32 v199, v249, v250
    v_exp_f32 v249, v184
    v_mfma_f32_16x16x32_bf16 v[44:47], v[236:239], v[208:211], v[44:47]
    v_exp_f32 v250, v185
    s_nop 0
    v_cvt_pk_bf16_f32 v202, v249, v250
    v_mfma_f32_16x16x32_bf16 v[76:79], v[236:239], v[212:215], v[76:79]
    v_add_u32 v243, s15, v243
    v_exp_f32 v249, v186
    s_waitcnt lgkmcnt(0)
    s_waitcnt vmcnt(4)
    s_barrier
    ds_read_b128 v[232:235], v240 offset:4224
    ds_read_b128 v[236:239], v241 offset:4224
    v_mfma_f32_16x16x32_bf16 v[16:19], v[216:219], v[204:207], v[16:19]
    v_exp_f32 v250, v187
    s_nop 0
    v_cvt_pk_bf16_f32 v203, v249, v250
    v_mfma_f32_16x16x32_bf16 v[48:51], v[216:219], v[208:211], v[48:51]
    v_or3_b32 v251, v196, v197, v198
    v_or3_b32 v251, v199, v200, v251
    v_mfma_f32_16x16x32_bf16 v[80:83], v[216:219], v[212:215], v[80:83]
    v_or3_b32 v251, v201, v202, v251
    ds_read_b128 v[216:219], v240 offset:0
    v_mfma_f32_16x16x32_bf16 v[20:23], v[220:223], v[204:207], v[20:23]
    v_or_b32 v251, v203, v251
    v_and_b32 v251, 0x40004000, v251
    v_mfma_f32_16x16x32_bf16 v[52:55], v[220:223], v[208:211], v[52:55]
    v_cmp_ne_u32 vcc, 0, v251
    v_mfma_f32_16x16x32_bf16 v[84:87], v[220:223], v[212:215], v[84:87]
    ds_read_b128 v[220:223], v241 offset:0
    v_mfma_f32_16x16x32_bf16 v[24:27], v[224:227], v[204:207], v[24:27]
    v_mfma_f32_16x16x32_bf16 v[56:59], v[224:227], v[208:211], v[56:59]
    v_mfma_f32_16x16x32_bf16 v[88:91], v[224:227], v[212:215], v[88:91]
    ds_read_b128 v[224:227], v242 offset:0
    v_mfma_f32_16x16x32_bf16 v[28:31], v[228:231], v[204:207], v[28:31]
    v_mfma_f32_16x16x32_bf16 v[60:63], v[228:231], v[208:211], v[60:63]
    v_mfma_f32_16x16x32_bf16 v[92:95], v[228:231], v[212:215], v[92:95]
    ds_read_b128 v[228:231], v243 offset:0
    s_cbranch_vccnz L_tl14_B_rare
L_tl14_next:
    s_cmp_eq_u32 s31, 3
    s_cbranch_scc1 L_tl15_A
    s_cmp_eq_u32 s31, 2
    s_cbranch_scc1 L_tl15_B
    s_waitcnt lgkmcnt(2)
    v_mfma_f32_16x16x32_bf16 v[172:175], v[216:219], v[96:99], v[156:159]
    v_add_u32 v244, s15, v244
    v_add_u32 v245, s15, v245
    v_mfma_f32_16x16x32_bf16 v[180:183], v[216:219], v[112:115], v[160:163]
    ds_read_b128 v[216:219], v242 offset:4224
    v_mfma_f32_16x16x32_bf16 v[172:175], v[220:223], v[100:103], v[172:175]
    v_add_u32 v246, s15, v246
    v_add_u32 v247, s15, v247
    v_mfma_f32_16x16x32_bf16 v[180:183], v[220:223], v[116:119], v[180:183]
    ds_read_b128 v[220:223], v243 offset:4224
    s_waitcnt lgkmcnt(2)
    v_mfma_f32_16x16x32_bf16 v[172:175], v[224:227], v[104:107], v[172:175]
    v_mfma_f32_16x16x32_bf16 v[180:183], v[224:227], v[120:123], v[180:183]
    ds_read_b64_tr_b16 v[224:225], v244 offset:0
    ds_read_b64_tr_b16 v[226:227], v244 offset:4224
    v_mfma_f32_16x16x32_bf16 v[172:175], v[228:231], v[108:111], v[172:175]
    v_mfma_f32_16x16x32_bf16 v[180:183], v[228:231], v[124:127], v[180:183]
    ds_read_b64_tr_b16 v[228:229], v244 offset:32
    ds_read_b64_tr_b16 v[230:231], v244 offset:4256
    s_add_u32 s16, s16, s17
    s_cmp_eq_u32 s16, 135168
    s_cselect_b32 s15, s18, s17
    s_cselect_b32 s16, 0, s16
    v_mfma_f32_16x16x32_bf16 v[176:179], v[232:235], v[96:99], v[156:159]
    v_mfma_f32_16x16x32_bf16 v[184:187], v[232:235], v[112:115], v[160:163]
    ds_read_b64_tr_b16 v[232:233], v245 offset:0
    ds_read_b64_tr_b16 v[234:235], v245 offset:4224
    v_mfma_f32_16x16x32_bf16 v[176:179], v[236:239], v[100:103], v[176:179]
    v_exp_f32 v249, v172
    v_mfma_f32_16x16x32_bf16 v[184:187], v[236:239], v[116:119], v[184:187]
    ds_read_b64_tr_b16 v[236:237], v245 offset:32
    ds_read_b64_tr_b16 v[238:239], v245 offset:4256
    s_waitcnt lgkmcnt(8)
    v_mfma_f32_16x16x32_bf16 v[176:179], v[216:219], v[104:107], v[176:179]
    v_exp_f32 v250, v173
    v_mfma_f32_16x16x32_bf16 v[184:187], v[216:219], v[120:123], v[184:187]
    ds_read_b64_tr_b16 v[216:217], v246 offset:0
    ds_read_b64_tr_b16 v[218:219], v246 offset:4224
    v_mfma_f32_16x16x32_bf16 v[176:179], v[220:223], v[108:111], v[176:179]
    v_cvt_pk_bf16_f32 v204, v249, v250
    v_mfma_f32_16x16x32_bf16 v[184:187], v[220:223], v[124:127], v[184:187]
    ds_read_b64_tr_b16 v[220:221], v246 offset:32
    ds_read_b64_tr_b16 v[222:223], v246 offset:4256
    v_mfma_f32_16x16x32_bf16 v[144:147], v[168:171], v[196:199], v[144:147]
    v_exp_f32 v249, v174
    v_mfma_f32_16x16x32_bf16 v[148:151], v[168:171], v[200:203], v[148:151]
    v_exp_f32 v250, v175
    s_waitcnt lgkmcnt(8)
    v_mfma_f32_16x16x32_bf16 v[0:3], v[224:227], v[196:199], v[0:3]
    v_cvt_pk_bf16_f32 v205, v249, v250
    v_mfma_f32_16x16x32_bf16 v[32:35], v[224:227], v[200:203], v[32:35]
    ds_read_b64_tr_b16 v[224:225], v247 offset:0
    ds_read_b64_tr_b16 v[226:227], v247 offset:4224
    v_exp_f32 v249, v180
    v_mfma_f32_16x16x32_bf16 v[4:7], v[228:231], v[196:199], v[4:7]
    v_exp_f32 v250, v181
    v_mfma_f32_16x16x32_bf16 v[36:39], v[228:231], v[200:203], v[36:39]
    ds_read_b64_tr_b16 v[228:229], v247 offset:32
    ds_read_b64_tr_b16 v[230:231], v247 offset:4256
    v_cvt_pk_bf16_f32 v208, v249, v250
    s_waitcnt lgkmcnt(8)
    v_mfma_f32_16x16x32_bf16 v[8:11], v[232:235], v[196:199], v[8:11]
    v_exp_f32 v249, v182
    v_exp_f32 v250, v183
    v_mfma_f32_16x16x32_bf16 v[40:43], v[232:235], v[200:203], v[40:43]
    v_cvt_pk_bf16_f32 v209, v249, v250
    v_mfma_f32_16x16x32_bf16 v[12:15], v[236:239], v[196:199], v[12:15]
    v_exp_f32 v249, v176
    v_exp_f32 v250, v177
    v_mfma_f32_16x16x32_bf16 v[44:47], v[236:239], v[200:203], v[44:47]
    v_cvt_pk_bf16_f32 v206, v249, v250
    s_waitcnt lgkmcnt(0)
    v_add_u32 v244, s15, v244
    v_add_u32 v245, s15, v245
    v_add_u32 v246, s15, v246
    v_add_u32 v247, s15, v247
    s_waitcnt vmcnt(0)
    s_barrier
    ds_read_b64_tr_b16 v[232:233], v245 offset:0
    ds_read_b64_tr_b16 v[234:235], v245 offset:4224
    ds_read_b64_tr_b16 v[236:237], v245 offset:32
    ds_read_b64_tr_b16 v[238:239], v245 offset:4256
    v_mfma_f32_16x16x32_bf16 v[16:19], v[216:219], v[196:199], v[16:19]
    v_exp_f32 v249, v178
    v_exp_f32 v250, v179
    v_mfma_f32_16x16x32_bf16 v[48:51], v[216:219], v[200:203], v[48:51]
    v_cvt_pk_bf16_f32 v207, v249, v250
    ds_read_b64_tr_b16 v[216:217], v244 offset:0
    ds_read_b64_tr_b16 v[218:219], v244 offset:4224
    v_mfma_f32_16x16x32_bf16 v[20:23], v[220:223], v[196:199], v[20:23]
    v_exp_f32 v249, v184
    v_exp_f32 v250, v185
    v_mfma_f32_16x16x32_bf16 v[52:55], v[220:223], v[200:203], v[52:55]
    v_cvt_pk_bf16_f32 v210, v249, v250
    ds_read_b64_tr_b16 v[220:221], v244 offset:32
    ds_read_b64_tr_b16 v[222:223], v244 offset:4256
    v_mfma_f32_16x16x32_bf16 v[24:27], v[224:227], v[196:199], v[24:27]
    v_exp_f32 v249, v186
    v_exp_f32 v250, v187
    v_mfma_f32_16x16x32_bf16 v[56:59], v[224:227], v[200:203], v[56:59]
    v_cvt_pk_bf16_f32 v211, v249, v250
    ds_read_b64_tr_b16 v[224:225], v246 offset:0
    ds_read_b64_tr_b16 v[226:227], v246 offset:4224
    v_mfma_f32_16x16x32_bf16 v[28:31], v[228:231], v[196:199], v[28:31]
    v_or3_b32 v251, v204, v205, v206
    v_or3_b32 v251, v207, v208, v251
    v_mfma_f32_16x16x32_bf16 v[60:63], v[228:231], v[200:203], v[60:63]
    v_or3_b32 v251, v209, v210, v251
    ds_read_b64_tr_b16 v[228:229], v246 offset:32
    ds_read_b64_tr_b16 v[230:231], v246 offset:4256
    v_or_b32 v251, v211, v251
    v_and_b32 v251, 0x40004000, v251
    v_cmp_ne_u32 vcc, 0, v251
    s_cbranch_vccnz L_tl15_C_rare
    s_branch L_tl15_next
L_tl15_A:
    s_waitcnt lgkmcnt(2)
    v_mfma_f32_16x16x32_bf16 v[172:175], v[216:219], v[96:99], v[156:159]
    v_add_u32 v244, s15, v244
    v_add_u32 v245, s15, v245
    v_mfma_f32_16x16x32_bf16 v[180:183], v[216:219], v[112:115], v[160:163]
    v_add_u32 v246, s15, v246
    v_add_u32 v247, s15, v247
    v_mfma_f32_16x16x32_bf16 v[188:191], v[216:219], v[128:131], v[164:167]
    ds_read_b128 v[216:219], v242 offset:4224
    v_mfma_f32_16x16x32_bf16 v[172:175], v[220:223], v[100:103], v[172:175]
    v_mfma_f32_16x16x32_bf16 v[180:183], v[220:223], v[116:119], v[180:183]
    v_mfma_f32_16x16x32_bf16 v[188:191], v[220:223], v[132:135], v[188:191]
    ds_read_b128 v[220:223], v243 offset:4224
    s_waitcnt lgkmcnt(2)
    v_mfma_f32_16x16x32_bf16 v[172:175], v[224:227], v[104:107], v[172:175]
    v_mfma_f32_16x16x32_bf16 v[180:183], v[224:227], v[120:123], v[180:183]
    v_mfma_f32_16x16x32_bf16 v[188:191], v[224:227], v[136:139], v[188:191]
    ds_read_b64_tr_b16 v[224:225], v244 offset:0
    ds_read_b64_tr_b16 v[226:227], v244 offset:4224
    v_mfma_f32_16x16x32_bf16 v[172:175], v[228:231], v[108:111], v[172:175]
    v_mfma_f32_16x16x32_bf16 v[180:183], v[228:231], v[124:127], v[180:183]
    v_mfma_f32_16x16x32_bf16 v[188:191], v[228:231], v[140:143], v[188:191]
    ds_read_b64_tr_b16 v[228:229], v244 offset:32
    ds_read_b64_tr_b16 v[230:231], v244 offset:4256
    s_add_u32 s16, s16, s17
    s_cmp_eq_u32 s16, 135168
    s_cselect_b32 s15, s18, s17
    s_cselect_b32 s16, 0, s16
    v_mfma_f32_16x16x32_bf16 v[176:179], v[232:235], v[96:99], v[156:159]
    v_mfma_f32_16x16x32_bf16 v[184:187], v[232:235], v[112:115], v[160:163]
    v_exp_f32 v249, v172
    v_mfma_f32_16x16x32_bf16 v[192:195], v[232:235], v[128:131], v[164:167]
    ds_read_b64_tr_b16 v[232:233], v245 offset:0
    ds_read_b64_tr_b16 v[234:235], v245 offset:4224
    v_mfma_f32_16x16x32_bf16 v[176:179], v[236:239], v[100:103], v[176:179]
    v_exp_f32 v250, v173
    v_mfma_f32_16x16x32_bf16 v[184:187], v[236:239], v[116:119], v[184:187]
    v_cvt_pk_bf16_f32 v204, v249, v250
    v_mfma_f32_16x16x32_bf16 v[192:195], v[236:239], v[132:135], v[192:195]
    ds_read_b64_tr_b16 v[236:237], v245 offset:32
    ds_read_b64_tr_b16 v[238:239], v245 offset:4256
    s_waitcnt lgkmcnt(8)
    v_mfma_f32_16x16x32_bf16 v[176:179], v[216:219], v[104:107], v[176:179]
    v_exp_f32 v249, v174
    v_mfma_f32_16x16x32_bf16 v[184:187], v[216:219], v[120:123], v[184:187]
    v_exp_f32 v250, v175
    v_mfma_f32_16x16x32_bf16 v[192:195], v[216:219], v[136:139], v[192:195]
    ds_read_b64_tr_b16 v[216:217], v246 offset:0
    ds_read_b64_tr_b16 v[218:219], v246 offset:4224
    v_mfma_f32_16x16x32_bf16 v[176:179], v[220:223], v[108:111], v[176:179]
    v_cvt_pk_bf16_f32 v205, v249, v250
    v_mfma_f32_16x16x32_bf16 v[184:187], v[220:223], v[124:127], v[184:187]
    v_exp_f32 v249, v180
    v_mfma_f32_16x16x32_bf16 v[192:195], v[220:223], v[140:143], v[192:195]
    ds_read_b64_tr_b16 v[220:221], v246 offset:32
    ds_read_b64_tr_b16 v[222:223], v246 offset:4256
    v_mfma_f32_16x16x32_bf16 v[144:147], v[168:171], v[196:199], v[144:147]
    v_exp_f32 v250, v181
    v_mfma_f32_16x16x32_bf16 v[148:151], v[168:171], v[200:203], v[148:151]
    v_cvt_pk_bf16_f32 v208, v249, v250
    s_waitcnt lgkmcnt(8)
    v_mfma_f32_16x16x32_bf16 v[0:3], v[224:227], v[196:199], v[0:3]
    v_exp_f32 v249, v182
    v_mfma_f32_16x16x32_bf16 v[32:35], v[224:227], v[200:203], v[32:35]
    ds_read_b64_tr_b16 v[224:225], v247 offset:0
    ds_read_b64_tr_b16 v[226:227], v247 offset:4224
    v_exp_f32 v250, v183
    v_mfma_f32_16x16x32_bf16 v[4:7], v[228:231], v[196:199], v[4:7]
    v_cvt_pk_bf16_f32 v209, v249, v250
    v_mfma_f32_16x16x32_bf16 v[36:39], v[228:231], v[200:203], v[36:39]
    ds_read_b64_tr_b16 v[228:229], v247 offset:32
    ds_read_b64_tr_b16 v[230:231], v247 offset:4256
    v_exp_f32 v249, v188
    s_waitcnt lgkmcnt(8)
    v_mfma_f32_16x16x32_bf16 v[8:11], v[232:235], v[196:199], v[8:11]
    v_exp_f32 v250, v189
    s_nop 0
    v_cvt_pk_bf16_f32 v212, v249, v250
    v_mfma_f32_16x16x32_bf16 v[40:43], v[232:235], v[200:203], v[40:43]
    v_exp_f32 v249, v190
    v_mfma_f32_16x16x32_bf16 v[12:15], v[236:239], v[196:199], v[12:15]
    v_exp_f32 v250, v191
    s_nop 0
    v_cvt_pk_bf16_f32 v213, v249, v250
    v_mfma_f32_16x16x32_bf16 v[44:47], v[236:239], v[200:203], v[44:47]
    v_exp_f32 v249, v176
    s_waitcnt lgkmcnt(0)
    v_add_u32 v244, s15, v244
    v_add_u32 v245, s15, v245
    v_add_u32 v246, s15, v246
    v_add_u32 v247, s15, v247
    s_waitcnt vmcnt(0)
    s_barrier
    ds_read_b64_tr_b16 v[232:233], v245 offset:0
    ds_read_b64_tr_b16 v[234:235], v245 offset:4224
    ds_read_b64_tr_b16 v[236:237], v245 offset:32
    ds_read_b64_tr_b16 v[238:239], v245 offset:4256
    v_mfma_f32_16x16x32_bf16 v[16:19], v[216:219], v[196:199], v[16:19]
    v_exp_f32 v250, v177
    s_nop 0
    v_cvt_pk_bf16_f32 v206, v249, v250
    v_mfma_f32_16x16x32_bf16 v[48:51], v[216:219], v[200:203], v[48:51]
    v_exp_f32 v249, v178
    ds_read_b64_tr_b16 v[216:217], v244 offset:0
    ds_read_b64_tr_b16 v[218:219], v244 offset:4224
    v_mfma_f32_16x16x32_bf16 v[20:23], v[220:223], v[196:199], v[20:23]
    v_exp_f32 v250, v179
    s_nop 0
    v_cvt_pk_bf16_f32 v207, v249, v250
    v_mfma_f32_16x16x32_bf16 v[52:55], v[220:223], v[200:203], v[52:55]
    v_exp_f32 v249, v184
    ds_read_b64_tr_b16 v[220:221], v244 offset:32
    ds_read_b64_tr_b16 v[222:223], v244 offset:4256
    v_mfma_f32_16x16x32_bf16 v[24:27], v[224:227], v[196:199], v[24:27]
    v_exp_f32 v250, v185
    s_nop 0
    v_cvt_pk_bf16_f32 v210, v249, v250
    v_mfma_f32_16x16x32_bf16 v[56:59], v[224:227], v[200:203], v[56:59]
    v_exp_f32 v249, v186
    ds_read_b64_tr_b16 v[224:225], v246 offset:0
    ds_read_b64_tr_b16 v[226:227], v246 offset:4224
    v_mfma_f32_16x16x32_bf16 v[28:31], v[228:231], v[196:199], v[28:31]
    v_exp_f32 v250, v187
    s_nop 0
    v_cvt_pk_bf16_f32 v211, v249, v250
    v_mfma_f32_16x16x32_bf16 v[60:63], v[228:231], v[200:203], v[60:63]
    v_exp_f32 v249, v192
    ds_read_b64_tr_b16 v[228:229], v246 offset:32
    ds_read_b64_tr_b16 v[230:231], v246 offset:4256
    v_exp_f32 v250, v193
    s_nop 0
    v_cvt_pk_bf16_f32 v214, v249, v250
    v_exp_f32 v249, v194
    v_exp_f32 v250, v195
    s_nop 0
    v_cvt_pk_bf16_f32 v215, v249, v250
    v_or3_b32 v251, v204, v205, v206
    v_or3_b32 v251, v207, v208, v251
    v_or3_b32 v251, v209, v210, v251
    v_or3_b32 v251, v211, v212, v251
    v_or3_b32 v251, v213, v214, v251
    v_or_b32 v251, v215, v251
    v_and_b32 v251, 0x40004000, v251
    v_cmp_ne_u32 vcc, 0, v251
    s_cbranch_vccnz L_tl15_A_rare
    s_branch L_tl15_next
L_tl15_B:
    s_waitcnt lgkmcnt(2)
    v_mfma_f32_16x16x32_bf16 v[172:175], v[216:219], v[96:99], v[156:159]
    v_add_u32 v244, s15, v244
    v_add_u32 v245, s15, v245
    v_mfma_f32_16x16x32_bf16 v[180:183], v[216:219], v[112:115], v[160:163]
    ds_read_b128 v[216:219], v242 offset:4224
    v_mfma_f32_16x16x32_bf16 v[172:175], v[220:223], v[100:103], v[172:175]
    v_add_u32 v246, s15, v246
    v_add_u32 v247, s15, v247
    v_mfma_f32_16x16x32_bf16 v[180:183], v[220:223], v[116:119], v[180:183]
    ds_read_b128 v[220:223], v243 offset:4224
    s_waitcnt lgkmcnt(2)
    v_mfma_f32_16x16x32_bf16 v[172:175], v[224:227], v[104:107], v[172:175]
    v_mfma_f32_16x16x32_bf16 v[180:183], v[224:227], v[120:123], v[180:183]
    ds_read_b64_tr_b16 v[224:225], v244 offset:0
    ds_read_b64_tr_b16 v[226:227], v244 offset:4224
    v_mfma_f32_16x16x32_bf16 v[172:175], v[228:231], v[108:111], v[172:175]
    v_mfma_f32_16x16x32_bf16 v[180:183], v[228:231], v[124:127], v[180:183]
    ds_read_b64_tr_b16 v[228:229], v244 offset:32
    ds_read_b64_tr_b16 v[230:231], v244 offset:4256
    s_add_u32 s16, s16, s17
    s_cmp_eq_u32 s16, 135168
    s_cselect_b32 s15, s18, s17
    s_cselect_b32 s16, 0, s16
    v_mfma_f32_16x16x32_bf16 v[176:179], v[232:235], v[96:99], v[156:159]
    v_mfma_f32_16x16x32_bf16 v[184:187], v[232:235], v[112:115], v[160:163]
    ds_read_b64_tr_b16 v[232:233], v245 offset:0
    ds_read_b64_tr_b16 v[234:235], v245 offset:4224
    v_mfma_f32_16x16x32_bf16 v[176:179], v[236:239], v[100:103], v[176:179]
    v_exp_f32 v249, v172
    v_mfma_f32_16x16x32_bf16 v[184:187], v[236:239], v[116:119], v[184:187]
    ds_read_b64_tr_b16 v[236:237], v245 offset:32
    ds_read_b64_tr_b16 v[238:239], v245 offset:4256
    s_waitcnt lgkmcnt(8)
    v_mfma_f32_16x16x32_bf16 v[176:179], v[216:219], v[104:107], v[176:179]
    v_exp_f32 v250, v173
    v_mfma_f32_16x16x32_bf16 v[184:187], v[216:219], v[120:123], v[184:187]
    ds_read_b64_tr_b16 v[216:217], v246 offset:0
    ds_read_b64_tr_b16 v[218:219], v246 offset:4224
    v_mfma_f32_16x16x32_bf16 v[176:179], v[220:223], v[108:111], v[176:179]
    v_cvt_pk_bf16_f32 v204, v249, v250
    v_mfma_f32_16x16x32_bf16 v[184:187], v[220:223], v[124:127], v[184:187]
    ds_read_b64_tr_b16 v[220:221], v246 offset:32
    ds_read_b64_tr_b16 v[222:223], v246 offset:4256
    v_mfma_f32_16x16x32_bf16 v[144:147], v[168:171], v[196:199], v[144:147]
    v_exp_f32 v249, v174
    v_mfma_f32_16x16x32_bf16 v[148:151], v[168:171], v[200:203], v[148:151]
    v_exp_f32 v250, v175
    v_mfma_f32_16x16x32_bf16 v[152:155], v[168:171], v[212:215], v[152:155]
    v_cvt_pk_bf16_f32 v205, v249, v250
    s_waitcnt lgkmcnt(8)
    v_mfma_f32_16x16x32_bf16 v[0:3], v[224:227], v[196:199], v[0:3]
    v_exp_f32 v249, v180
    v_mfma_f32_16x16x32_bf16 v[32:35], v[224:227], v[200:203], v[32:35]
    v_exp_f32 v250, v181
    v_mfma_f32_16x16x32_bf16 v[64:67], v[224:227], v[212:215], v[64:67]
    ds_read_b64_tr_b16 v[224:225], v247 offset:0
    ds_read_b64_tr_b16 v[226:227], v247 offset:4224
    v_cvt_pk_bf16_f32 v208, v249, v250
    v_mfma_f32_16x16x32_bf16 v[4:7], v[228:231], v[196:199], v[4:7]
    v_exp_f32 v249, v182
    v_mfma_f32_16x16x32_bf16 v[36:39], v[228:231], v[200:203], v[36:39]
    v_exp_f32 v250, v183
    v_mfma_f32_16x16x32_bf16 v[68:71], v[228:231], v[212:215], v[68:71]
    ds_read_b64_tr_b16 v[228:229], v247 offset:32
    ds_read_b64_tr_b16 v[230:231], v247 offset:4256
    v_cvt_pk_bf16_f32 v209, v249, v250
    s_waitcnt lgkmcnt(8)
    v_mfma_f32_16x16x32_bf16 v[8:11], v[232:235], v[196:199], v[8:11]
    v_exp_f32 v249, v176
    v_exp_f32 v250, v177
    v_mfma_f32_16x16x32_bf16 v[40:43], v[232:235], v[200:203], v[40:43]
    v_cvt_pk_bf16_f32 v206, v249, v250
    v_exp_f32 v249, v178
    v_mfma_f32_16x16x32_bf16 v[72:75], v[232:235], v[212:215], v[72:75]
    v_exp_f32 v250, v179
    v_mfma_f32_16x16x32_bf16 v[12:15], v[236:239], v[196:199], v[12:15]
    v_cvt_pk_bf16_f32 v207, v249, v250
    v_exp_f32 v249, v184
    v_mfma_f32_16x16x32_bf16 v[44:47], v[236:239], v[200:203], v[44:47]
    v_exp_f32 v250, v185
    s_nop 0
    v_cvt_pk_bf16_f32 v210, v249, v250
    v_mfma_f32_16x16x32_bf16 v[76:79], v[236:239], v[212:215], v[76:79]
    v_exp_f32 v249, v186
    s_waitcnt lgkmcnt(0)
    v_add_u32 v244, s15, v244
    v_add_u32 v245, s15, v245
    v_add_u32 v246, s15, v246
    v_add_u32 v247, s15, v247
    s_waitcnt vmcnt(0)
    s_barrier
    ds_read_b64_tr_b16 v[232:233], v245 offset:0
    ds_read_b64_tr_b16 v[234:235], v245 offset:4224
    ds_read_b64_tr_b16 v[236:237], v245 offset:32
    ds_read_b64_tr_b16 v[238:239], v245 offset:4256
    v_mfma_f32_16x16x32_bf16 v[16:19], v[216:219], v[196:199], v[16:19]
    v_exp_f32 v250, v187
    s_nop 0
    v_cvt_pk_bf16_f32 v211, v249, v250
    v_mfma_f32_16x16x32_bf16 v[48:51], v[216:219], v[200:203], v[48:51]
    v_or3_b32 v251, v204, v205, v206
    v_or3_b32 v251, v207, v208, v251
    v_mfma_f32_16x16x32_bf16 v[80:83], v[216:219], v[212:215], v[80:83]
    v_or3_b32 v251, v209, v210, v251
    ds_read_b64_tr_b16 v[216:217], v244 offset:0
    ds_read_b64_tr_b16 v[218:219], v244 offset:4224
    v_mfma_f32_16x16x32_bf16 v[20:23], v[220:223], v[196:199], v[20:23]
    v_or_b32 v251, v211, v251
    v_and_b32 v251, 0x40004000, v251
    v_mfma_f32_16x16x32_bf16 v[52:55], v[220:223], v[200:203], v[52:55]
    v_cmp_ne_u32 vcc, 0, v251
    v_mfma_f32_16x16x32_bf16 v[84:87], v[220:223], v[212:215], v[84:87]
    ds_read_b64_tr_b16 v[220:221], v244 offset:32
    ds_read_b64_tr_b16 v[222:223], v244 offset:4256
    v_mfma_f32_16x16x32_bf16 v[24:27], v[224:227], v[196:199], v[24:27]
    v_mfma_f32_16x16x32_bf16 v[56:59], v[224:227], v[200:203], v[56:59]
    v_mfma_f32_16x16x32_bf16 v[88:91], v[224:227], v[212:215], v[88:91]
    ds_read_b64_tr_b16 v[224:225], v246 offset:0
    ds_read_b64_tr_b16 v[226:227], v246 offset:4224
    v_mfma_f32_16x16x32_bf16 v[28:31], v[228:231], v[196:199], v[28:31]
    v_mfma_f32_16x16x32_bf16 v[60:63], v[228:231], v[200:203], v[60:63]
    v_mfma_f32_16x16x32_bf16 v[92:95], v[228:231], v[212:215], v[92:95]
    ds_read_b64_tr_b16 v[228:229], v246 offset:32
    ds_read_b64_tr_b16 v[230:231], v246 offset:4256
    s_cbranch_vccnz L_tl15_B_rare
L_tl15_next:
    s_mul_i32 s14, s77, 80128
    s_add_u32 s14, s14, 512
    s_mul_i32 s53, s52, 2112
    s_add_u32 s53, s53, s14
    s_cmp_eq_u32 s70, 0
    s_cselect_b32 s12, s12, s22
    s_cselect_b32 s13, s13, s23
    s_and_b32 s62, s71, 30
    s_lshl_b32 s62, s62, 17
    s_lshl_b32 s63, s77, 9
    s_add_u32 s62, s62, s63
    s_sub_u32 s63, 0x40000, s63
    s_add_u32 s36, s12, s62
    s_addc_u32 s37, s13, 0
    s_and_b32 s37, s37, 0xffff
    s_mov_b32 s38, s63
    s_mov_b32 s39, 0x20000
    s_lshl_b32 s62, s52, 13
    s_lshl_b32 s63, s77, 17
    s_add_u32 s4, s62, s63
    s_xor_b32 s5, s4, 0x20000
    s_add_u32 m0, s53, 71680
    s_add_u32 s62, s4, 0
    buffer_load_dwordx4 v252, s[36:39], s62 offen lds
    s_add_u32 m0, s53, 72736
    s_add_u32 s62, s4, 4096
    buffer_load_dwordx4 v252, s[36:39], s62 offen lds
    s_and_b32 s62, s71, 30
    s_lshl_b32 s62, s62, 2
    s_add_u32 s62, s62, s72
    s_lshl_b32 s62, s62, 3
    s_add_u32 s62, s62, s30
    s_lshl_b32 s62, s62, 12
    s_add_u32 s80, s12, s62
    s_addc_u32 s81, s13, 0
    s_and_b32 s81, s81, 0xffff
    s_mov_b32 s82, 0x1000
    s_mov_b32 s83, 0x20000
    s_mov_b32 m0, 160768
    s_nop 0
    buffer_load_dwordx4 v255, s[80:83], 0 offen offset:0 lds
    s_mov_b32 m0, 159744
    s_nop 0
    buffer_load_dwordx4 v255, s[80:83], 0 offen offset:1024 lds
    s_mov_b32 m0, 158720
    s_nop 0
    buffer_load_dwordx4 v255, s[80:83], 0 offen offset:2048 lds
    s_mov_b32 m0, 157696
    s_nop 0
    buffer_load_dwordx4 v255, s[80:83], 0 offen offset:3072 lds
    s_cmp_eq_u32 s31, 3
    s_cbranch_scc1 L_tl16_B
    v_mfma_f32_16x16x32_bf16 v[144:147], v[168:171], v[204:207], v[144:147]
    v_mfma_f32_16x16x32_bf16 v[148:151], v[168:171], v[208:211], v[148:151]
    s_waitcnt lgkmcnt(4)
    v_mfma_f32_16x16x32_bf16 v[0:3], v[216:219], v[204:207], v[0:3]
    v_mfma_f32_16x16x32_bf16 v[32:35], v[216:219], v[208:211], v[32:35]
    ds_read_b64_tr_b16 v[216:217], v247 offset:0
    ds_read_b64_tr_b16 v[218:219], v247 offset:4224
    v_mfma_f32_16x16x32_bf16 v[4:7], v[220:223], v[204:207], v[4:7]
    v_mfma_f32_16x16x32_bf16 v[36:39], v[220:223], v[208:211], v[36:39]
    ds_read_b64_tr_b16 v[220:221], v247 offset:32
    ds_read_b64_tr_b16 v[222:223], v247 offset:4256
    v_mfma_f32_16x16x32_bf16 v[8:11], v[232:235], v[204:207], v[8:11]
    v_mfma_f32_16x16x32_bf16 v[40:43], v[232:235], v[208:211], v[40:43]
    v_mfma_f32_16x16x32_bf16 v[12:15], v[236:239], v[204:207], v[12:15]
    v_mfma_f32_16x16x32_bf16 v[44:47], v[236:239], v[208:211], v[44:47]
    s_waitcnt lgkmcnt(0)
    v_mfma_f32_16x16x32_bf16 v[16:19], v[224:227], v[204:207], v[16:19]
    v_mfma_f32_16x16x32_bf16 v[48:51], v[224:227], v[208:211], v[48:51]
    v_mfma_f32_16x16x32_bf16 v[20:23], v[228:231], v[204:207], v[20:23]
    v_mfma_f32_16x16x32_bf16 v[52:55], v[228:231], v[208:211], v[52:55]
    v_mfma_f32_16x16x32_bf16 v[24:27], v[216:219], v[204:207], v[24:27]
    v_mfma_f32_16x16x32_bf16 v[56:59], v[216:219], v[208:211], v[56:59]
    v_mfma_f32_16x16x32_bf16 v[28:31], v[220:223], v[204:207], v[28:31]
    v_mfma_f32_16x16x32_bf16 v[60:63], v[220:223], v[208:211], v[60:63]
    s_branch L_tl16_next
L_tl16_B:
    v_mfma_f32_16x16x32_bf16 v[144:147], v[168:171], v[204:207], v[144:147]
    v_mfma_f32_16x16x32_bf16 v[148:151], v[168:171], v[208:211], v[148:151]
    v_mfma_f32_16x16x32_bf16 v[152:155], v[168:171], v[212:215], v[152:155]
    s_waitcnt lgkmcnt(4)
    v_mfma_f32_16x16x32_bf16 v[0:3], v[216:219], v[204:207], v[0:3]
    v_mfma_f32_16x16x32_bf16 v[32:35], v[216:219], v[208:211], v[32:35]
    v_mfma_f32_16x16x32_bf16 v[64:67], v[216:219], v[212:215], v[64:67]
    ds_read_b64_tr_b16 v[216:217], v247 offset:0
    ds_read_b64_tr_b16 v[218:219], v247 offset:4224
    v_mfma_f32_16x16x32_bf16 v[4:7], v[220:223], v[204:207], v[4:7]
    v_mfma_f32_16x16x32_bf16 v[36:39], v[220:223], v[208:211], v[36:39]
    v_mfma_f32_16x16x32_bf16 v[68:71], v[220:223], v[212:215], v[68:71]
    ds_read_b64_tr_b16 v[220:221], v247 offset:32
    ds_read_b64_tr_b16 v[222:223], v247 offset:4256
    v_mfma_f32_16x16x32_bf16 v[8:11], v[232:235], v[204:207], v[8:11]
    v_mfma_f32_16x16x32_bf16 v[40:43], v[232:235], v[208:211], v[40:43]
    v_mfma_f32_16x16x32_bf16 v[72:75], v[232:235], v[212:215], v[72:75]
    v_mfma_f32_16x16x32_bf16 v[12:15], v[236:239], v[204:207], v[12:15]
    v_mfma_f32_16x16x32_bf16 v[44:47], v[236:239], v[208:211], v[44:47]
    v_mfma_f32_16x16x32_bf16 v[76:79], v[236:239], v[212:215], v[76:79]
    s_waitcnt lgkmcnt(0)
    v_mfma_f32_16x16x32_bf16 v[16:19], v[224:227], v[204:207], v[16:19]
    v_mfma_f32_16x16x32_bf16 v[48:51], v[224:227], v[208:211], v[48:51]
    v_mfma_f32_16x16x32_bf16 v[80:83], v[224:227], v[212:215], v[80:83]
    v_mfma_f32_16x16x32_bf16 v[20:23], v[228:231], v[204:207], v[20:23]
    v_mfma_f32_16x16x32_bf16 v[52:55], v[228:231], v[208:211], v[52:55]
    v_mfma_f32_16x16x32_bf16 v[84:87], v[228:231], v[212:215], v[84:87]
    v_mfma_f32_16x16x32_bf16 v[24:27], v[216:219], v[204:207], v[24:27]
    v_mfma_f32_16x16x32_bf16 v[56:59], v[216:219], v[208:211], v[56:59]
    v_mfma_f32_16x16x32_bf16 v[88:91], v[216:219], v[212:215], v[88:91]
    v_mfma_f32_16x16x32_bf16 v[28:31], v[220:223], v[204:207], v[28:31]
    v_mfma_f32_16x16x32_bf16 v[60:63], v[220:223], v[208:211], v[60:63]
    v_mfma_f32_16x16x32_bf16 v[92:95], v[220:223], v[212:215], v[92:95]
L_tl16_next:
    s_barrier
    s_mul_i32 s62, s52, 8704
    s_add_u32 s62, s62, s14
    v_add_u32 v216, s62, v255
    ds_write_b128 v216, v[64:67] offset:0
    ds_write_b128 v216, v[68:71] offset:1024
    ds_write_b128 v216, v[72:75] offset:2048
    ds_write_b128 v216, v[76:79] offset:3072
    ds_write_b128 v216, v[80:83] offset:4096
    ds_write_b128 v216, v[84:87] offset:5120
    ds_write_b128 v216, v[88:91] offset:6144
    ds_write_b128 v216, v[92:95] offset:7168
    v_lshrrev_b32 v217, 2, v255
    v_add_u32 v218, s62, v217
    v_add_u32 v217, s14, v217
    ds_write_b32 v218, v152 offset:8192
    ds_write_b32 v218, v164 offset:8448
    v_rcp_f32 v219, v144
    v_rcp_f32 v220, v148
    s_waitcnt lgkmcnt(0)
    s_barrier
    s_lshl_b32 s63, s52, 11
    s_add_u32 s62, s63, s14
    v_add_u32 v216, s62, v255
    ds_read_b128 v[96:99], v216 offset:0
    ds_read_b128 v[100:103], v216 offset:1024
    ds_read_b128 v[104:107], v216 offset:8704
    ds_read_b128 v[108:111], v216 offset:9728
    ds_read_b128 v[112:115], v216 offset:17408
    ds_read_b128 v[116:119], v216 offset:18432
    ds_read_b128 v[120:123], v216 offset:26112
    ds_read_b128 v[124:127], v216 offset:27136
    ds_read_b32 v200, v217 offset:8192
    ds_read_b32 v201, v217 offset:16896
    ds_read_b32 v202, v217 offset:25600
    ds_read_b32 v203, v217 offset:34304
    s_lshl_b32 s62, s52, 13
    s_add_u32 s62, s62, s14
    v_add_u32 v218, s62, v255
    v_mul_f32 v0, v0, v219
    v_mul_f32 v1, v1, v219
    v_mul_f32 v2, v2, v219
    v_mul_f32 v3, v3, v219
    v_mul_f32 v4, v4, v219
    v_mul_f32 v5, v5, v219
    v_mul_f32 v6, v6, v219
    v_mul_f32 v7, v7, v219
    v_cvt_pk_bf16_f32 v128, v0, v1
    v_cvt_pk_bf16_f32 v129, v2, v3
    v_cvt_pk_bf16_f32 v130, v4, v5
    v_cvt_pk_bf16_f32 v131, v6, v7
    ds_write_b128 v218, v[128:131] offset:34816
    v_mul_f32 v32, v32, v220
    v_mul_f32 v33, v33, v220
    v_mul_f32 v34, v34, v220
    v_mul_f32 v35, v35, v220
    v_mul_f32 v36, v36, v220
    v_mul_f32 v37, v37, v220
    v_mul_f32 v38, v38, v220
    v_mul_f32 v39, v39, v220
    v_cvt_pk_bf16_f32 v132, v32, v33
    v_cvt_pk_bf16_f32 v133, v34, v35
    v_cvt_pk_bf16_f32 v134, v36, v37
    v_cvt_pk_bf16_f32 v135, v38, v39
    ds_write_b128 v218, v[132:135] offset:35840
    s_waitcnt lgkmcnt(2)
    ds_read_b32 v204, v217 offset:8448
    ds_read_b32 v205, v217 offset:17152
    ds_read_b32 v206, v217 offset:25856
    ds_read_b32 v207, v217 offset:34560
    v_mul_f32 v8, v8, v219
    v_mul_f32 v9, v9, v219
    v_mul_f32 v10, v10, v219
    v_mul_f32 v11, v11, v219
    v_mul_f32 v12, v12, v219
    v_mul_f32 v13, v13, v219
    v_mul_f32 v14, v14, v219
    v_mul_f32 v15, v15, v219
    v_cvt_pk_bf16_f32 v140, v8, v9
    v_cvt_pk_bf16_f32 v141, v10, v11
    v_cvt_pk_bf16_f32 v142, v12, v13
    v_cvt_pk_bf16_f32 v143, v14, v15
    ds_write_b128 v218, v[140:143] offset:36864
    v_mul_f32 v40, v40, v220
    v_mul_f32 v41, v41, v220
    v_mul_f32 v42, v42, v220
    v_mul_f32 v43, v43, v220
    v_mul_f32 v44, v44, v220
    v_mul_f32 v45, v45, v220
    v_mul_f32 v46, v46, v220
    v_mul_f32 v47, v47, v220
    v_cvt_pk_bf16_f32 v144, v40, v41
    v_cvt_pk_bf16_f32 v145, v42, v43
    v_cvt_pk_bf16_f32 v146, v44, v45
    v_cvt_pk_bf16_f32 v147, v46, v47
    ds_write_b128 v218, v[144:147] offset:37888
    v_mul_f32 v16, v16, v219
    v_mul_f32 v17, v17, v219
    v_mul_f32 v18, v18, v219
    v_mul_f32 v19, v19, v219
    v_mul_f32 v20, v20, v219
    v_mul_f32 v21, v21, v219
    v_mul_f32 v22, v22, v219
    v_mul_f32 v23, v23, v219
    v_cvt_pk_bf16_f32 v152, v16, v17
    v_cvt_pk_bf16_f32 v153, v18, v19
    v_cvt_pk_bf16_f32 v154, v20, v21
    v_cvt_pk_bf16_f32 v155, v22, v23
    ds_write_b128 v218, v[152:155] offset:38912
    v_mul_f32 v48, v48, v220
    v_mul_f32 v49, v49, v220
    v_mul_f32 v50, v50, v220
    v_mul_f32 v51, v51, v220
    v_mul_f32 v52, v52, v220
    v_mul_f32 v53, v53, v220
    v_mul_f32 v54, v54, v220
    v_mul_f32 v55, v55, v220
    v_cvt_pk_bf16_f32 v156, v48, v49
    v_cvt_pk_bf16_f32 v157, v50, v51
    v_cvt_pk_bf16_f32 v158, v52, v53
    v_cvt_pk_bf16_f32 v159, v54, v55
    ds_write_b128 v218, v[156:159] offset:39936
    v_mul_f32 v24, v24, v219
    v_mul_f32 v25, v25, v219
    v_mul_f32 v26, v26, v219
    v_mul_f32 v27, v27, v219
    v_mul_f32 v28, v28, v219
    v_mul_f32 v29, v29, v219
    v_mul_f32 v30, v30, v219
    v_mul_f32 v31, v31, v219
    v_cvt_pk_bf16_f32 v164, v24, v25
    v_cvt_pk_bf16_f32 v165, v26, v27
    v_cvt_pk_bf16_f32 v166, v28, v29
    v_cvt_pk_bf16_f32 v167, v30, v31
    ds_write_b128 v218, v[164:167] offset:40960
    v_mul_f32 v56, v56, v220
    v_mul_f32 v57, v57, v220
    v_mul_f32 v58, v58, v220
    v_mul_f32 v59, v59, v220
    v_mul_f32 v60, v60, v220
    v_mul_f32 v61, v61, v220
    v_mul_f32 v62, v62, v220
    v_mul_f32 v63, v63, v220
    v_cvt_pk_bf16_f32 v168, v56, v57
    v_cvt_pk_bf16_f32 v169, v58, v59
    v_cvt_pk_bf16_f32 v170, v60, v61
    v_cvt_pk_bf16_f32 v171, v62, v63
    ds_write_b128 v218, v[168:171] offset:41984
    s_waitcnt lgkmcnt(6)
    v_min3_f32 v208, v204, v205, v206
    v_min_f32 v208, v208, v207
    v_sub_f32 v204, v208, v204
    v_exp_f32 v204, v204
    v_sub_f32 v205, v208, v205
    v_exp_f32 v205, v205
    v_sub_f32 v206, v208, v206
    v_exp_f32 v206, v206
    v_sub_f32 v207, v208, v207
    v_exp_f32 v207, v207
    v_mul_f32 v209, v200, v204
    v_fma_f32 v209, v201, v205, v209
    v_fma_f32 v209, v202, v206, v209
    v_fma_f32 v209, v203, v207, v209
    v_rcp_f32 v209, v209
    v_mul_f32 v96, v96, v204
    v_fma_f32 v96, v104, v205, v96
    v_fma_f32 v96, v112, v206, v96
    v_fma_f32 v96, v120, v207, v96
    v_mul_f32 v97, v97, v204
    v_fma_f32 v97, v105, v205, v97
    v_fma_f32 v97, v113, v206, v97
    v_fma_f32 v97, v121, v207, v97
    v_mul_f32 v98, v98, v204
    v_fma_f32 v98, v106, v205, v98
    v_fma_f32 v98, v114, v206, v98
    v_fma_f32 v98, v122, v207, v98
    v_mul_f32 v99, v99, v204
    v_fma_f32 v99, v107, v205, v99
    v_fma_f32 v99, v115, v206, v99
    v_fma_f32 v99, v123, v207, v99
    v_mul_f32 v100, v100, v204
    v_fma_f32 v100, v108, v205, v100
    v_fma_f32 v100, v116, v206, v100
    v_fma_f32 v100, v124, v207, v100
    v_mul_f32 v101, v101, v204
    v_fma_f32 v101, v109, v205, v101
    v_fma_f32 v101, v117, v206, v101
    v_fma_f32 v101, v125, v207, v101
    v_mul_f32 v102, v102, v204
    v_fma_f32 v102, v110, v205, v102
    v_fma_f32 v102, v118, v206, v102
    v_fma_f32 v102, v126, v207, v102
    v_mul_f32 v103, v103, v204
    v_fma_f32 v103, v111, v205, v103
    v_fma_f32 v103, v119, v206, v103
    v_fma_f32 v103, v127, v207, v103
    v_mul_f32 v96, v96, v209
    v_mul_f32 v97, v97, v209
    v_mul_f32 v98, v98, v209
    v_mul_f32 v99, v99, v209
    v_mul_f32 v100, v100, v209
    v_mul_f32 v101, v101, v209
    v_mul_f32 v102, v102, v209
    v_mul_f32 v103, v103, v209
    v_cvt_pk_bf16_f32 v212, v96, v97
    v_cvt_pk_bf16_f32 v213, v98, v99
    v_cvt_pk_bf16_f32 v214, v100, v101
    v_cvt_pk_bf16_f32 v215, v102, v103
    s_lshl_b32 s62, s52, 10
    s_add_u32 s62, s62, s14
    s_add_u32 s62, s62, 34816
    v_add_u32 v216, s62, v255
    ds_write_b128 v216, v[212:215] offset:32768
    v_lshrrev_b32 v240, 4, v255
    v_lshrrev_b32 v241, 4, v240
    v_bfe_u32 v243, v240, 2, 2
    v_and_b32 v244, 3, v240
    v_lshlrev_b32 v245, 8, v243
    v_lshl_add_u32 v245, v244, 3, v245
    s_movk_i32 s63, 1056
    v_mad_u32_u24 v245, v241, s63, v245
    v_add_u32 v245, s14, v245
    v_xor_b32 v246, s52, v243
    v_xor_b32 v247, 0, v246
    v_lshl_add_u32 v64, v247, 6, v245
    v_add_u32 v68, 33792, v64
    v_xor_b32 v247, 1, v246
    v_lshl_add_u32 v65, v247, 6, v245
    v_add_u32 v69, 33792, v65
    v_xor_b32 v247, 2, v246
    v_lshl_add_u32 v66, v247, 6, v245
    v_add_u32 v70, 33792, v66
    v_xor_b32 v247, 3, v246
    v_lshl_add_u32 v67, v247, 6, v245
    v_add_u32 v71, 33792, v67
    s_lshr_b32 s62, s71, 1
    s_lshl_b32 s62, s62, 1
    s_add_u32 s62, s62, s70
    s_lshl_b32 s62, s62, 3
    s_add_u32 s62, s62, s72
    s_lshl_b32 s62, s62, 1
    s_add_u32 s62, s62, s77
    s_lshl_b32 s62, s62, 3
    s_add_u32 s62, s62, s52
    s_mul_i32 s62, s62, 9216
    s_add_u32 s62, s62, 0x2000000
    s_add_u32 s40, s28, s62
    s_addc_u32 s41, s29, 0
    s_and_b32 s41, s41, 0xffff
    s_mov_b32 s42, 0xb400
    s_mov_b32 s43, 0x20000
    v_add_u32 v250, 0x1000, v255
    v_add_u32 v251, 0x2000, v255
    s_waitcnt lgkmcnt(0)
    s_waitcnt vmcnt(4)
    s_barrier
    s_mov_b32 s63, 115968
    s_sub_u32 s63, s63, s14
    s_add_u32 s62, s14, 34816
    v_add_u32 v246, s62, v255
    ds_read_b128 v[136:139], v246 offset:32768
    ds_read_b128 v[148:151], v246 offset:33792
    ds_read_b128 v[160:163], v246 offset:34816
    ds_read_b128 v[172:175], v246 offset:35840
    s_add_u32 m0, s53, 0
    s_add_u32 s62, s4, 32768
    buffer_load_dwordx4 v252, s[36:39], s62 offen lds
    s_add_u32 m0, s53, 1056
    s_add_u32 s62, s4, 36864
    buffer_load_dwordx4 v252, s[36:39], s62 offen lds
    s_add_u32 m0, s53, 8448
    s_add_u32 s62, s4, 65536
    buffer_load_dwordx4 v252, s[36:39], s62 offen lds
    s_add_u32 m0, s53, 9504
    s_add_u32 s62, s4, 69632
    buffer_load_dwordx4 v252, s[36:39], s62 offen lds
    s_add_u32 m0, s53, 16896
    s_add_u32 s62, s4, 98304
    buffer_load_dwordx4 v252, s[36:39], s62 offen lds
    s_add_u32 m0, s53, 17952
    s_add_u32 s62, s4, 102400
    buffer_load_dwordx4 v252, s[36:39], s62 offen lds
    s_add_u32 m0, s53, 25344
    s_add_u32 s62, s5, 0
    buffer_load_dwordx4 v252, s[36:39], s62 offen lds
    s_add_u32 m0, s53, 26400
    s_add_u32 s62, s5, 4096
    buffer_load_dwordx4 v252, s[36:39], s62 offen lds
    v_add_u32 v247, s63, v255
    s_lshl_b32 s62, s52, 13
    v_add_u32 v248, s62, v247
    s_mov_b32 s59, 36864
    ds_read_b64_tr_b16 v[176:177], v68 offset:37888
    ds_read_b64_tr_b16 v[178:179], v68 offset:42112
    ds_read_b64_tr_b16 v[180:181], v68 offset:37920
    ds_read_b64_tr_b16 v[182:183], v68 offset:42144
    ds_read_b64_tr_b16 v[184:185], v69 offset:37888
    ds_read_b64_tr_b16 v[186:187], v69 offset:42112
    ds_read_b64_tr_b16 v[188:189], v69 offset:37920
    ds_read_b64_tr_b16 v[190:191], v69 offset:42144
    ds_read_b64_tr_b16 v[192:193], v70 offset:37888
    ds_read_b64_tr_b16 v[194:195], v70 offset:42112
    ds_read_b64_tr_b16 v[196:197], v70 offset:37920
    ds_read_b64_tr_b16 v[198:199], v70 offset:42144
    s_waitcnt lgkmcnt(8)
    v_mfma_f32_16x16x32_bf16 v[0:3], v[176:179], v[128:131], 0
    ds_read_b128 v[72:75], v248 offset:0
    ds_read_b128 v[76:79], v248 offset:1024
    v_mfma_f32_16x16x32_bf16 v[32:35], v[176:179], v[132:135], 0
    ds_read_b64_tr_b16 v[200:201], v71 offset:37888
    ds_read_b64_tr_b16 v[202:203], v71 offset:42112
    v_mfma_f32_16x16x32_bf16 v[120:123], v[176:179], v[136:139], 0
    ds_read_b128 v[80:83], v247 offset:32768
    ds_read_b128 v[84:87], v248 offset:2048
    v_mfma_f32_16x16x32_bf16 v[4:7], v[180:183], v[128:131], 0
    ds_read_b64_tr_b16 v[204:205], v71 offset:37920
    ds_read_b64_tr_b16 v[206:207], v71 offset:42144
    v_mfma_f32_16x16x32_bf16 v[36:39], v[180:183], v[132:135], 0
    ds_read_b128 v[88:91], v248 offset:3072
    ds_read_b128 v[92:95], v247 offset:33792
    v_mfma_f32_16x16x32_bf16 v[124:127], v[180:183], v[136:139], 0
    s_waitcnt lgkmcnt(14)
    v_mfma_f32_16x16x32_bf16 v[8:11], v[184:187], v[128:131], 0
    v_mfma_f32_16x16x32_bf16 v[40:43], v[184:187], v[132:135], 0
    v_mfma_f32_16x16x32_bf16 v[12:15], v[188:191], v[128:131], 0
    v_mfma_f32_16x16x32_bf16 v[44:47], v[188:191], v[132:135], 0
    s_waitcnt lgkmcnt(0)
    s_waitcnt vmcnt(6)
    s_barrier
    v_mfma_f32_16x16x32_bf16 v[16:19], v[192:195], v[128:131], 0
    ds_read_b64_tr_b16 v[208:209], v64 offset:0
    ds_read_b64_tr_b16 v[210:211], v64 offset:4224
    v_mfma_f32_16x16x32_bf16 v[48:51], v[192:195], v[132:135], 0
    ds_read_b64_tr_b16 v[212:213], v64 offset:32
    ds_read_b64_tr_b16 v[214:215], v64 offset:4256
    v_mfma_f32_16x16x32_bf16 v[20:23], v[196:199], v[128:131], 0
    ds_read_b64_tr_b16 v[176:177], v65 offset:0
    ds_read_b64_tr_b16 v[178:179], v65 offset:4224
    v_mfma_f32_16x16x32_bf16 v[52:55], v[196:199], v[132:135], 0
    ds_read_b64_tr_b16 v[180:181], v65 offset:32
    ds_read_b64_tr_b16 v[182:183], v65 offset:4256
    v_mfma_f32_16x16x32_bf16 v[24:27], v[200:203], v[128:131], 0
    ds_read_b64_tr_b16 v[184:185], v66 offset:0
    ds_read_b64_tr_b16 v[186:187], v66 offset:4224
    v_mfma_f32_16x16x32_bf16 v[56:59], v[200:203], v[132:135], 0
    ds_read_b64_tr_b16 v[188:189], v66 offset:32
    ds_read_b64_tr_b16 v[190:191], v66 offset:4256
    v_mfma_f32_16x16x32_bf16 v[28:31], v[204:207], v[128:131], 0
    v_mfma_f32_16x16x32_bf16 v[60:63], v[204:207], v[132:135], 0
    s_waitcnt lgkmcnt(8)
    v_mfma_f32_16x16x32_bf16 v[0:3], v[208:211], v[140:143], v[0:3]
    ds_read_b128 v[96:99], v248 offset:4096
    ds_read_b128 v[100:103], v248 offset:5120
    v_mfma_f32_16x16x32_bf16 v[32:35], v[208:211], v[144:147], v[32:35]
    ds_read_b64_tr_b16 v[192:193], v67 offset:0
    ds_read_b64_tr_b16 v[194:195], v67 offset:4224
    v_mfma_f32_16x16x32_bf16 v[120:123], v[208:211], v[148:151], v[120:123]
    ds_read_b128 v[104:107], v247 offset:34816
    ds_read_b128 v[108:111], v248 offset:6144
    v_mfma_f32_16x16x32_bf16 v[4:7], v[212:215], v[140:143], v[4:7]
    ds_read_b64_tr_b16 v[196:197], v67 offset:32
    ds_read_b64_tr_b16 v[198:199], v67 offset:4256
    v_mfma_f32_16x16x32_bf16 v[36:39], v[212:215], v[144:147], v[36:39]
    ds_read_b128 v[112:115], v248 offset:7168
    ds_read_b128 v[116:119], v247 offset:35840
    v_mfma_f32_16x16x32_bf16 v[124:127], v[212:215], v[148:151], v[124:127]
    s_waitcnt lgkmcnt(14)
    v_mfma_f32_16x16x32_bf16 v[8:11], v[176:179], v[140:143], v[8:11]
    v_mfma_f32_16x16x32_bf16 v[40:43], v[176:179], v[144:147], v[40:43]
    v_mfma_f32_16x16x32_bf16 v[12:15], v[180:183], v[140:143], v[12:15]
    v_mfma_f32_16x16x32_bf16 v[44:47], v[180:183], v[144:147], v[44:47]
    s_waitcnt lgkmcnt(0)
    s_waitcnt vmcnt(4)
    s_barrier
    v_mfma_f32_16x16x32_bf16 v[16:19], v[184:187], v[140:143], v[16:19]
    ds_read_b64_tr_b16 v[200:201], v64 offset:8448
    ds_read_b64_tr_b16 v[202:203], v64 offset:12672
    v_mfma_f32_16x16x32_bf16 v[48:51], v[184:187], v[144:147], v[48:51]
    ds_read_b64_tr_b16 v[204:205], v64 offset:8480
    ds_read_b64_tr_b16 v[206:207], v64 offset:12704
    v_mfma_f32_16x16x32_bf16 v[20:23], v[188:191], v[140:143], v[20:23]
    ds_read_b64_tr_b16 v[208:209], v65 offset:8448
    ds_read_b64_tr_b16 v[210:211], v65 offset:12672
    v_mfma_f32_16x16x32_bf16 v[52:55], v[188:191], v[144:147], v[52:55]
    ds_read_b64_tr_b16 v[212:213], v65 offset:8480
    ds_read_b64_tr_b16 v[214:215], v65 offset:12704
    v_mfma_f32_16x16x32_bf16 v[24:27], v[192:195], v[140:143], v[24:27]
    ds_read_b64_tr_b16 v[176:177], v66 offset:8448
    ds_read_b64_tr_b16 v[178:179], v66 offset:12672
    v_mfma_f32_16x16x32_bf16 v[56:59], v[192:195], v[144:147], v[56:59]
    ds_read_b64_tr_b16 v[180:181], v66 offset:8480
    ds_read_b64_tr_b16 v[182:183], v66 offset:12704
    v_mfma_f32_16x16x32_bf16 v[28:31], v[196:199], v[140:143], v[28:31]
    v_mfma_f32_16x16x32_bf16 v[60:63], v[196:199], v[144:147], v[60:63]
    s_waitcnt lgkmcnt(8)
    v_mfma_f32_16x16x32_bf16 v[0:3], v[200:203], v[152:155], v[0:3]
    s_add_u32 m0, s53, 33792
    s_add_u32 s62, s5, 32768
    buffer_load_dwordx4 v252, s[36:39], s62 offen lds
    v_mfma_f32_16x16x32_bf16 v[32:35], v[200:203], v[156:159], v[32:35]
    ds_read_b64_tr_b16 v[184:185], v67 offset:8448
    ds_read_b64_tr_b16 v[186:187], v67 offset:12672
    v_mfma_f32_16x16x32_bf16 v[120:123], v[200:203], v[160:163], v[120:123]
    s_add_u32 m0, s53, 34848
    s_add_u32 s62, s5, 36864
    buffer_load_dwordx4 v252, s[36:39], s62 offen lds
    v_mfma_f32_16x16x32_bf16 v[4:7], v[204:207], v[152:155], v[4:7]
    ds_read_b64_tr_b16 v[188:189], v67 offset:8480
    ds_read_b64_tr_b16 v[190:191], v67 offset:12704
    v_mfma_f32_16x16x32_bf16 v[36:39], v[204:207], v[156:159], v[36:39]
    s_add_u32 m0, s53, 42240
    s_add_u32 s62, s5, 65536
    buffer_load_dwordx4 v252, s[36:39], s62 offen lds
    v_mfma_f32_16x16x32_bf16 v[124:127], v[204:207], v[160:163], v[124:127]
    s_waitcnt lgkmcnt(8)
    v_mfma_f32_16x16x32_bf16 v[8:11], v[208:211], v[152:155], v[8:11]
    s_add_u32 m0, s53, 43296
    s_add_u32 s62, s5, 69632
    buffer_load_dwordx4 v252, s[36:39], s62 offen lds
    v_mfma_f32_16x16x32_bf16 v[40:43], v[208:211], v[156:159], v[40:43]
    v_mfma_f32_16x16x32_bf16 v[12:15], v[212:215], v[152:155], v[12:15]
    s_add_u32 m0, s53, 50688
    s_add_u32 s62, s5, 98304
    buffer_load_dwordx4 v252, s[36:39], s62 offen lds
    v_mfma_f32_16x16x32_bf16 v[44:47], v[212:215], v[156:159], v[44:47]
    s_add_u32 m0, s53, 51744
    s_add_u32 s62, s5, 102400
    buffer_load_dwordx4 v252, s[36:39], s62 offen lds
    s_add_u32 m0, s53, 59136
    s_add_u32 s62, s4, 256
    buffer_load_dwordx4 v252, s[36:39], s62 offen lds
    s_add_u32 m0, s53, 60192
    s_add_u32 s62, s4, 4352
    buffer_load_dwordx4 v252, s[36:39], s62 offen lds
    s_add_u32 m0, s53, 0
    s_add_u32 s62, s4, 33024
    buffer_load_dwordx4 v252, s[36:39], s62 offen lds
    s_add_u32 m0, s53, 1056
    s_add_u32 s62, s4, 37120
    buffer_load_dwordx4 v252, s[36:39], s62 offen lds
    s_waitcnt lgkmcnt(0)
    s_waitcnt vmcnt(12)
    s_barrier
    v_mfma_f32_16x16x32_bf16 v[16:19], v[176:179], v[152:155], v[16:19]
    ds_read_b64_tr_b16 v[192:193], v64 offset:16896
    ds_read_b64_tr_b16 v[194:195], v64 offset:21120
    v_mfma_f32_16x16x32_bf16 v[48:51], v[176:179], v[156:159], v[48:51]
    ds_read_b64_tr_b16 v[196:197], v64 offset:16928
    ds_read_b64_tr_b16 v[198:199], v64 offset:21152
    v_mfma_f32_16x16x32_bf16 v[20:23], v[180:183], v[152:155], v[20:23]
    ds_read_b64_tr_b16 v[200:201], v65 offset:16896
    ds_read_b64_tr_b16 v[202:203], v65 offset:21120
    v_mfma_f32_16x16x32_bf16 v[52:55], v[180:183], v[156:159], v[52:55]
    ds_read_b64_tr_b16 v[204:205], v65 offset:16928
    ds_read_b64_tr_b16 v[206:207], v65 offset:21152
    v_mfma_f32_16x16x32_bf16 v[24:27], v[184:187], v[152:155], v[24:27]
    ds_read_b64_tr_b16 v[208:209], v66 offset:16896
    ds_read_b64_tr_b16 v[210:211], v66 offset:21120
    v_mfma_f32_16x16x32_bf16 v[56:59], v[184:187], v[156:159], v[56:59]
    ds_read_b64_tr_b16 v[212:213], v66 offset:16928
    ds_read_b64_tr_b16 v[214:215], v66 offset:21152
    v_mfma_f32_16x16x32_bf16 v[28:31], v[188:191], v[152:155], v[28:31]
    v_mfma_f32_16x16x32_bf16 v[60:63], v[188:191], v[156:159], v[60:63]
    s_waitcnt lgkmcnt(8)
    v_mfma_f32_16x16x32_bf16 v[0:3], v[192:195], v[164:167], v[0:3]
    s_add_u32 m0, s53, 8448
    s_add_u32 s62, s4, 65792
    buffer_load_dwordx4 v252, s[36:39], s62 offen lds
    v_mfma_f32_16x16x32_bf16 v[32:35], v[192:195], v[168:171], v[32:35]
    ds_read_b64_tr_b16 v[176:177], v67 offset:16896
    ds_read_b64_tr_b16 v[178:179], v67 offset:21120
    v_mfma_f32_16x16x32_bf16 v[120:123], v[192:195], v[172:175], v[120:123]
    s_add_u32 m0, s53, 9504
    s_add_u32 s62, s4, 69888
    buffer_load_dwordx4 v252, s[36:39], s62 offen lds
    v_mfma_f32_16x16x32_bf16 v[4:7], v[196:199], v[164:167], v[4:7]
    ds_read_b64_tr_b16 v[180:181], v67 offset:16928
    ds_read_b64_tr_b16 v[182:183], v67 offset:21152
    v_mfma_f32_16x16x32_bf16 v[36:39], v[196:199], v[168:171], v[36:39]
    v_mfma_f32_16x16x32_bf16 v[124:127], v[196:199], v[172:175], v[124:127]
    s_waitcnt lgkmcnt(8)
    v_mfma_f32_16x16x32_bf16 v[8:11], v[200:203], v[164:167], v[8:11]
    v_mfma_f32_16x16x32_bf16 v[40:43], v[200:203], v[168:171], v[40:43]
    v_mfma_f32_16x16x32_bf16 v[12:15], v[204:207], v[164:167], v[12:15]
    v_mfma_f32_16x16x32_bf16 v[44:47], v[204:207], v[168:171], v[44:47]
    s_waitcnt lgkmcnt(0)
    s_waitcnt vmcnt(12)
    s_barrier
    v_mfma_f32_16x16x32_bf16 v[16:19], v[208:211], v[164:167], v[16:19]
    ds_read_b64_tr_b16 v[184:185], v64 offset:25344
    ds_read_b64_tr_b16 v[186:187], v64 offset:29568
    v_mfma_f32_16x16x32_bf16 v[48:51], v[208:211], v[168:171], v[48:51]
    ds_read_b64_tr_b16 v[188:189], v64 offset:25376
    ds_read_b64_tr_b16 v[190:191], v64 offset:29600
    v_mfma_f32_16x16x32_bf16 v[20:23], v[212:215], v[164:167], v[20:23]
    ds_read_b64_tr_b16 v[192:193], v65 offset:25344
    ds_read_b64_tr_b16 v[194:195], v65 offset:29568
    v_mfma_f32_16x16x32_bf16 v[52:55], v[212:215], v[168:171], v[52:55]
    ds_read_b64_tr_b16 v[196:197], v65 offset:25376
    ds_read_b64_tr_b16 v[198:199], v65 offset:29600
    v_mfma_f32_16x16x32_bf16 v[24:27], v[176:179], v[164:167], v[24:27]
    ds_read_b64_tr_b16 v[200:201], v66 offset:25344
    ds_read_b64_tr_b16 v[202:203], v66 offset:29568
    v_mfma_f32_16x16x32_bf16 v[56:59], v[176:179], v[168:171], v[56:59]
    ds_read_b64_tr_b16 v[204:205], v66 offset:25376
    ds_read_b64_tr_b16 v[206:207], v66 offset:29600
    v_mfma_f32_16x16x32_bf16 v[28:31], v[180:183], v[164:167], v[28:31]
    v_mfma_f32_16x16x32_bf16 v[60:63], v[180:183], v[168:171], v[60:63]
    s_waitcnt lgkmcnt(8)
    v_mfma_f32_16x16x32_bf16 v[0:3], v[184:187], v[72:75], v[0:3]
    s_add_u32 m0, s53, 16896
    s_add_u32 s62, s4, 98560
    buffer_load_dwordx4 v252, s[36:39], s62 offen lds
    v_mfma_f32_16x16x32_bf16 v[32:35], v[184:187], v[76:79], v[32:35]
    ds_read_b64_tr_b16 v[208:209], v67 offset:25344
    ds_read_b64_tr_b16 v[210:211], v67 offset:29568
    v_mfma_f32_16x16x32_bf16 v[120:123], v[184:187], v[80:83], v[120:123]
    s_add_u32 m0, s53, 17952
    s_add_u32 s62, s4, 102656
    buffer_load_dwordx4 v252, s[36:39], s62 offen lds
    v_mfma_f32_16x16x32_bf16 v[4:7], v[188:191], v[72:75], v[4:7]
    ds_read_b64_tr_b16 v[212:213], v67 offset:25376
    ds_read_b64_tr_b16 v[214:215], v67 offset:29600
    v_mfma_f32_16x16x32_bf16 v[36:39], v[188:191], v[76:79], v[36:39]
    v_mfma_f32_16x16x32_bf16 v[124:127], v[188:191], v[80:83], v[124:127]
    s_waitcnt lgkmcnt(8)
    v_mfma_f32_16x16x32_bf16 v[8:11], v[192:195], v[72:75], v[8:11]
    v_mfma_f32_16x16x32_bf16 v[40:43], v[192:195], v[76:79], v[40:43]
    v_mfma_f32_16x16x32_bf16 v[12:15], v[196:199], v[72:75], v[12:15]
    v_mfma_f32_16x16x32_bf16 v[44:47], v[196:199], v[76:79], v[44:47]
    s_waitcnt lgkmcnt(0)
    s_waitcnt vmcnt(12)
    s_barrier
    v_mfma_f32_16x16x32_bf16 v[16:19], v[200:203], v[72:75], v[16:19]
    ds_read_b64_tr_b16 v[176:177], v68 offset:0
    ds_read_b64_tr_b16 v[178:179], v68 offset:4224
    v_mfma_f32_16x16x32_bf16 v[48:51], v[200:203], v[76:79], v[48:51]
    ds_read_b64_tr_b16 v[180:181], v68 offset:32
    ds_read_b64_tr_b16 v[182:183], v68 offset:4256
    v_mfma_f32_16x16x32_bf16 v[20:23], v[204:207], v[72:75], v[20:23]
    ds_read_b64_tr_b16 v[184:185], v69 offset:0
    ds_read_b64_tr_b16 v[186:187], v69 offset:4224
    v_mfma_f32_16x16x32_bf16 v[52:55], v[204:207], v[76:79], v[52:55]
    ds_read_b64_tr_b16 v[188:189], v69 offset:32
    ds_read_b64_tr_b16 v[190:191], v69 offset:4256
    v_mfma_f32_16x16x32_bf16 v[24:27], v[208:211], v[72:75], v[24:27]
    ds_read_b64_tr_b16 v[192:193], v70 offset:0
    ds_read_b64_tr_b16 v[194:195], v70 offset:4224
    v_mfma_f32_16x16x32_bf16 v[56:59], v[208:211], v[76:79], v[56:59]
    ds_read_b64_tr_b16 v[196:197], v70 offset:32
    ds_read_b64_tr_b16 v[198:199], v70 offset:4256
    v_mfma_f32_16x16x32_bf16 v[28:31], v[212:215], v[72:75], v[28:31]
    v_mfma_f32_16x16x32_bf16 v[60:63], v[212:215], v[76:79], v[60:63]
    s_waitcnt lgkmcnt(8)
    v_mfma_f32_16x16x32_bf16 v[0:3], v[176:179], v[84:87], v[0:3]
    s_add_u32 m0, s53, 25344
    s_add_u32 s62, s5, 256
    buffer_load_dwordx4 v252, s[36:39], s62 offen lds
    v_mfma_f32_16x16x32_bf16 v[32:35], v[176:179], v[88:91], v[32:35]
    ds_read_b64_tr_b16 v[200:201], v71 offset:0
    ds_read_b64_tr_b16 v[202:203], v71 offset:4224
    v_mfma_f32_16x16x32_bf16 v[120:123], v[176:179], v[92:95], v[120:123]
    s_add_u32 m0, s53, 26400
    s_add_u32 s62, s5, 4352
    buffer_load_dwordx4 v252, s[36:39], s62 offen lds
    v_mfma_f32_16x16x32_bf16 v[4:7], v[180:183], v[84:87], v[4:7]
    ds_read_b64_tr_b16 v[204:205], v71 offset:32
    ds_read_b64_tr_b16 v[206:207], v71 offset:4256
    v_mfma_f32_16x16x32_bf16 v[36:39], v[180:183], v[88:91], v[36:39]
    v_mfma_f32_16x16x32_bf16 v[124:127], v[180:183], v[92:95], v[124:127]
    s_waitcnt lgkmcnt(8)
    v_mfma_f32_16x16x32_bf16 v[8:11], v[184:187], v[84:87], v[8:11]
    v_mfma_f32_16x16x32_bf16 v[40:43], v[184:187], v[88:91], v[40:43]
    v_mfma_f32_16x16x32_bf16 v[12:15], v[188:191], v[84:87], v[12:15]
    v_mfma_f32_16x16x32_bf16 v[44:47], v[188:191], v[88:91], v[44:47]
    s_waitcnt lgkmcnt(0)
    s_waitcnt vmcnt(12)
    s_barrier
    v_mfma_f32_16x16x32_bf16 v[16:19], v[192:195], v[84:87], v[16:19]
    ds_read_b64_tr_b16 v[208:209], v68 offset:8448
    ds_read_b64_tr_b16 v[210:211], v68 offset:12672
    v_mfma_f32_16x16x32_bf16 v[48:51], v[192:195], v[88:91], v[48:51]
    ds_read_b64_tr_b16 v[212:213], v68 offset:8480
    ds_read_b64_tr_b16 v[214:215], v68 offset:12704
    v_mfma_f32_16x16x32_bf16 v[20:23], v[196:199], v[84:87], v[20:23]
    ds_read_b64_tr_b16 v[176:177], v69 offset:8448
    ds_read_b64_tr_b16 v[178:179], v69 offset:12672
    v_mfma_f32_16x16x32_bf16 v[52:55], v[196:199], v[88:91], v[52:55]
    ds_read_b64_tr_b16 v[180:181], v69 offset:8480
    ds_read_b64_tr_b16 v[182:183], v69 offset:12704
    v_mfma_f32_16x16x32_bf16 v[24:27], v[200:203], v[84:87], v[24:27]
    ds_read_b64_tr_b16 v[184:185], v70 offset:8448
    ds_read_b64_tr_b16 v[186:187], v70 offset:12672
    v_mfma_f32_16x16x32_bf16 v[56:59], v[200:203], v[88:91], v[56:59]
    ds_read_b64_tr_b16 v[188:189], v70 offset:8480
    ds_read_b64_tr_b16 v[190:191], v70 offset:12704
    v_mfma_f32_16x16x32_bf16 v[28:31], v[204:207], v[84:87], v[28:31]
    v_mfma_f32_16x16x32_bf16 v[60:63], v[204:207], v[88:91], v[60:63]
    s_waitcnt lgkmcnt(8)
    v_mfma_f32_16x16x32_bf16 v[0:3], v[208:211], v[96:99], v[0:3]
    s_add_u32 m0, s53, 33792
    s_add_u32 s62, s5, 33024
    buffer_load_dwordx4 v252, s[36:39], s62 offen lds
    v_mfma_f32_16x16x32_bf16 v[32:35], v[208:211], v[100:103], v[32:35]
    ds_read_b64_tr_b16 v[192:193], v71 offset:8448
    ds_read_b64_tr_b16 v[194:195], v71 offset:12672
    v_mfma_f32_16x16x32_bf16 v[120:123], v[208:211], v[104:107], v[120:123]
    s_add_u32 m0, s53, 34848
    s_add_u32 s62, s5, 37120
    buffer_load_dwordx4 v252, s[36:39], s62 offen lds
    v_mfma_f32_16x16x32_bf16 v[4:7], v[212:215], v[96:99], v[4:7]
    ds_read_b64_tr_b16 v[196:197], v71 offset:8480
    ds_read_b64_tr_b16 v[198:199], v71 offset:12704
    v_mfma_f32_16x16x32_bf16 v[36:39], v[212:215], v[100:103], v[36:39]
    v_mfma_f32_16x16x32_bf16 v[124:127], v[212:215], v[104:107], v[124:127]
    s_waitcnt lgkmcnt(8)
    v_mfma_f32_16x16x32_bf16 v[8:11], v[176:179], v[96:99], v[8:11]
    v_mfma_f32_16x16x32_bf16 v[40:43], v[176:179], v[100:103], v[40:43]
    v_mfma_f32_16x16x32_bf16 v[12:15], v[180:183], v[96:99], v[12:15]
    v_mfma_f32_16x16x32_bf16 v[44:47], v[180:183], v[100:103], v[44:47]
    s_waitcnt lgkmcnt(0)
    s_waitcnt vmcnt(12)
    s_barrier
    v_mfma_f32_16x16x32_bf16 v[16:19], v[184:187], v[96:99], v[16:19]
    ds_read_b64_tr_b16 v[200:201], v68 offset:16896
    ds_read_b64_tr_b16 v[202:203], v68 offset:21120
    v_mfma_f32_16x16x32_bf16 v[48:51], v[184:187], v[100:103], v[48:51]
    ds_read_b64_tr_b16 v[204:205], v68 offset:16928
    ds_read_b64_tr_b16 v[206:207], v68 offset:21152
    v_mfma_f32_16x16x32_bf16 v[20:23], v[188:191], v[96:99], v[20:23]
    ds_read_b64_tr_b16 v[208:209], v69 offset:16896
    ds_read_b64_tr_b16 v[210:211], v69 offset:21120
    v_mfma_f32_16x16x32_bf16 v[52:55], v[188:191], v[100:103], v[52:55]
    ds_read_b64_tr_b16 v[212:213], v69 offset:16928
    ds_read_b64_tr_b16 v[214:215], v69 offset:21152
    v_mfma_f32_16x16x32_bf16 v[24:27], v[192:195], v[96:99], v[24:27]
    ds_read_b64_tr_b16 v[176:177], v70 offset:16896
    ds_read_b64_tr_b16 v[178:179], v70 offset:21120
    v_mfma_f32_16x16x32_bf16 v[56:59], v[192:195], v[100:103], v[56:59]
    ds_read_b64_tr_b16 v[180:181], v70 offset:16928
    ds_read_b64_tr_b16 v[182:183], v70 offset:21152
    v_mfma_f32_16x16x32_bf16 v[28:31], v[196:199], v[96:99], v[28:31]
    v_mfma_f32_16x16x32_bf16 v[60:63], v[196:199], v[100:103], v[60:63]
    s_waitcnt lgkmcnt(8)
    v_mfma_f32_16x16x32_bf16 v[0:3], v[200:203], v[108:111], v[0:3]
    s_add_u32 m0, s53, 42240
    s_add_u32 s62, s5, 65792
    buffer_load_dwordx4 v252, s[36:39], s62 offen lds
    v_mfma_f32_16x16x32_bf16 v[32:35], v[200:203], v[112:115], v[32:35]
    ds_read_b64_tr_b16 v[184:185], v71 offset:16896
    ds_read_b64_tr_b16 v[186:187], v71 offset:21120
    v_mfma_f32_16x16x32_bf16 v[120:123], v[200:203], v[116:119], v[120:123]
    s_add_u32 m0, s53, 43296
    s_add_u32 s62, s5, 69888
    buffer_load_dwordx4 v252, s[36:39], s62 offen lds
    v_mfma_f32_16x16x32_bf16 v[4:7], v[204:207], v[108:111], v[4:7]
    ds_read_b64_tr_b16 v[188:189], v71 offset:16928
    ds_read_b64_tr_b16 v[190:191], v71 offset:21152
    v_mfma_f32_16x16x32_bf16 v[36:39], v[204:207], v[112:115], v[36:39]
    v_mfma_f32_16x16x32_bf16 v[124:127], v[204:207], v[116:119], v[124:127]
    s_waitcnt lgkmcnt(8)
    v_mfma_f32_16x16x32_bf16 v[8:11], v[208:211], v[108:111], v[8:11]
    v_mfma_f32_16x16x32_bf16 v[40:43], v[208:211], v[112:115], v[40:43]
    v_mfma_f32_16x16x32_bf16 v[12:15], v[212:215], v[108:111], v[12:15]
    v_mfma_f32_16x16x32_bf16 v[44:47], v[212:215], v[112:115], v[44:47]
    s_waitcnt lgkmcnt(0)
    s_waitcnt vmcnt(12)
    s_barrier
    v_mfma_f32_16x16x32_bf16 v[16:19], v[176:179], v[108:111], v[16:19]
    ds_read_b64_tr_b16 v[192:193], v68 offset:25344
    ds_read_b64_tr_b16 v[194:195], v68 offset:29568
    v_mfma_f32_16x16x32_bf16 v[48:51], v[176:179], v[112:115], v[48:51]
    ds_read_b64_tr_b16 v[196:197], v68 offset:25376
    ds_read_b64_tr_b16 v[198:199], v68 offset:29600
    v_mfma_f32_16x16x32_bf16 v[20:23], v[180:183], v[108:111], v[20:23]
    ds_read_b64_tr_b16 v[200:201], v69 offset:25344
    ds_read_b64_tr_b16 v[202:203], v69 offset:29568
    v_mfma_f32_16x16x32_bf16 v[52:55], v[180:183], v[112:115], v[52:55]
    ds_read_b64_tr_b16 v[204:205], v69 offset:25376
    ds_read_b64_tr_b16 v[206:207], v69 offset:29600
    v_mfma_f32_16x16x32_bf16 v[24:27], v[184:187], v[108:111], v[24:27]
    ds_read_b64_tr_b16 v[208:209], v70 offset:25344
    ds_read_b64_tr_b16 v[210:211], v70 offset:29568
    v_mfma_f32_16x16x32_bf16 v[56:59], v[184:187], v[112:115], v[56:59]
    ds_read_b64_tr_b16 v[212:213], v70 offset:25376
    ds_read_b64_tr_b16 v[214:215], v70 offset:29600
    v_mfma_f32_16x16x32_bf16 v[28:31], v[188:191], v[108:111], v[28:31]
    v_mfma_f32_16x16x32_bf16 v[60:63], v[188:191], v[112:115], v[60:63]
    s_waitcnt lgkmcnt(8)
    v_cvt_pk_bf16_f32 v216, v0, v1
    v_cvt_pk_bf16_f32 v217, v2, v3
    v_cvt_pk_bf16_f32 v218, v4, v5
    v_cvt_pk_bf16_f32 v219, v6, v7
    buffer_store_dwordx4 v[216:219], v255, s[40:43], 0 offen offset:0 sc1
    v_mfma_f32_16x16x32_bf16 v[0:3], v[192:195], v[128:131], 0
    s_add_u32 m0, s53, 50688
    s_add_u32 s62, s5, 98560
    buffer_load_dwordx4 v252, s[36:39], s62 offen lds
    v_cvt_pk_bf16_f32 v220, v32, v33
    v_cvt_pk_bf16_f32 v221, v34, v35
    v_cvt_pk_bf16_f32 v222, v36, v37
    v_cvt_pk_bf16_f32 v223, v38, v39
    v_mfma_f32_16x16x32_bf16 v[32:35], v[192:195], v[132:135], 0
    ds_read_b64_tr_b16 v[176:177], v71 offset:25344
    ds_read_b64_tr_b16 v[178:179], v71 offset:29568
    v_cvt_pk_bf16_f32 v224, v120, v121
    v_cvt_pk_bf16_f32 v225, v122, v123
    v_cvt_pk_bf16_f32 v226, v124, v125
    v_cvt_pk_bf16_f32 v227, v126, v127
    v_mfma_f32_16x16x32_bf16 v[120:123], v[192:195], v[136:139], 0
    s_add_u32 m0, s53, 51744
    s_add_u32 s62, s5, 102656
    buffer_load_dwordx4 v252, s[36:39], s62 offen lds
    v_mfma_f32_16x16x32_bf16 v[4:7], v[196:199], v[128:131], 0
    ds_read_b64_tr_b16 v[180:181], v71 offset:25376
    ds_read_b64_tr_b16 v[182:183], v71 offset:29600
    v_mfma_f32_16x16x32_bf16 v[36:39], v[196:199], v[132:135], 0
    v_mfma_f32_16x16x32_bf16 v[124:127], v[196:199], v[136:139], 0
    s_waitcnt lgkmcnt(8)
    v_cvt_pk_bf16_f32 v228, v8, v9
    v_cvt_pk_bf16_f32 v229, v10, v11
    v_cvt_pk_bf16_f32 v230, v12, v13
    v_cvt_pk_bf16_f32 v231, v14, v15
    v_mfma_f32_16x16x32_bf16 v[8:11], v[200:203], v[128:131], 0
    v_cvt_pk_bf16_f32 v232, v40, v41
    v_cvt_pk_bf16_f32 v233, v42, v43
    v_cvt_pk_bf16_f32 v234, v44, v45
    v_cvt_pk_bf16_f32 v235, v46, v47
    v_mfma_f32_16x16x32_bf16 v[40:43], v[200:203], v[132:135], 0
    v_mfma_f32_16x16x32_bf16 v[12:15], v[204:207], v[128:131], 0
    v_mfma_f32_16x16x32_bf16 v[44:47], v[204:207], v[132:135], 0
    s_waitcnt lgkmcnt(0)
    s_waitcnt vmcnt(13)
    s_barrier
    v_cvt_pk_bf16_f32 v236, v16, v17
    v_cvt_pk_bf16_f32 v237, v18, v19
    v_cvt_pk_bf16_f32 v238, v20, v21
    v_cvt_pk_bf16_f32 v239, v22, v23
    v_mfma_f32_16x16x32_bf16 v[16:19], v[208:211], v[128:131], 0
    ds_read_b64_tr_b16 v[184:185], v64 offset:0
    ds_read_b64_tr_b16 v[186:187], v64 offset:4224
    v_cvt_pk_bf16_f32 v240, v48, v49
    v_cvt_pk_bf16_f32 v241, v50, v51
    v_cvt_pk_bf16_f32 v242, v52, v53
    v_cvt_pk_bf16_f32 v243, v54, v55
    v_mfma_f32_16x16x32_bf16 v[48:51], v[208:211], v[132:135], 0
    ds_read_b64_tr_b16 v[188:189], v64 offset:32
    ds_read_b64_tr_b16 v[190:191], v64 offset:4256
    v_mfma_f32_16x16x32_bf16 v[20:23], v[212:215], v[128:131], 0
    ds_read_b64_tr_b16 v[192:193], v65 offset:0
    ds_read_b64_tr_b16 v[194:195], v65 offset:4224
    v_mfma_f32_16x16x32_bf16 v[52:55], v[212:215], v[132:135], 0
    ds_read_b64_tr_b16 v[196:197], v65 offset:32
    ds_read_b64_tr_b16 v[198:199], v65 offset:4256
    v_cvt_pk_bf16_f32 v244, v24, v25
    v_cvt_pk_bf16_f32 v245, v26, v27
    v_cvt_pk_bf16_f32 v246, v28, v29
    v_cvt_pk_bf16_f32 v247, v30, v31
    v_mfma_f32_16x16x32_bf16 v[24:27], v[176:179], v[128:131], 0
    ds_read_b64_tr_b16 v[200:201], v66 offset:0
    ds_read_b64_tr_b16 v[202:203], v66 offset:4224
    v_cvt_pk_bf16_f32 v216, v56, v57
    v_cvt_pk_bf16_f32 v217, v58, v59
    v_cvt_pk_bf16_f32 v218, v60, v61
    v_cvt_pk_bf16_f32 v219, v62, v63
    v_mfma_f32_16x16x32_bf16 v[56:59], v[176:179], v[132:135], 0
    ds_read_b64_tr_b16 v[204:205], v66 offset:32
    ds_read_b64_tr_b16 v[206:207], v66 offset:4256
    v_mfma_f32_16x16x32_bf16 v[28:31], v[180:183], v[128:131], 0
    v_mfma_f32_16x16x32_bf16 v[60:63], v[180:183], v[132:135], 0
    s_waitcnt lgkmcnt(8)
    v_mfma_f32_16x16x32_bf16 v[0:3], v[184:187], v[140:143], v[0:3]
    buffer_store_dwordx4 v[220:223], v250, s[40:43], 0 offen offset:0 sc1
    v_mfma_f32_16x16x32_bf16 v[32:35], v[184:187], v[144:147], v[32:35]
    ds_read_b64_tr_b16 v[208:209], v67 offset:0
    ds_read_b64_tr_b16 v[210:211], v67 offset:4224
    v_mfma_f32_16x16x32_bf16 v[120:123], v[184:187], v[148:151], v[120:123]
    buffer_store_dwordx4 v[224:227], v251, s[40:43], 0 offen offset:0 sc1
    v_mfma_f32_16x16x32_bf16 v[4:7], v[188:191], v[140:143], v[4:7]
    ds_read_b64_tr_b16 v[212:213], v67 offset:32
    ds_read_b64_tr_b16 v[214:215], v67 offset:4256
    v_mfma_f32_16x16x32_bf16 v[36:39], v[188:191], v[144:147], v[36:39]
    v_mfma_f32_16x16x32_bf16 v[124:127], v[188:191], v[148:151], v[124:127]
    s_waitcnt lgkmcnt(8)
    v_mfma_f32_16x16x32_bf16 v[8:11], v[192:195], v[140:143], v[8:11]
    v_mfma_f32_16x16x32_bf16 v[40:43], v[192:195], v[144:147], v[40:43]
    v_mfma_f32_16x16x32_bf16 v[12:15], v[196:199], v[140:143], v[12:15]
    v_mfma_f32_16x16x32_bf16 v[44:47], v[196:199], v[144:147], v[44:47]
    s_waitcnt lgkmcnt(0)
    s_waitcnt vmcnt(13)
    s_barrier
    v_mfma_f32_16x16x32_bf16 v[16:19], v[200:203], v[140:143], v[16:19]
    ds_read_b64_tr_b16 v[176:177], v64 offset:8448
    ds_read_b64_tr_b16 v[178:179], v64 offset:12672
    v_mfma_f32_16x16x32_bf16 v[48:51], v[200:203], v[144:147], v[48:51]
    ds_read_b64_tr_b16 v[180:181], v64 offset:8480
    ds_read_b64_tr_b16 v[182:183], v64 offset:12704
    v_mfma_f32_16x16x32_bf16 v[20:23], v[204:207], v[140:143], v[20:23]
    ds_read_b64_tr_b16 v[184:185], v65 offset:8448
    ds_read_b64_tr_b16 v[186:187], v65 offset:12672
    v_mfma_f32_16x16x32_bf16 v[52:55], v[204:207], v[144:147], v[52:55]
    ds_read_b64_tr_b16 v[188:189], v65 offset:8480
    ds_read_b64_tr_b16 v[190:191], v65 offset:12704
    v_mfma_f32_16x16x32_bf16 v[24:27], v[208:211], v[140:143], v[24:27]
    ds_read_b64_tr_b16 v[192:193], v66 offset:8448
    ds_read_b64_tr_b16 v[194:195], v66 offset:12672
    v_mfma_f32_16x16x32_bf16 v[56:59], v[208:211], v[144:147], v[56:59]
    ds_read_b64_tr_b16 v[196:197], v66 offset:8480
    ds_read_b64_tr_b16 v[198:199], v66 offset:12704
    v_mfma_f32_16x16x32_bf16 v[28:31], v[212:215], v[140:143], v[28:31]
    v_mfma_f32_16x16x32_bf16 v[60:63], v[212:215], v[144:147], v[60:63]
    s_waitcnt lgkmcnt(8)
    v_mfma_f32_16x16x32_bf16 v[0:3], v[176:179], v[152:155], v[0:3]
    buffer_store_dwordx4 v[228:231], v255, s[40:43], 0 offen offset:1024 sc1
    v_mfma_f32_16x16x32_bf16 v[32:35], v[176:179], v[156:159], v[32:35]
    ds_read_b64_tr_b16 v[200:201], v67 offset:8448
    ds_read_b64_tr_b16 v[202:203], v67 offset:12672
    v_mfma_f32_16x16x32_bf16 v[120:123], v[176:179], v[160:163], v[120:123]
    ds_read_b64_tr_b16 v[204:205], v67 offset:8480
    ds_read_b64_tr_b16 v[206:207], v67 offset:12704
    v_mfma_f32_16x16x32_bf16 v[4:7], v[180:183], v[152:155], v[4:7]
    v_mfma_f32_16x16x32_bf16 v[36:39], v[180:183], v[156:159], v[36:39]
    v_mfma_f32_16x16x32_bf16 v[124:127], v[180:183], v[160:163], v[124:127]
    s_waitcnt lgkmcnt(8)
    v_mfma_f32_16x16x32_bf16 v[8:11], v[184:187], v[152:155], v[8:11]
    v_mfma_f32_16x16x32_bf16 v[40:43], v[184:187], v[156:159], v[40:43]
    v_mfma_f32_16x16x32_bf16 v[12:15], v[188:191], v[152:155], v[12:15]
    v_mfma_f32_16x16x32_bf16 v[44:47], v[188:191], v[156:159], v[44:47]
    s_waitcnt lgkmcnt(0)
    s_waitcnt vmcnt(12)
    s_barrier
    v_mfma_f32_16x16x32_bf16 v[16:19], v[192:195], v[152:155], v[16:19]
    ds_read_b64_tr_b16 v[208:209], v64 offset:16896
    ds_read_b64_tr_b16 v[210:211], v64 offset:21120
    v_mfma_f32_16x16x32_bf16 v[48:51], v[192:195], v[156:159], v[48:51]
    ds_read_b64_tr_b16 v[212:213], v64 offset:16928
    ds_read_b64_tr_b16 v[214:215], v64 offset:21152
    v_mfma_f32_16x16x32_bf16 v[20:23], v[196:199], v[152:155], v[20:23]
    ds_read_b64_tr_b16 v[176:177], v65 offset:16896
    ds_read_b64_tr_b16 v[178:179], v65 offset:21120
    v_mfma_f32_16x16x32_bf16 v[52:55], v[196:199], v[156:159], v[52:55]
    ds_read_b64_tr_b16 v[180:181], v65 offset:16928
    ds_read_b64_tr_b16 v[182:183], v65 offset:21152
    v_mfma_f32_16x16x32_bf16 v[24:27], v[200:203], v[152:155], v[24:27]
    ds_read_b64_tr_b16 v[184:185], v66 offset:16896
    ds_read_b64_tr_b16 v[186:187], v66 offset:21120
    v_mfma_f32_16x16x32_bf16 v[56:59], v[200:203], v[156:159], v[56:59]
    ds_read_b64_tr_b16 v[188:189], v66 offset:16928
    ds_read_b64_tr_b16 v[190:191], v66 offset:21152
    v_mfma_f32_16x16x32_bf16 v[28:31], v[204:207], v[152:155], v[28:31]
    v_mfma_f32_16x16x32_bf16 v[60:63], v[204:207], v[156:159], v[60:63]
    s_waitcnt lgkmcnt(8)
    v_mfma_f32_16x16x32_bf16 v[0:3], v[208:211], v[164:167], v[0:3]
    buffer_store_dwordx4 v[232:235], v250, s[40:43], 0 offen offset:1024 sc1
    v_mfma_f32_16x16x32_bf16 v[32:35], v[208:211], v[168:171], v[32:35]
    ds_read_b64_tr_b16 v[192:193], v67 offset:16896
    ds_read_b64_tr_b16 v[194:195], v67 offset:21120
    v_mfma_f32_16x16x32_bf16 v[120:123], v[208:211], v[172:175], v[120:123]
    ds_read_b64_tr_b16 v[196:197], v67 offset:16928
    ds_read_b64_tr_b16 v[198:199], v67 offset:21152
    v_mfma_f32_16x16x32_bf16 v[4:7], v[212:215], v[164:167], v[4:7]
    v_mfma_f32_16x16x32_bf16 v[36:39], v[212:215], v[168:171], v[36:39]
    v_mfma_f32_16x16x32_bf16 v[124:127], v[212:215], v[172:175], v[124:127]
    s_waitcnt lgkmcnt(8)
    v_mfma_f32_16x16x32_bf16 v[8:11], v[176:179], v[164:167], v[8:11]
    v_mfma_f32_16x16x32_bf16 v[40:43], v[176:179], v[168:171], v[40:43]
    v_mfma_f32_16x16x32_bf16 v[12:15], v[180:183], v[164:167], v[12:15]
    v_mfma_f32_16x16x32_bf16 v[44:47], v[180:183], v[168:171], v[44:47]
    s_waitcnt lgkmcnt(0)
    s_waitcnt vmcnt(11)
    s_barrier
    v_mfma_f32_16x16x32_bf16 v[16:19], v[184:187], v[164:167], v[16:19]
    ds_read_b64_tr_b16 v[200:201], v64 offset:25344
    ds_read_b64_tr_b16 v[202:203], v64 offset:29568
    v_mfma_f32_16x16x32_bf16 v[48:51], v[184:187], v[168:171], v[48:51]
    ds_read_b64_tr_b16 v[204:205], v64 offset:25376
    ds_read_b64_tr_b16 v[206:207], v64 offset:29600
    v_mfma_f32_16x16x32_bf16 v[20:23], v[188:191], v[164:167], v[20:23]
    ds_read_b64_tr_b16 v[208:209], v65 offset:25344
    ds_read_b64_tr_b16 v[210:211], v65 offset:29568
    v_mfma_f32_16x16x32_bf16 v[52:55], v[188:191], v[168:171], v[52:55]
    ds_read_b64_tr_b16 v[212:213], v65 offset:25376
    ds_read_b64_tr_b16 v[214:215], v65 offset:29600
    v_mfma_f32_16x16x32_bf16 v[24:27], v[192:195], v[164:167], v[24:27]
    ds_read_b64_tr_b16 v[176:177], v66 offset:25344
    ds_read_b64_tr_b16 v[178:179], v66 offset:29568
    v_mfma_f32_16x16x32_bf16 v[56:59], v[192:195], v[168:171], v[56:59]
    ds_read_b64_tr_b16 v[180:181], v66 offset:25376
    ds_read_b64_tr_b16 v[182:183], v66 offset:29600
    v_mfma_f32_16x16x32_bf16 v[28:31], v[196:199], v[164:167], v[28:31]
    v_mfma_f32_16x16x32_bf16 v[60:63], v[196:199], v[168:171], v[60:63]
    s_waitcnt lgkmcnt(8)
    v_mfma_f32_16x16x32_bf16 v[0:3], v[200:203], v[72:75], v[0:3]
    buffer_store_dwordx4 v[236:239], v255, s[40:43], 0 offen offset:2048 sc1
    v_mfma_f32_16x16x32_bf16 v[32:35], v[200:203], v[76:79], v[32:35]
    ds_read_b64_tr_b16 v[184:185], v67 offset:25344
    ds_read_b64_tr_b16 v[186:187], v67 offset:29568
    v_mfma_f32_16x16x32_bf16 v[120:123], v[200:203], v[80:83], v[120:123]
    ds_read_b64_tr_b16 v[188:189], v67 offset:25376
    ds_read_b64_tr_b16 v[190:191], v67 offset:29600
    v_mfma_f32_16x16x32_bf16 v[4:7], v[204:207], v[72:75], v[4:7]
    v_mfma_f32_16x16x32_bf16 v[36:39], v[204:207], v[76:79], v[36:39]
    v_mfma_f32_16x16x32_bf16 v[124:127], v[204:207], v[80:83], v[124:127]
    s_waitcnt lgkmcnt(8)
    v_mfma_f32_16x16x32_bf16 v[8:11], v[208:211], v[72:75], v[8:11]
    v_mfma_f32_16x16x32_bf16 v[40:43], v[208:211], v[76:79], v[40:43]
    v_mfma_f32_16x16x32_bf16 v[12:15], v[212:215], v[72:75], v[12:15]
    v_mfma_f32_16x16x32_bf16 v[44:47], v[212:215], v[76:79], v[44:47]
    s_waitcnt lgkmcnt(0)
    s_waitcnt vmcnt(10)
    s_barrier
    v_mfma_f32_16x16x32_bf16 v[16:19], v[176:179], v[72:75], v[16:19]
    ds_read_b64_tr_b16 v[192:193], v68 offset:0
    ds_read_b64_tr_b16 v[194:195], v68 offset:4224
    v_mfma_f32_16x16x32_bf16 v[48:51], v[176:179], v[76:79], v[48:51]
    ds_read_b64_tr_b16 v[196:197], v68 offset:32
    ds_read_b64_tr_b16 v[198:199], v68 offset:4256
    v_mfma_f32_16x16x32_bf16 v[20:23], v[180:183], v[72:75], v[20:23]
    ds_read_b64_tr_b16 v[200:201], v69 offset:0
    ds_read_b64_tr_b16 v[202:203], v69 offset:4224
    v_mfma_f32_16x16x32_bf16 v[52:55], v[180:183], v[76:79], v[52:55]
    ds_read_b64_tr_b16 v[204:205], v69 offset:32
    ds_read_b64_tr_b16 v[206:207], v69 offset:4256
    v_mfma_f32_16x16x32_bf16 v[24:27], v[184:187], v[72:75], v[24:27]
    ds_read_b64_tr_b16 v[208:209], v70 offset:0
    ds_read_b64_tr_b16 v[210:211], v70 offset:4224
    v_mfma_f32_16x16x32_bf16 v[56:59], v[184:187], v[76:79], v[56:59]
    ds_read_b64_tr_b16 v[212:213], v70 offset:32
    ds_read_b64_tr_b16 v[214:215], v70 offset:4256
    v_mfma_f32_16x16x32_bf16 v[28:31], v[188:191], v[72:75], v[28:31]
    v_mfma_f32_16x16x32_bf16 v[60:63], v[188:191], v[76:79], v[60:63]
    s_waitcnt lgkmcnt(8)
    v_mfma_f32_16x16x32_bf16 v[0:3], v[192:195], v[84:87], v[0:3]
    buffer_store_dwordx4 v[240:243], v250, s[40:43], 0 offen offset:2048 sc1
    v_mfma_f32_16x16x32_bf16 v[32:35], v[192:195], v[88:91], v[32:35]
    ds_read_b64_tr_b16 v[176:177], v71 offset:0
    ds_read_b64_tr_b16 v[178:179], v71 offset:4224
    v_mfma_f32_16x16x32_bf16 v[120:123], v[192:195], v[92:95], v[120:123]
    ds_read_b64_tr_b16 v[180:181], v71 offset:32
    ds_read_b64_tr_b16 v[182:183], v71 offset:4256
    v_mfma_f32_16x16x32_bf16 v[4:7], v[196:199], v[84:87], v[4:7]
    v_mfma_f32_16x16x32_bf16 v[36:39], v[196:199], v[88:91], v[36:39]
    v_mfma_f32_16x16x32_bf16 v[124:127], v[196:199], v[92:95], v[124:127]
    s_waitcnt lgkmcnt(8)
    v_mfma_f32_16x16x32_bf16 v[8:11], v[200:203], v[84:87], v[8:11]
    v_mfma_f32_16x16x32_bf16 v[40:43], v[200:203], v[88:91], v[40:43]
    v_mfma_f32_16x16x32_bf16 v[12:15], v[204:207], v[84:87], v[12:15]
    v_mfma_f32_16x16x32_bf16 v[44:47], v[204:207], v[88:91], v[44:47]
    s_waitcnt lgkmcnt(0)
    s_waitcnt vmcnt(9)
    s_barrier
    v_mfma_f32_16x16x32_bf16 v[16:19], v[208:211], v[84:87], v[16:19]
    ds_read_b64_tr_b16 v[184:185], v68 offset:8448
    ds_read_b64_tr_b16 v[186:187], v68 offset:12672
    v_mfma_f32_16x16x32_bf16 v[48:51], v[208:211], v[88:91], v[48:51]
    ds_read_b64_tr_b16 v[188:189], v68 offset:8480
    ds_read_b64_tr_b16 v[190:191], v68 offset:12704
    v_mfma_f32_16x16x32_bf16 v[20:23], v[212:215], v[84:87], v[20:23]
    ds_read_b64_tr_b16 v[192:193], v69 offset:8448
    ds_read_b64_tr_b16 v[194:195], v69 offset:12672
    v_mfma_f32_16x16x32_bf16 v[52:55], v[212:215], v[88:91], v[52:55]
    ds_read_b64_tr_b16 v[196:197], v69 offset:8480
    ds_read_b64_tr_b16 v[198:199], v69 offset:12704
    v_mfma_f32_16x16x32_bf16 v[24:27], v[176:179], v[84:87], v[24:27]
    ds_read_b64_tr_b16 v[200:201], v70 offset:8448
    ds_read_b64_tr_b16 v[202:203], v70 offset:12672
    v_mfma_f32_16x16x32_bf16 v[56:59], v[176:179], v[88:91], v[56:59]
    ds_read_b64_tr_b16 v[204:205], v70 offset:8480
    ds_read_b64_tr_b16 v[206:207], v70 offset:12704
    v_mfma_f32_16x16x32_bf16 v[28:31], v[180:183], v[84:87], v[28:31]
    v_mfma_f32_16x16x32_bf16 v[60:63], v[180:183], v[88:91], v[60:63]
    s_waitcnt lgkmcnt(8)
    v_mfma_f32_16x16x32_bf16 v[0:3], v[184:187], v[96:99], v[0:3]
    buffer_store_dwordx4 v[244:247], v255, s[40:43], 0 offen offset:3072 sc1
    v_mfma_f32_16x16x32_bf16 v[32:35], v[184:187], v[100:103], v[32:35]
    ds_read_b64_tr_b16 v[208:209], v71 offset:8448
    ds_read_b64_tr_b16 v[210:211], v71 offset:12672
    v_mfma_f32_16x16x32_bf16 v[120:123], v[184:187], v[104:107], v[120:123]
    ds_read_b64_tr_b16 v[212:213], v71 offset:8480
    ds_read_b64_tr_b16 v[214:215], v71 offset:12704
    v_mfma_f32_16x16x32_bf16 v[4:7], v[188:191], v[96:99], v[4:7]
    v_mfma_f32_16x16x32_bf16 v[36:39], v[188:191], v[100:103], v[36:39]
    v_mfma_f32_16x16x32_bf16 v[124:127], v[188:191], v[104:107], v[124:127]
    s_waitcnt lgkmcnt(8)
    v_mfma_f32_16x16x32_bf16 v[8:11], v[192:195], v[96:99], v[8:11]
    v_mfma_f32_16x16x32_bf16 v[40:43], v[192:195], v[100:103], v[40:43]
    v_mfma_f32_16x16x32_bf16 v[12:15], v[196:199], v[96:99], v[12:15]
    v_mfma_f32_16x16x32_bf16 v[44:47], v[196:199], v[100:103], v[44:47]
    s_waitcnt lgkmcnt(0)
    s_waitcnt vmcnt(7)
    s_barrier
    v_mfma_f32_16x16x32_bf16 v[16:19], v[200:203], v[96:99], v[16:19]
    ds_read_b64_tr_b16 v[176:177], v68 offset:16896
    ds_read_b64_tr_b16 v[178:179], v68 offset:21120
    v_mfma_f32_16x16x32_bf16 v[48:51], v[200:203], v[100:103], v[48:51]
    ds_read_b64_tr_b16 v[180:181], v68 offset:16928
    ds_read_b64_tr_b16 v[182:183], v68 offset:21152
    v_mfma_f32_16x16x32_bf16 v[20:23], v[204:207], v[96:99], v[20:23]
    ds_read_b64_tr_b16 v[184:185], v69 offset:16896
    ds_read_b64_tr_b16 v[186:187], v69 offset:21120
    v_mfma_f32_16x16x32_bf16 v[52:55], v[204:207], v[100:103], v[52:55]
    ds_read_b64_tr_b16 v[188:189], v69 offset:16928
    ds_read_b64_tr_b16 v[190:191], v69 offset:21152
    v_mfma_f32_16x16x32_bf16 v[24:27], v[208:211], v[96:99], v[24:27]
    ds_read_b64_tr_b16 v[192:193], v70 offset:16896
    ds_read_b64_tr_b16 v[194:195], v70 offset:21120
    v_mfma_f32_16x16x32_bf16 v[56:59], v[208:211], v[100:103], v[56:59]
    ds_read_b64_tr_b16 v[196:197], v70 offset:16928
    ds_read_b64_tr_b16 v[198:199], v70 offset:21152
    v_mfma_f32_16x16x32_bf16 v[28:31], v[212:215], v[96:99], v[28:31]
    v_mfma_f32_16x16x32_bf16 v[60:63], v[212:215], v[100:103], v[60:63]
    s_waitcnt lgkmcnt(8)
    v_mfma_f32_16x16x32_bf16 v[0:3], v[176:179], v[108:111], v[0:3]
    buffer_store_dwordx4 v[216:219], v250, s[40:43], 0 offen offset:3072 sc1
    v_mfma_f32_16x16x32_bf16 v[32:35], v[176:179], v[112:115], v[32:35]
    ds_read_b64_tr_b16 v[200:201], v71 offset:16896
    ds_read_b64_tr_b16 v[202:203], v71 offset:21120
    v_mfma_f32_16x16x32_bf16 v[120:123], v[176:179], v[116:119], v[120:123]
    ds_read_b64_tr_b16 v[204:205], v71 offset:16928
    ds_read_b64_tr_b16 v[206:207], v71 offset:21152
    v_mfma_f32_16x16x32_bf16 v[4:7], v[180:183], v[108:111], v[4:7]
    v_mfma_f32_16x16x32_bf16 v[36:39], v[180:183], v[112:115], v[36:39]
    v_mfma_f32_16x16x32_bf16 v[124:127], v[180:183], v[116:119], v[124:127]
    s_waitcnt lgkmcnt(8)
    v_mfma_f32_16x16x32_bf16 v[8:11], v[184:187], v[108:111], v[8:11]
    v_mfma_f32_16x16x32_bf16 v[40:43], v[184:187], v[112:115], v[40:43]
    v_mfma_f32_16x16x32_bf16 v[12:15], v[188:191], v[108:111], v[12:15]
    v_mfma_f32_16x16x32_bf16 v[44:47], v[188:191], v[112:115], v[44:47]
    s_waitcnt lgkmcnt(0)
    v_mfma_f32_16x16x32_bf16 v[16:19], v[192:195], v[108:111], v[16:19]
    v_mfma_f32_16x16x32_bf16 v[48:51], v[192:195], v[112:115], v[48:51]
    v_mfma_f32_16x16x32_bf16 v[20:23], v[196:199], v[108:111], v[20:23]
    v_mfma_f32_16x16x32_bf16 v[52:55], v[196:199], v[112:115], v[52:55]
    v_mfma_f32_16x16x32_bf16 v[24:27], v[200:203], v[108:111], v[24:27]
    v_mfma_f32_16x16x32_bf16 v[56:59], v[200:203], v[112:115], v[56:59]
    v_mfma_f32_16x16x32_bf16 v[28:31], v[204:207], v[108:111], v[28:31]
    v_mfma_f32_16x16x32_bf16 v[60:63], v[204:207], v[112:115], v[60:63]
    v_cvt_pk_bf16_f32 v220, v0, v1
    v_cvt_pk_bf16_f32 v221, v2, v3
    v_cvt_pk_bf16_f32 v222, v4, v5
    v_cvt_pk_bf16_f32 v223, v6, v7
    buffer_store_dwordx4 v[220:223], v255, s[40:43], s59 offen offset:0 sc1
    v_cvt_pk_bf16_f32 v224, v32, v33
    v_cvt_pk_bf16_f32 v225, v34, v35
    v_cvt_pk_bf16_f32 v226, v36, v37
    v_cvt_pk_bf16_f32 v227, v38, v39
    buffer_store_dwordx4 v[224:227], v250, s[40:43], s59 offen offset:0 sc1
    v_cvt_pk_bf16_f32 v228, v120, v121
    v_cvt_pk_bf16_f32 v229, v122, v123
    v_cvt_pk_bf16_f32 v230, v124, v125
    v_cvt_pk_bf16_f32 v231, v126, v127
    buffer_store_dwordx4 v[228:231], v251, s[40:43], s59 offen offset:0 sc1
    v_cvt_pk_bf16_f32 v232, v8, v9
    v_cvt_pk_bf16_f32 v233, v10, v11
    v_cvt_pk_bf16_f32 v234, v12, v13
    v_cvt_pk_bf16_f32 v235, v14, v15
    buffer_store_dwordx4 v[232:235], v255, s[40:43], s59 offen offset:1024 sc1
    v_cvt_pk_bf16_f32 v236, v40, v41
    v_cvt_pk_bf16_f32 v237, v42, v43
    v_cvt_pk_bf16_f32 v238, v44, v45
    v_cvt_pk_bf16_f32 v239, v46, v47
    buffer_store_dwordx4 v[236:239], v250, s[40:43], s59 offen offset:1024 sc1
    v_cvt_pk_bf16_f32 v240, v16, v17
    v_cvt_pk_bf16_f32 v241, v18, v19
    v_cvt_pk_bf16_f32 v242, v20, v21
    v_cvt_pk_bf16_f32 v243, v22, v23
    buffer_store_dwordx4 v[240:243], v255, s[40:43], s59 offen offset:2048 sc1
    v_cvt_pk_bf16_f32 v244, v48, v49
    v_cvt_pk_bf16_f32 v245, v50, v51
    v_cvt_pk_bf16_f32 v246, v52, v53
    v_cvt_pk_bf16_f32 v247, v54, v55
    buffer_store_dwordx4 v[244:247], v250, s[40:43], s59 offen offset:2048 sc1
    v_cvt_pk_bf16_f32 v216, v24, v25
    v_cvt_pk_bf16_f32 v217, v26, v27
    v_cvt_pk_bf16_f32 v218, v28, v29
    v_cvt_pk_bf16_f32 v219, v30, v31
    buffer_store_dwordx4 v[216:219], v255, s[40:43], s59 offen offset:3072 sc1
    v_cvt_pk_bf16_f32 v220, v56, v57
    v_cvt_pk_bf16_f32 v221, v58, v59
    v_cvt_pk_bf16_f32 v222, v60, v61
    v_cvt_pk_bf16_f32 v223, v62, v63
    buffer_store_dwordx4 v[220:223], v250, s[40:43], s59 offen offset:3072 sc1
L_k1_fin:
L_k1_end:
    s_endpgm
L_s1_C_rare:
    s_mov_b32 s68, 0
    s_call_b64 s[66:67], L_rare1
    s_branch L_s1_next
L_s1_A_rare:
    s_mov_b32 s68, 1
    s_call_b64 s[66:67], L_rare1
    s_branch L_s1_next
L_s1_B_rare:
    s_mov_b32 s68, 0
    s_call_b64 s[66:67], L_rare1
    s_branch L_s1_next
L_lp2_C_rare:
    s_mov_b32 s68, 0
    s_call_b64 s[66:67], L_rare0
    s_branch L_lp2_next
L_lp2_A_rare:
    s_mov_b32 s68, 1
    s_call_b64 s[66:67], L_rare0
    s_branch L_lp2_next
L_lp2_B_rare:
    s_mov_b32 s68, 0
    s_call_b64 s[66:67], L_rare0
    s_branch L_lp2_next
L_lp3_C_rare:
    s_mov_b32 s68, 0
    s_call_b64 s[66:67], L_rare1
    s_branch L_lp3_next
L_lp3_A_rare:
    s_mov_b32 s68, 1
    s_call_b64 s[66:67], L_rare1
    s_branch L_lp3_next
L_lp3_B_rare:
    s_mov_b32 s68, 0
    s_call_b64 s[66:67], L_rare1
    s_branch L_lp3_next
L_lp4_C_rare:
    s_mov_b32 s68, 0
    s_call_b64 s[66:67], L_rare0
    s_branch L_lp4_next
L_lp4_A_rare:
    s_mov_b32 s68, 1
    s_call_b64 s[66:67], L_rare0
    s_branch L_lp4_next
L_lp4_B_rare:
    s_mov_b32 s68, 0
    s_call_b64 s[66:67], L_rare0
    s_branch L_lp4_next
L_lp5_C_rare:
    s_mov_b32 s68, 0
    s_call_b64 s[66:67], L_rare1
    s_branch L_lp5_next
L_lp5_A_rare:
    s_mov_b32 s68, 1
    s_call_b64 s[66:67], L_rare1
    s_branch L_lp5_next
L_lp5_B_rare:
    s_mov_b32 s68, 0
    s_call_b64 s[66:67], L_rare1
    s_branch L_lp5_next
L_tl14_C_rare:
    s_mov_b32 s68, 0
    s_call_b64 s[66:67], L_rare0
    s_branch L_tl14_next
L_tl14_A_rare:
    s_mov_b32 s68, 1
    s_call_b64 s[66:67], L_rare0
    s_branch L_tl14_next
L_tl14_B_rare:
    s_mov_b32 s68, 0
    s_call_b64 s[66:67], L_rare0
    s_branch L_tl14_next
L_tl15_C_rare:
    s_mov_b32 s68, 0
    s_call_b64 s[66:67], L_rare1
    s_branch L_tl15_next
L_tl15_A_rare:
    s_mov_b32 s68, 1
    s_call_b64 s[66:67], L_rare1
    s_branch L_tl15_next
L_tl15_B_rare:
    s_mov_b32 s68, 0
    s_call_b64 s[66:67], L_rare1
    s_branch L_tl15_next
L_rare0:
    s_nop 8
    v_max3_f32 v249, v172, v173, v174
    v_max3_f32 v250, v175, v176, v177
    v_max3_f32 v249, v178, v179, v249
    v_max_f32 v249, v249, v250
    v_mov_b32 v250, v249
    s_nop 1
    v_permlane32_swap_b32 v249, v250
    v_max_f32 v249, v249, v250
    v_mov_b32 v250, v249
    s_nop 1
    v_permlane16_swap_b32 v249, v250
    v_max_f32 v249, v249, v250
    v_add_f32 v249, 0x40e00000, v249
    v_max_f32 v249, 0, v249
    v_sub_f32 v250, 0, v249
    v_exp_f32 v250, v250
    v_sub_f32 v156, v156, v249
    v_sub_f32 v157, v157, v249
    v_sub_f32 v158, v158, v249
    v_sub_f32 v159, v159, v249
    v_mul_f32 v144, v144, v250
    v_mul_f32 v145, v145, v250
    v_mul_f32 v146, v146, v250
    v_mul_f32 v147, v147, v250
    v_mul_f32 v0, v0, v250
    v_mul_f32 v1, v1, v250
    v_mul_f32 v2, v2, v250
    v_mul_f32 v3, v3, v250
    v_mul_f32 v4, v4, v250
    v_mul_f32 v5, v5, v250
    v_mul_f32 v6, v6, v250
    v_mul_f32 v7, v7, v250
    v_mul_f32 v8, v8, v250
    v_mul_f32 v9, v9, v250
    v_mul_f32 v10, v10, v250
    v_mul_f32 v11, v11, v250
    v_mul_f32 v12, v12, v250
    v_mul_f32 v13, v13, v250
    v_mul_f32 v14, v14, v250
    v_mul_f32 v15, v15, v250
    v_mul_f32 v16, v16, v250
    v_mul_f32 v17, v17, v250
    v_mul_f32 v18, v18, v250
    v_mul_f32 v19, v19, v250
    v_mul_f32 v20, v20, v250
    v_mul_f32 v21, v21, v250
    v_mul_f32 v22, v22, v250
    v_mul_f32 v23, v23, v250
    v_mul_f32 v24, v24, v250
    v_mul_f32 v25, v25, v250
    v_mul_f32 v26, v26, v250
    v_mul_f32 v27, v27, v250
    v_mul_f32 v28, v28, v250
    v_mul_f32 v29, v29, v250
    v_mul_f32 v30, v30, v250
    v_mul_f32 v31, v31, v250
    v_sub_f32 v250, v172, v249
    v_sub_f32 v251, v173, v249
    v_exp_f32 v250, v250
    v_exp_f32 v251, v251
    s_nop 0
    v_cvt_pk_bf16_f32 v196, v250, v251
    v_sub_f32 v250, v174, v249
    v_sub_f32 v251, v175, v249
    v_exp_f32 v250, v250
    v_exp_f32 v251, v251
    s_nop 0
    v_cvt_pk_bf16_f32 v197, v250, v251
    v_sub_f32 v250, v176, v249
    v_sub_f32 v251, v177, v249
    v_exp_f32 v250, v250
    v_exp_f32 v251, v251
    s_nop 0
    v_cvt_pk_bf16_f32 v198, v250, v251
    v_sub_f32 v250, v178, v249
    v_sub_f32 v251, v179, v249
    v_exp_f32 v250, v250
    v_exp_f32 v251, v251
    s_nop 0
    v_cvt_pk_bf16_f32 v199, v250, v251
    v_max3_f32 v249, v180, v181, v182
    v_max3_f32 v250, v183, v184, v185
    v_max3_f32 v249, v186, v187, v249
    v_max_f32 v249, v249, v250
    v_mov_b32 v250, v249
    s_nop 1
    v_permlane32_swap_b32 v249, v250
    v_max_f32 v249, v249, v250
    v_mov_b32 v250, v249
    s_nop 1
    v_permlane16_swap_b32 v249, v250
    v_max_f32 v249, v249, v250
    v_add_f32 v249, 0x40e00000, v249
    v_max_f32 v249, 0, v249
    v_sub_f32 v250, 0, v249
    v_exp_f32 v250, v250
    v_sub_f32 v160, v160, v249
    v_sub_f32 v161, v161, v249
    v_sub_f32 v162, v162, v249
    v_sub_f32 v163, v163, v249
    v_mul_f32 v148, v148, v250
    v_mul_f32 v149, v149, v250
    v_mul_f32 v150, v150, v250
    v_mul_f32 v151, v151, v250
    v_mul_f32 v32, v32, v250
    v_mul_f32 v33, v33, v250
    v_mul_f32 v34, v34, v250
    v_mul_f32 v35, v35, v250
    v_mul_f32 v36, v36, v250
    v_mul_f32 v37, v37, v250
    v_mul_f32 v38, v38, v250
    v_mul_f32 v39, v39, v250
    v_mul_f32 v40, v40, v250
    v_mul_f32 v41, v41, v250
    v_mul_f32 v42, v42, v250
    v_mul_f32 v43, v43, v250
    v_mul_f32 v44, v44, v250
    v_mul_f32 v45, v45, v250
    v_mul_f32 v46, v46, v250
    v_mul_f32 v47, v47, v250
    v_mul_f32 v48, v48, v250
    v_mul_f32 v49, v49, v250
    v_mul_f32 v50, v50, v250
    v_mul_f32 v51, v51, v250
    v_mul_f32 v52, v52, v250
    v_mul_f32 v53, v53, v250
    v_mul_f32 v54, v54, v250
    v_mul_f32 v55, v55, v250
    v_mul_f32 v56, v56, v250
    v_mul_f32 v57, v57, v250
    v_mul_f32 v58, v58, v250
    v_mul_f32 v59, v59, v250
    v_mul_f32 v60, v60, v250
    v_mul_f32 v61, v61, v250
    v_mul_f32 v62, v62, v250
    v_mul_f32 v63, v63, v250
    v_sub_f32 v250, v180, v249
    v_sub_f32 v251, v181, v249
    v_exp_f32 v250, v250
    v_exp_f32 v251, v251
    s_nop 0
    v_cvt_pk_bf16_f32 v200, v250, v251
    v_sub_f32 v250, v182, v249
    v_sub_f32 v251, v183, v249
    v_exp_f32 v250, v250
    v_exp_f32 v251, v251
    s_nop 0
    v_cvt_pk_bf16_f32 v201, v250, v251
    v_sub_f32 v250, v184, v249
    v_sub_f32 v251, v185, v249
    v_exp_f32 v250, v250
    v_exp_f32 v251, v251
    s_nop 0
    v_cvt_pk_bf16_f32 v202, v250, v251
    v_sub_f32 v250, v186, v249
    v_sub_f32 v251, v187, v249
    v_exp_f32 v250, v250
    v_exp_f32 v251, v251
    s_nop 0
    v_cvt_pk_bf16_f32 v203, v250, v251
    s_cmp_eq_u32 s68, 0
    s_cbranch_scc1 L_rare0_ret
    v_max3_f32 v249, v188, v189, v190
    v_max3_f32 v250, v191, v192, v193
    v_max3_f32 v249, v194, v195, v249
    v_max_f32 v249, v249, v250
    v_mov_b32 v250, v249
    s_nop 1
    v_permlane32_swap_b32 v249, v250
    v_max_f32 v249, v249, v250
    v_mov_b32 v250, v249
    s_nop 1
    v_permlane16_swap_b32 v249, v250
    v_max_f32 v249, v249, v250
    v_add_f32 v249, 0x40e00000, v249
    v_max_f32 v249, 0, v249
    v_sub_f32 v250, 0, v249
    v_exp_f32 v250, v250
    v_sub_f32 v164, v164, v249
    v_sub_f32 v165, v165, v249
    v_sub_f32 v166, v166, v249
    v_sub_f32 v167, v167, v249
    v_mul_f32 v152, v152, v250
    v_mul_f32 v153, v153, v250
    v_mul_f32 v154, v154, v250
    v_mul_f32 v155, v155, v250
    v_mul_f32 v64, v64, v250
    v_mul_f32 v65, v65, v250
    v_mul_f32 v66, v66, v250
    v_mul_f32 v67, v67, v250
    v_mul_f32 v68, v68, v250
    v_mul_f32 v69, v69, v250
    v_mul_f32 v70, v70, v250
    v_mul_f32 v71, v71, v250
    v_mul_f32 v72, v72, v250
    v_mul_f32 v73, v73, v250
    v_mul_f32 v74, v74, v250
    v_mul_f32 v75, v75, v250
    v_mul_f32 v76, v76, v250
    v_mul_f32 v77, v77, v250
    v_mul_f32 v78, v78, v250
    v_mul_f32 v79, v79, v250
    v_mul_f32 v80, v80, v250
    v_mul_f32 v81, v81, v250
    v_mul_f32 v82, v82, v250
    v_mul_f32 v83, v83, v250
    v_mul_f32 v84, v84, v250
    v_mul_f32 v85, v85, v250
    v_mul_f32 v86, v86, v250
    v_mul_f32 v87, v87, v250
    v_mul_f32 v88, v88, v250
    v_mul_f32 v89, v89, v250
    v_mul_f32 v90, v90, v250
    v_mul_f32 v91, v91, v250
    v_mul_f32 v92, v92, v250
    v_mul_f32 v93, v93, v250
    v_mul_f32 v94, v94, v250
    v_mul_f32 v95, v95, v250
    v_sub_f32 v250, v188, v249
    v_sub_f32 v251, v189, v249
    v_exp_f32 v250, v250
    v_exp_f32 v251, v251
    s_nop 0
    v_cvt_pk_bf16_f32 v212, v250, v251
    v_sub_f32 v250, v190, v249
    v_sub_f32 v251, v191, v249
    v_exp_f32 v250, v250
    v_exp_f32 v251, v251
    s_nop 0
    v_cvt_pk_bf16_f32 v213, v250, v251
    v_sub_f32 v250, v192, v249
    v_sub_f32 v251, v193, v249
    v_exp_f32 v250, v250
    v_exp_f32 v251, v251
    s_nop 0
    v_cvt_pk_bf16_f32 v214, v250, v251
    v_sub_f32 v250, v194, v249
    v_sub_f32 v251, v195, v249
    v_exp_f32 v250, v250
    v_exp_f32 v251, v251
    s_nop 0
    v_cvt_pk_bf16_f32 v215, v250, v251
L_rare0_ret:
    s_nop 1
    s_setpc_b64 s[66:67]
L_rare1:
    s_nop 8
    v_max3_f32 v249, v172, v173, v174
    v_max3_f32 v250, v175, v176, v177
    v_max3_f32 v249, v178, v179, v249
    v_max_f32 v249, v249, v250
    v_mov_b32 v250, v249
    s_nop 1
    v_permlane32_swap_b32 v249, v250
    v_max_f32 v249, v249, v250
    v_mov_b32 v250, v249
    s_nop 1
    v_permlane16_swap_b32 v249, v250
    v_max_f32 v249, v249, v250
    v_add_f32 v249, 0x40e00000, v249
    v_max_f32 v249, 0, v249
    v_sub_f32 v250, 0, v249
    v_exp_f32 v250, v250
    v_sub_f32 v156, v156, v249
    v_sub_f32 v157, v157, v249
    v_sub_f32 v158, v158, v249
    v_sub_f32 v159, v159, v249
    v_mul_f32 v144, v144, v250
    v_mul_f32 v145, v145, v250
    v_mul_f32 v146, v146, v250
    v_mul_f32 v147, v147, v250
    v_mul_f32 v0, v0, v250
    v_mul_f32 v1, v1, v250
    v_mul_f32 v2, v2, v250
    v_mul_f32 v3, v3, v250
    v_mul_f32 v4, v4, v250
    v_mul_f32 v5, v5, v250
    v_mul_f32 v6, v6, v250
    v_mul_f32 v7, v7, v250
    v_mul_f32 v8, v8, v250
    v_mul_f32 v9, v9, v250
    v_mul_f32 v10, v10, v250
    v_mul_f32 v11, v11, v250
    v_mul_f32 v12, v12, v250
    v_mul_f32 v13, v13, v250
    v_mul_f32 v14, v14, v250
    v_mul_f32 v15, v15, v250
    v_mul_f32 v16, v16, v250
    v_mul_f32 v17, v17, v250
    v_mul_f32 v18, v18, v250
    v_mul_f32 v19, v19, v250
    v_mul_f32 v20, v20, v250
    v_mul_f32 v21, v21, v250
    v_mul_f32 v22, v22, v250
    v_mul_f32 v23, v23, v250
    v_mul_f32 v24, v24, v250
    v_mul_f32 v25, v25, v250
    v_mul_f32 v26, v26, v250
    v_mul_f32 v27, v27, v250
    v_mul_f32 v28, v28, v250
    v_mul_f32 v29, v29, v250
    v_mul_f32 v30, v30, v250
    v_mul_f32 v31, v31, v250
    v_sub_f32 v250, v172, v249
    v_sub_f32 v251, v173, v249
    v_exp_f32 v250, v250
    v_exp_f32 v251, v251
    s_nop 0
    v_cvt_pk_bf16_f32 v204, v250, v251
    v_sub_f32 v250, v174, v249
    v_sub_f32 v251, v175, v249
    v_exp_f32 v250, v250
    v_exp_f32 v251, v251
    s_nop 0
    v_cvt_pk_bf16_f32 v205, v250, v251
    v_sub_f32 v250, v176, v249
    v_sub_f32 v251, v177, v249
    v_exp_f32 v250, v250
    v_exp_f32 v251, v251
    s_nop 0
    v_cvt_pk_bf16_f32 v206, v250, v251
    v_sub_f32 v250, v178, v249
    v_sub_f32 v251, v179, v249
    v_exp_f32 v250, v250
    v_exp_f32 v251, v251
    s_nop 0
    v_cvt_pk_bf16_f32 v207, v250, v251
    v_max3_f32 v249, v180, v181, v182
    v_max3_f32 v250, v183, v184, v185
    v_max3_f32 v249, v186, v187, v249
    v_max_f32 v249, v249, v250
    v_mov_b32 v250, v249
    s_nop 1
    v_permlane32_swap_b32 v249, v250
    v_max_f32 v249, v249, v250
    v_mov_b32 v250, v249
    s_nop 1
    v_permlane16_swap_b32 v249, v250
    v_max_f32 v249, v249, v250
    v_add_f32 v249, 0x40e00000, v249
    v_max_f32 v249, 0, v249
    v_sub_f32 v250, 0, v249
    v_exp_f32 v250, v250
    v_sub_f32 v160, v160, v249
    v_sub_f32 v161, v161, v249
    v_sub_f32 v162, v162, v249
    v_sub_f32 v163, v163, v249
    v_mul_f32 v148, v148, v250
    v_mul_f32 v149, v149, v250
    v_mul_f32 v150, v150, v250
    v_mul_f32 v151, v151, v250
    v_mul_f32 v32, v32, v250
    v_mul_f32 v33, v33, v250
    v_mul_f32 v34, v34, v250
    v_mul_f32 v35, v35, v250
    v_mul_f32 v36, v36, v250
    v_mul_f32 v37, v37, v250
    v_mul_f32 v38, v38, v250
    v_mul_f32 v39, v39, v250
    v_mul_f32 v40, v40, v250
    v_mul_f32 v41, v41, v250
    v_mul_f32 v42, v42, v250
    v_mul_f32 v43, v43, v250
    v_mul_f32 v44, v44, v250
    v_mul_f32 v45, v45, v250
    v_mul_f32 v46, v46, v250
    v_mul_f32 v47, v47, v250
    v_mul_f32 v48, v48, v250
    v_mul_f32 v49, v49, v250
    v_mul_f32 v50, v50, v250
    v_mul_f32 v51, v51, v250
    v_mul_f32 v52, v52, v250
    v_mul_f32 v53, v53, v250
    v_mul_f32 v54, v54, v250
    v_mul_f32 v55, v55, v250
    v_mul_f32 v56, v56, v250
    v_mul_f32 v57, v57, v250
    v_mul_f32 v58, v58, v250
    v_mul_f32 v59, v59, v250
    v_mul_f32 v60, v60, v250
    v_mul_f32 v61, v61, v250
    v_mul_f32 v62, v62, v250
    v_mul_f32 v63, v63, v250
    v_sub_f32 v250, v180, v249
    v_sub_f32 v251, v181, v249
    v_exp_f32 v250, v250
    v_exp_f32 v251, v251
    s_nop 0
    v_cvt_pk_bf16_f32 v208, v250, v251
    v_sub_f32 v250, v182, v249
    v_sub_f32 v251, v183, v249
    v_exp_f32 v250, v250
    v_exp_f32 v251, v251
    s_nop 0
    v_cvt_pk_bf16_f32 v209, v250, v251
    v_sub_f32 v250, v184, v249
    v_sub_f32 v251, v185, v249
    v_exp_f32 v250, v250
    v_exp_f32 v251, v251
    s_nop 0
    v_cvt_pk_bf16_f32 v210, v250, v251
    v_sub_f32 v250, v186, v249
    v_sub_f32 v251, v187, v249
    v_exp_f32 v250, v250
    v_exp_f32 v251, v251
    s_nop 0
    v_cvt_pk_bf16_f32 v211, v250, v251
    s_cmp_eq_u32 s68, 0
    s_cbranch_scc1 L_rare1_ret
    v_max3_f32 v249, v188, v189, v190
    v_max3_f32 v250, v191, v192, v193
    v_max3_f32 v249, v194, v195, v249
    v_max_f32 v249, v249, v250
    v_mov_b32 v250, v249
    s_nop 1
    v_permlane32_swap_b32 v249, v250
    v_max_f32 v249, v249, v250
    v_mov_b32 v250, v249
    s_nop 1
    v_permlane16_swap_b32 v249, v250
    v_max_f32 v249, v249, v250
    v_add_f32 v249, 0x40e00000, v249
    v_max_f32 v249, 0, v249
    v_sub_f32 v250, 0, v249
    v_exp_f32 v250, v250
    v_sub_f32 v164, v164, v249
    v_sub_f32 v165, v165, v249
    v_sub_f32 v166, v166, v249
    v_sub_f32 v167, v167, v249
    v_mul_f32 v152, v152, v250
    v_mul_f32 v153, v153, v250
    v_mul_f32 v154, v154, v250
    v_mul_f32 v155, v155, v250
    v_mul_f32 v64, v64, v250
    v_mul_f32 v65, v65, v250
    v_mul_f32 v66, v66, v250
    v_mul_f32 v67, v67, v250
    v_mul_f32 v68, v68, v250
    v_mul_f32 v69, v69, v250
    v_mul_f32 v70, v70, v250
    v_mul_f32 v71, v71, v250
    v_mul_f32 v72, v72, v250
    v_mul_f32 v73, v73, v250
    v_mul_f32 v74, v74, v250
    v_mul_f32 v75, v75, v250
    v_mul_f32 v76, v76, v250
    v_mul_f32 v77, v77, v250
    v_mul_f32 v78, v78, v250
    v_mul_f32 v79, v79, v250
    v_mul_f32 v80, v80, v250
    v_mul_f32 v81, v81, v250
    v_mul_f32 v82, v82, v250
    v_mul_f32 v83, v83, v250
    v_mul_f32 v84, v84, v250
    v_mul_f32 v85, v85, v250
    v_mul_f32 v86, v86, v250
    v_mul_f32 v87, v87, v250
    v_mul_f32 v88, v88, v250
    v_mul_f32 v89, v89, v250
    v_mul_f32 v90, v90, v250
    v_mul_f32 v91, v91, v250
    v_mul_f32 v92, v92, v250
    v_mul_f32 v93, v93, v250
    v_mul_f32 v94, v94, v250
    v_mul_f32 v95, v95, v250
    v_sub_f32 v250, v188, v249
    v_sub_f32 v251, v189, v249
    v_exp_f32 v250, v250
    v_exp_f32 v251, v251
    s_nop 0
    v_cvt_pk_bf16_f32 v212, v250, v251
    v_sub_f32 v250, v190, v249
    v_sub_f32 v251, v191, v249
    v_exp_f32 v250, v250
    v_exp_f32 v251, v251
    s_nop 0
    v_cvt_pk_bf16_f32 v213, v250, v251
    v_sub_f32 v250, v192, v249
    v_sub_f32 v251, v193, v249
    v_exp_f32 v250, v250
    v_exp_f32 v251, v251
    s_nop 0
    v_cvt_pk_bf16_f32 v214, v250, v251
    v_sub_f32 v250, v194, v249
    v_sub_f32 v251, v195, v249
    v_exp_f32 v250, v250
    v_exp_f32 v251, v251
    s_nop 0
    v_cvt_pk_bf16_f32 v215, v250, v251
L_rare1_ret:
    s_nop 1
    s_setpc_b64 s[66:67]
.globl reduce_kernel
.p2align 8
.type reduce_kernel,@function
reduce_kernel:
    s_cmp_ge_u32 s2, 256
    s_cbranch_scc1 L_k3_end
    s_load_dwordx2 s[8:9], s[0:1], 80
    s_load_dwordx2 s[10:11], s[0:1], 96
    v_lshrrev_b32 v1, 6, v0
    v_and_b32 v2, 63, v0
    v_readfirstlane_b32 s40, v1
    v_lshlrev_b32 v3, 4, v2
    v_and_b32 v4, 15, v2
    v_lshlrev_b32 v4, 11, v4
    v_lshrrev_b32 v5, 4, v2
    v_lshl_add_u32 v4, v5, 3, v4
    s_mov_b32 s41, s40
    s_mul_i32 s62, s2, 9
    s_add_u32 s40, s40, s62
    s_lshl_b32 s62, s40, 10
    s_add_u32 s62, s62, 0x2000000
    s_waitcnt lgkmcnt(0)
    s_add_u32 s32, s10, s62
    s_addc_u32 s33, s11, 0
    s_and_b32 s33, s33, 0xffff
    s_mov_b32 s34, 0x21c0400
    s_mov_b32 s35, 0x20000
    s_mov_b32 s63, 0
    buffer_load_dwordx4 v[16:19], v3, s[32:35], s63 offen
    s_mov_b32 s63, 2359296
    buffer_load_dwordx4 v[20:23], v3, s[32:35], s63 offen
    s_mov_b32 s63, 4718592
    buffer_load_dwordx4 v[24:27], v3, s[32:35], s63 offen
    s_mov_b32 s63, 7077888
    buffer_load_dwordx4 v[28:31], v3, s[32:35], s63 offen
    s_mov_b32 s63, 9437184
    buffer_load_dwordx4 v[32:35], v3, s[32:35], s63 offen
    s_mov_b32 s63, 11796480
    buffer_load_dwordx4 v[36:39], v3, s[32:35], s63 offen
    s_mov_b32 s63, 14155776
    buffer_load_dwordx4 v[40:43], v3, s[32:35], s63 offen
    s_mov_b32 s63, 16515072
    buffer_load_dwordx4 v[44:47], v3, s[32:35], s63 offen
    s_mov_b32 s63, 18874368
    buffer_load_dwordx4 v[48:51], v3, s[32:35], s63 offen
    s_mov_b32 s63, 21233664
    buffer_load_dwordx4 v[52:55], v3, s[32:35], s63 offen
    s_mov_b32 s63, 23592960
    buffer_load_dwordx4 v[56:59], v3, s[32:35], s63 offen
    s_mov_b32 s63, 25952256
    buffer_load_dwordx4 v[60:63], v3, s[32:35], s63 offen
    s_mov_b32 s63, 28311552
    buffer_load_dwordx4 v[64:67], v3, s[32:35], s63 offen
    s_mov_b32 s63, 30670848
    buffer_load_dwordx4 v[68:71], v3, s[32:35], s63 offen
    s_mov_b32 s63, 33030144
    buffer_load_dwordx4 v[72:75], v3, s[32:35], s63 offen
    s_mov_b32 s63, 35389440
    buffer_load_dwordx4 v[76:79], v3, s[32:35], s63 offen
    s_mov_b32 s42, s2
    s_and_b32 s43, s42, 3
    s_bfe_u32 s44, s42, 0x20002
    s_lshr_b32 s45, s42, 4
    s_lshr_b32 s46, s41, 2
    s_lshl_b32 s62, s43, 1
    s_add_u32 s46, s46, s62
    s_and_b32 s47, s41, 3
    s_xor_b32 s47, s47, s43
    s_cmp_eq_u32 s41, 8
    s_cselect_b32 s46, 8, s46
    s_and_b32 s62, s45, 7
    s_mul_i32 s62, s62, 9
    s_add_u32 s62, s62, s46
    s_lshl_b32 s62, s62, 15
    s_lshr_b32 s63, s45, 3
    s_lshl_b32 s63, s63, 10
    s_add_u32 s62, s62, s63
    s_lshl_b32 s63, s44, 8
    s_add_u32 s62, s62, s63
    s_lshl_b32 s63, s47, 6
    s_add_u32 s62, s62, s63
    s_sub_u32 s63, 2359296, s62
    s_add_u32 s36, s8, s62
    s_addc_u32 s37, s9, 0
    s_and_b32 s37, s37, 0xffff
    s_mov_b32 s38, s63
    s_mov_b32 s39, 0x20000
    s_waitcnt vmcnt(15)
    v_lshlrev_b32 v8, 16, v16
    v_and_b32 v9, 0xffff0000, v16
    v_lshlrev_b32 v10, 16, v17
    v_and_b32 v11, 0xffff0000, v17
    v_lshlrev_b32 v12, 16, v18
    v_and_b32 v13, 0xffff0000, v18
    v_lshlrev_b32 v14, 16, v19
    v_and_b32 v15, 0xffff0000, v19
    s_waitcnt vmcnt(14)
    v_lshlrev_b32 v6, 16, v20
    v_and_b32 v7, 0xffff0000, v20
    v_add_f32 v8, v8, v6
    v_add_f32 v9, v9, v7
    v_lshlrev_b32 v6, 16, v21
    v_and_b32 v7, 0xffff0000, v21
    v_add_f32 v10, v10, v6
    v_add_f32 v11, v11, v7
    v_lshlrev_b32 v6, 16, v22
    v_and_b32 v7, 0xffff0000, v22
    v_add_f32 v12, v12, v6
    v_add_f32 v13, v13, v7
    v_lshlrev_b32 v6, 16, v23
    v_and_b32 v7, 0xffff0000, v23
    v_add_f32 v14, v14, v6
    v_add_f32 v15, v15, v7
    s_waitcnt vmcnt(13)
    v_lshlrev_b32 v6, 16, v24
    v_and_b32 v7, 0xffff0000, v24
    v_add_f32 v8, v8, v6
    v_add_f32 v9, v9, v7
    v_lshlrev_b32 v6, 16, v25
    v_and_b32 v7, 0xffff0000, v25
    v_add_f32 v10, v10, v6
    v_add_f32 v11, v11, v7
    v_lshlrev_b32 v6, 16, v26
    v_and_b32 v7, 0xffff0000, v26
    v_add_f32 v12, v12, v6
    v_add_f32 v13, v13, v7
    v_lshlrev_b32 v6, 16, v27
    v_and_b32 v7, 0xffff0000, v27
    v_add_f32 v14, v14, v6
    v_add_f32 v15, v15, v7
    s_waitcnt vmcnt(12)
    v_lshlrev_b32 v6, 16, v28
    v_and_b32 v7, 0xffff0000, v28
    v_add_f32 v8, v8, v6
    v_add_f32 v9, v9, v7
    v_lshlrev_b32 v6, 16, v29
    v_and_b32 v7, 0xffff0000, v29
    v_add_f32 v10, v10, v6
    v_add_f32 v11, v11, v7
    v_lshlrev_b32 v6, 16, v30
    v_and_b32 v7, 0xffff0000, v30
    v_add_f32 v12, v12, v6
    v_add_f32 v13, v13, v7
    v_lshlrev_b32 v6, 16, v31
    v_and_b32 v7, 0xffff0000, v31
    v_add_f32 v14, v14, v6
    v_add_f32 v15, v15, v7
    s_waitcnt vmcnt(11)
    v_lshlrev_b32 v6, 16, v32
    v_and_b32 v7, 0xffff0000, v32
    v_add_f32 v8, v8, v6
    v_add_f32 v9, v9, v7
    v_lshlrev_b32 v6, 16, v33
    v_and_b32 v7, 0xffff0000, v33
    v_add_f32 v10, v10, v6
    v_add_f32 v11, v11, v7
    v_lshlrev_b32 v6, 16, v34
    v_and_b32 v7, 0xffff0000, v34
    v_add_f32 v12, v12, v6
    v_add_f32 v13, v13, v7
    v_lshlrev_b32 v6, 16, v35
    v_and_b32 v7, 0xffff0000, v35
    v_add_f32 v14, v14, v6
    v_add_f32 v15, v15, v7
    s_waitcnt vmcnt(10)
    v_lshlrev_b32 v6, 16, v36
    v_and_b32 v7, 0xffff0000, v36
    v_add_f32 v8, v8, v6
    v_add_f32 v9, v9, v7
    v_lshlrev_b32 v6, 16, v37
    v_and_b32 v7, 0xffff0000, v37
    v_add_f32 v10, v10, v6
    v_add_f32 v11, v11, v7
    v_lshlrev_b32 v6, 16, v38
    v_and_b32 v7, 0xffff0000, v38
    v_add_f32 v12, v12, v6
    v_add_f32 v13, v13, v7
    v_lshlrev_b32 v6, 16, v39
    v_and_b32 v7, 0xffff0000, v39
    v_add_f32 v14, v14, v6
    v_add_f32 v15, v15, v7
    s_waitcnt vmcnt(9)
    v_lshlrev_b32 v6, 16, v40
    v_and_b32 v7, 0xffff0000, v40
    v_add_f32 v8, v8, v6
    v_add_f32 v9, v9, v7
    v_lshlrev_b32 v6, 16, v41
    v_and_b32 v7, 0xffff0000, v41
    v_add_f32 v10, v10, v6
    v_add_f32 v11, v11, v7
    v_lshlrev_b32 v6, 16, v42
    v_and_b32 v7, 0xffff0000, v42
    v_add_f32 v12, v12, v6
    v_add_f32 v13, v13, v7
    v_lshlrev_b32 v6, 16, v43
    v_and_b32 v7, 0xffff0000, v43
    v_add_f32 v14, v14, v6
    v_add_f32 v15, v15, v7
    s_waitcnt vmcnt(8)
    v_lshlrev_b32 v6, 16, v44
    v_and_b32 v7, 0xffff0000, v44
    v_add_f32 v8, v8, v6
    v_add_f32 v9, v9, v7
    v_lshlrev_b32 v6, 16, v45
    v_and_b32 v7, 0xffff0000, v45
    v_add_f32 v10, v10, v6
    v_add_f32 v11, v11, v7
    v_lshlrev_b32 v6, 16, v46
    v_and_b32 v7, 0xffff0000, v46
    v_add_f32 v12, v12, v6
    v_add_f32 v13, v13, v7
    v_lshlrev_b32 v6, 16, v47
    v_and_b32 v7, 0xffff0000, v47
    v_add_f32 v14, v14, v6
    v_add_f32 v15, v15, v7
    s_waitcnt vmcnt(7)
    v_lshlrev_b32 v6, 16, v48
    v_and_b32 v7, 0xffff0000, v48
    v_add_f32 v8, v8, v6
    v_add_f32 v9, v9, v7
    v_lshlrev_b32 v6, 16, v49
    v_and_b32 v7, 0xffff0000, v49
    v_add_f32 v10, v10, v6
    v_add_f32 v11, v11, v7
    v_lshlrev_b32 v6, 16, v50
    v_and_b32 v7, 0xffff0000, v50
    v_add_f32 v12, v12, v6
    v_add_f32 v13, v13, v7
    v_lshlrev_b32 v6, 16, v51
    v_and_b32 v7, 0xffff0000, v51
    v_add_f32 v14, v14, v6
    v_add_f32 v15, v15, v7
    s_waitcnt vmcnt(6)
    v_lshlrev_b32 v6, 16, v52
    v_and_b32 v7, 0xffff0000, v52
    v_add_f32 v8, v8, v6
    v_add_f32 v9, v9, v7
    v_lshlrev_b32 v6, 16, v53
    v_and_b32 v7, 0xffff0000, v53
    v_add_f32 v10, v10, v6
    v_add_f32 v11, v11, v7
    v_lshlrev_b32 v6, 16, v54
    v_and_b32 v7, 0xffff0000, v54
    v_add_f32 v12, v12, v6
    v_add_f32 v13, v13, v7
    v_lshlrev_b32 v6, 16, v55
    v_and_b32 v7, 0xffff0000, v55
    v_add_f32 v14, v14, v6
    v_add_f32 v15, v15, v7
    s_waitcnt vmcnt(5)
    v_lshlrev_b32 v6, 16, v56
    v_and_b32 v7, 0xffff0000, v56
    v_add_f32 v8, v8, v6
    v_add_f32 v9, v9, v7
    v_lshlrev_b32 v6, 16, v57
    v_and_b32 v7, 0xffff0000, v57
    v_add_f32 v10, v10, v6
    v_add_f32 v11, v11, v7
    v_lshlrev_b32 v6, 16, v58
    v_and_b32 v7, 0xffff0000, v58
    v_add_f32 v12, v12, v6
    v_add_f32 v13, v13, v7
    v_lshlrev_b32 v6, 16, v59
    v_and_b32 v7, 0xffff0000, v59
    v_add_f32 v14, v14, v6
    v_add_f32 v15, v15, v7
    s_waitcnt vmcnt(4)
    v_lshlrev_b32 v6, 16, v60
    v_and_b32 v7, 0xffff0000, v60
    v_add_f32 v8, v8, v6
    v_add_f32 v9, v9, v7
    v_lshlrev_b32 v6, 16, v61
    v_and_b32 v7, 0xffff0000, v61
    v_add_f32 v10, v10, v6
    v_add_f32 v11, v11, v7
    v_lshlrev_b32 v6, 16, v62
    v_and_b32 v7, 0xffff0000, v62
    v_add_f32 v12, v12, v6
    v_add_f32 v13, v13, v7
    v_lshlrev_b32 v6, 16, v63
    v_and_b32 v7, 0xffff0000, v63
    v_add_f32 v14, v14, v6
    v_add_f32 v15, v15, v7
    s_waitcnt vmcnt(3)
    v_lshlrev_b32 v6, 16, v64
    v_and_b32 v7, 0xffff0000, v64
    v_add_f32 v8, v8, v6
    v_add_f32 v9, v9, v7
    v_lshlrev_b32 v6, 16, v65
    v_and_b32 v7, 0xffff0000, v65
    v_add_f32 v10, v10, v6
    v_add_f32 v11, v11, v7
    v_lshlrev_b32 v6, 16, v66
    v_and_b32 v7, 0xffff0000, v66
    v_add_f32 v12, v12, v6
    v_add_f32 v13, v13, v7
    v_lshlrev_b32 v6, 16, v67
    v_and_b32 v7, 0xffff0000, v67
    v_add_f32 v14, v14, v6
    v_add_f32 v15, v15, v7
    s_waitcnt vmcnt(2)
    v_lshlrev_b32 v6, 16, v68
    v_and_b32 v7, 0xffff0000, v68
    v_add_f32 v8, v8, v6
    v_add_f32 v9, v9, v7
    v_lshlrev_b32 v6, 16, v69
    v_and_b32 v7, 0xffff0000, v69
    v_add_f32 v10, v10, v6
    v_add_f32 v11, v11, v7
    v_lshlrev_b32 v6, 16, v70
    v_and_b32 v7, 0xffff0000, v70
    v_add_f32 v12, v12, v6
    v_add_f32 v13, v13, v7
    v_lshlrev_b32 v6, 16, v71
    v_and_b32 v7, 0xffff0000, v71
    v_add_f32 v14, v14, v6
    v_add_f32 v15, v15, v7
    s_waitcnt vmcnt(1)
    v_lshlrev_b32 v6, 16, v72
    v_and_b32 v7, 0xffff0000, v72
    v_add_f32 v8, v8, v6
    v_add_f32 v9, v9, v7
    v_lshlrev_b32 v6, 16, v73
    v_and_b32 v7, 0xffff0000, v73
    v_add_f32 v10, v10, v6
    v_add_f32 v11, v11, v7
    v_lshlrev_b32 v6, 16, v74
    v_and_b32 v7, 0xffff0000, v74
    v_add_f32 v12, v12, v6
    v_add_f32 v13, v13, v7
    v_lshlrev_b32 v6, 16, v75
    v_and_b32 v7, 0xffff0000, v75
    v_add_f32 v14, v14, v6
    v_add_f32 v15, v15, v7
    s_waitcnt vmcnt(0)
    v_lshlrev_b32 v6, 16, v76
    v_and_b32 v7, 0xffff0000, v76
    v_add_f32 v8, v8, v6
    v_add_f32 v9, v9, v7
    v_lshlrev_b32 v6, 16, v77
    v_and_b32 v7, 0xffff0000, v77
    v_add_f32 v10, v10, v6
    v_add_f32 v11, v11, v7
    v_lshlrev_b32 v6, 16, v78
    v_and_b32 v7, 0xffff0000, v78
    v_add_f32 v12, v12, v6
    v_add_f32 v13, v13, v7
    v_lshlrev_b32 v6, 16, v79
    v_and_b32 v7, 0xffff0000, v79
    v_add_f32 v14, v14, v6
    v_add_f32 v15, v15, v7
    v_cvt_pk_bf16_f32 v16, v8, v9
    v_cvt_pk_bf16_f32 v17, v10, v11
    buffer_store_dwordx2 v[16:17], v4, s[36:39], 0 offen offset:0
    v_cvt_pk_bf16_f32 v18, v12, v13
    v_cvt_pk_bf16_f32 v19, v14, v15
    buffer_store_dwordx2 v[18:19], v4, s[36:39], 0 offen offset:32
L_k3_end:
    s_endpgm
L_code_end:
    s_endpgm
.section .rodata,"a"
.p2align 6
.amdhsa_kernel concat_heads__mha_block_cached__gqa_block_cached__near_ridge_kernel
  .amdhsa_next_free_vgpr 256
  .amdhsa_next_free_sgpr 102
  .amdhsa_accum_offset 256
  .amdhsa_group_segment_fixed_size 0
  .amdhsa_kernarg_size 104
  .amdhsa_user_sgpr_count 2
  .amdhsa_user_sgpr_kernarg_segment_ptr 1
  .amdhsa_system_sgpr_workgroup_id_x 1
.end_amdhsa_kernel
.p2align 6
.amdhsa_kernel reduce_kernel
  .amdhsa_next_free_vgpr 80
  .amdhsa_next_free_sgpr 72
  .amdhsa_accum_offset 80
  .amdhsa_group_segment_fixed_size 0
  .amdhsa_kernarg_size 104
  .amdhsa_user_sgpr_count 2
  .amdhsa_user_sgpr_kernarg_segment_ptr 1
  .amdhsa_system_sgpr_workgroup_id_x 1
.end_amdhsa_kernel
```
